```python
import torch

def _softmax(x, axis=-1):
    return torch.softmax(x, dim=axis)
def _gelu(x):
    return torch.nn.functional.gelu(x, approximate="tanh")
def _silu(x):
    return torch.nn.functional.silu(x)
def _sigmoid(x):
    return torch.sigmoid(x)
def _layernorm(x, axis=-1, eps=1e-5):
    m = x.mean(dim=axis, keepdim=True)
    v = x.var(dim=axis, keepdim=True, unbiased=False)
    return (x - m) / torch.sqrt(v + eps)
def _scatter_add(tgt, idx, src, axis=0):
    return tgt.clone().index_add_(axis, idx, src)
def _segment_sum(src, seg, n):
    out = torch.zeros((n,) + src.shape[1:], dtype=src.dtype)
    return out.index_add_(0, seg, src)
def _pad(x, pw):
    flat = tuple(v for pair in reversed(pw) for v in pair)
    return torch.nn.functional.pad(x, flat)

kernel_name = 'gated_mix__linear_kernel_hedgehog__linear_kernel_hedgehog__prompt'

def setup_inputs():

    _w = (lambda a: (lambda t: t.to(torch.bfloat16) if t.is_floating_point() else t)(torch.as_tensor(a)))
    def _A_setup():
        B, S, D, H = 1, 2048, 576, 32
        Dh = D // H
        return {
            "x": _w((lambda *s: torch.randn(*s, dtype=torch.bfloat16) * 0.05)(B, S, D)),
            "wqkv": _w((lambda *s: torch.randn(*s, dtype=torch.bfloat16) * 0.8)(D, 3 * D)),
            "w_phi": _w((lambda *s: torch.randn(*s, dtype=torch.bfloat16) * 0.8)(H, Dh, Dh) * (Dh ** -0.5)),
            "wo": _w((lambda *s: torch.randn(*s, dtype=torch.bfloat16) * 0.05)(D, D)),
        }
    _A_in = _A_setup()

    def _B_setup():
        B, S, D, H = 1, 2048, 576, 32
        Dh = D // H
        return {
            "x": _w((lambda *s: torch.randn(*s, dtype=torch.bfloat16) * 0.05)(B, S, D)),
            "wqkv": _w((lambda *s: torch.randn(*s, dtype=torch.bfloat16) * 0.8)(D, 3 * D)),
            "w_phi": _w((lambda *s: torch.randn(*s, dtype=torch.bfloat16) * 0.8)(H, Dh, Dh) * (Dh ** -0.5)),
            "wo": _w((lambda *s: torch.randn(*s, dtype=torch.bfloat16) * 0.05)(D, D)),
        }
    _B_in = _B_setup()

    return {
        "A_x": _A_in["x"],
        "A_wqkv": _A_in["wqkv"],
        "A_w_phi": _A_in["w_phi"],
        "A_wo": _A_in["wo"],
        "B_x": _B_in["x"],
        "B_wqkv": _B_in["wqkv"],
        "B_w_phi": _B_in["w_phi"],
        "B_wo": _B_in["wo"],
        "gate_w": _w((lambda *s: torch.randn(*s, dtype=torch.bfloat16) * 0.05)(576) * 16.0),
    }

def reference(A_x, A_wqkv, A_w_phi, A_wo, B_x, B_wqkv, B_w_phi, B_wo, gate_w):
    def _A_ref(x, wqkv, w_phi, wo):
        B, S, D = x.shape
        H = 32; Dh = D // H
        qkv = (lambda x, *d: x.permute(*d))((x @ wqkv).reshape(B, S, 3, H, Dh), 2, 0, 3, 1, 4)
        q, k, v = qkv[0], qkv[1], qkv[2]
        pq = torch.einsum("bhsd,hdf->bhsf", q, w_phi)
        pk = torch.einsum("bhsd,hdf->bhsf", k, w_phi)
        phi_q = torch.concatenate([_softmax(pq, axis=-1), _softmax(-pq, axis=-1)], axis=-1)
        phi_k = torch.concatenate([_softmax(pk, axis=-1), _softmax(-pk, axis=-1)], axis=-1)
        kv = torch.einsum("bhsf,bhsd->bhfd", phi_k, v)
        z  = torch.einsum("bhsf->bhf", phi_k)
        num = torch.einsum("bhqf,bhfd->bhqd", phi_q, kv)
        den = torch.einsum("bhqf,bhf->bhq", phi_q, z)[..., None] + 1e-6
        o = num / den
        return (lambda x, *d: x.permute(*d))(o, 0, 2, 1, 3).reshape(B, S, D) @ wo

    def _B_ref(x, wqkv, w_phi, wo):
        B, S, D = x.shape
        H = 32; Dh = D // H
        qkv = (lambda x, *d: x.permute(*d))((x @ wqkv).reshape(B, S, 3, H, Dh), 2, 0, 3, 1, 4)
        q, k, v = qkv[0], qkv[1], qkv[2]
        pq = torch.einsum("bhsd,hdf->bhsf", q, w_phi)
        pk = torch.einsum("bhsd,hdf->bhsf", k, w_phi)
        phi_q = torch.concatenate([_softmax(pq, axis=-1), _softmax(-pq, axis=-1)], axis=-1)
        phi_k = torch.concatenate([_softmax(pk, axis=-1), _softmax(-pk, axis=-1)], axis=-1)
        kv = torch.einsum("bhsf,bhsd->bhfd", phi_k, v)
        z  = torch.einsum("bhsf->bhf", phi_k)
        num = torch.einsum("bhqf,bhfd->bhqd", phi_q, kv)
        den = torch.einsum("bhqf,bhf->bhq", phi_q, z)[..., None] + 1e-6
        o = num / den
        return (lambda x, *d: x.permute(*d))(o, 0, 2, 1, 3).reshape(B, S, D) @ wo

    x = A_x
    g = _sigmoid((x * gate_w).sum(-1, keepdims=True))
    a = _A_ref(x, A_wqkv, A_w_phi, A_wo)
    b = _B_ref(x, B_wqkv, B_w_phi, B_wo)
    return g * a + (1 - g) * b
```

```asm
; @launch grid=(256,1,1) block=(512,1,1) lds=163840
.amdgcn_target "amdgcn-amd-amdhsa--gfx950"
.text
.globl gated_mix__linear_kernel_hedgehog__linear_kernel_hedgehog__prompt_kernel
.p2align 8
.type gated_mix__linear_kernel_hedgehog__linear_kernel_hedgehog__prompt_kernel,@function
gated_mix__linear_kernel_hedgehog__linear_kernel_hedgehog__prompt_kernel:
  s_cmp_ge_u32 s2, 256
  s_cbranch_scc1 L_end
  s_load_dwordx16 s[64:79], s[0:1], 0
  s_load_dwordx8 s[80:87], s[0:1], 64
  s_getpc_b64 s[94:95]
L_pc:
  v_and_b32 v1, 63, v0
  v_lshrrev_b32 v4, 6, v0
  s_lshr_b32 s49, s2, 3
  s_and_b32 s48, s2, 7
  v_readfirstlane_b32 s98, v4
  s_nop 0
  s_cmp_ge_u32 s98, 2
  s_nop 2
  s_cbranch_scc1 L_nopf
  s_lshl_b32 s50, s98, 5
  s_add_u32 s50, s50, s49
  s_lshl_b32 s50, s50, 10
  v_lshlrev_b32 v5, 4, v1
  v_add_u32 v5, s50, v5
  v_min_u32 v5, L_end-L_pc, v5
  global_load_dword v63, v5, s[94:95]
  s_nop 0
L_nopf:
  s_and_b32 s40, s48, 1
  s_lshl_b32 s40, s40, 3
  s_and_b32 s50, s49, 7
  s_add_u32 s40, s40, s50
  s_lshr_b32 s41, s48, 1
  s_lshl_b32 s41, s41, 2
  s_lshr_b32 s51, s49, 3
  s_add_u32 s41, s41, s51
  s_lshr_b32 s42, s41, 3
  s_and_b32 s43, s41, 7
  s_mul_i32 s50, s50, 9
  s_lshr_b32 s50, s50, 3
  s_mul_i32 s51, s51, 9
  s_lshr_b32 s51, s51, 2
  s_add_u32 s56, s50, s51
  s_sub_u32 s50, s56, 9
  s_cmp_ge_u32 s56, 9
  s_cselect_b32 s56, s50, s56
  s_lshl_b32 s56, s56, 1
  s_and_b32 s57, s49, 3
  s_lshl_b32 s50, s48, 2
  s_add_u32 s57, s57, s50
  s_lshr_b32 s58, s49, 2
  s_lshl_b32 s50, s98, 2
  s_lshr_b32 s44, 0x76543120, s50
  s_and_b32 s44, s44, 7
  s_and_b32 s45, s44, 3
  s_lshr_b32 s46, s44, 2
  s_and_b32 s99, s98, 1
  v_and_b32 v2, 15, v1
  v_lshrrev_b32 v3, 4, v1
  v_mov_b32 v15, 0
  v_mov_b32 v16, 0
  v_mov_b32 v21, 0
  v_mov_b32 v22, 0
  v_mov_b32 v152, 0x7fff0000
  v_mov_b32 v153, 0x7fff0000
  v_mov_b32 v232, 0
  v_mov_b32 v233, 0
  v_mov_b32 v234, 0
  v_mov_b32 v238, 0
  s_mul_i32 s97, s43, 144
  s_mov_b32 s6, 2359296
  s_mov_b32 s7, 0x00020000
  s_mov_b32 s10, 1990656
  s_mov_b32 s11, 0x00020000
  s_mov_b32 s34, 20736
  s_mov_b32 s35, 0x00020000
  s_mov_b32 s14, 0x10000000
  s_mov_b32 s15, 0x00020000
  s_mov_b32 s18, 663552
  s_mov_b32 s19, 0x00020000
  s_mov_b32 s22, 663552
  s_mov_b32 s23, 0x00020000
  s_mov_b32 s26, 2359296
  s_mov_b32 s27, 0x00020000
  s_mov_b32 s30, 256
  s_mov_b32 s31, 0x00020000
  s_mov_b32 s38, 1152
  s_mov_b32 s39, 0x00020000
  s_cmp_lt_u32 s98, 4
  s_cbranch_scc1 L_pc0
  s_and_b32 s91, s98, 3
  v_lshrrev_b32 v4, 3, v1
  v_and_b32 v6, 7, v1
  v_xor_b32 v6, v6, v3
  s_lshl_b32 s50, s40, 7
  s_lshl_b32 s51, s91, 5
  s_add_u32 s50, s50, s51
  v_add_u32 v4, s50, v4
  s_movk_i32 s51, 1152
  v_mul_lo_u32 v4, v4, s51
  v_lshl_add_u32 v16, v6, 4, v4
  v_xor_b32 v6, 4, v6
  v_lshl_add_u32 v15, v6, 4, v4
  v_add_u32 v15, 9216, v15
  s_lshl_b32 s52, s91, 12
  s_lshl_b32 s53, s91, 10
  s_add_u32 s53, s53, 49152
  s_mov_b32 s47, s56
  s_mov_b32 s3, s56
  v_lshrrev_b32 v7, 5, v1
  s_lshl_b32 s50, s91, 1
  v_add_u32 v7, s50, v7
  v_and_b32 v8, 1, v7
  v_lshl_add_u32 v8, v7, 1, v8
  v_and_b32 v9, 31, v1
  v_xor_b32 v8, v8, v9
  v_lshrrev_b32 v12, 4, v8
  v_and_b32 v13, 15, v8
  v_lshrrev_b32 v10, 2, v7
  v_lshlrev_b32 v10, 3, v10
  v_and_b32 v11, 3, v7
  v_add_u32 v10, v10, v11
  s_movk_i32 s51, 3456
  v_mul_u32_u24 v9, s51, v10
  v_lshl_add_u32 v9, v13, 4, v9
  v_add_u32 v9, s97, v9
  s_movk_i32 s51, 1152
  v_mad_u32_u24 v10, v12, s51, v9
  v_add_u32 v10, 1152, v10
  s_mov_b32 s51, 110592
  v_mad_u32_u24 v9, v12, s51, v9
  v_cmp_lt_u32 vcc, 8, v13
  v_mov_b32 v12, 2147418112
  s_nop 0
  v_cndmask_b32 v21, v10, v12, vcc
  v_cndmask_b32 v22, v9, v12, vcc
  s_cmp_eq_u32 s42, 1
  s_waitcnt lgkmcnt(0)
  s_mov_b32 s4, s64
  s_mov_b32 s5, s65
  s_cselect_b32 s8, s74, s66
  s_cselect_b32 s9, s75, s67
  s_cselect_b32 s32, s76, s68
  s_cselect_b32 s33, s77, s69
  s_mov_b32 s36, s80
  s_mov_b32 s37, s81
  s_lshl_b32 s50, s47, 6
  s_add_u32 s51, s50, 18432
  s_add_u32 m0, s52, 0
  s_nop 0
  buffer_load_dwordx4 v16, s[4:7], s50 offen lds
  s_add_u32 m0, s52, 1024
  s_nop 0
  buffer_load_dwordx4 v15, s[4:7], s50 offen lds
  s_add_u32 m0, s52, 2048
  s_nop 0
  buffer_load_dwordx4 v16, s[4:7], s51 offen lds
  s_add_u32 m0, s52, 3072
  s_nop 0
  buffer_load_dwordx4 v15, s[4:7], s51 offen lds
  s_add_u32 s47, s47, 2
  s_cmp_eq_u32 s47, 18
  s_cselect_b32 s47, 0, s47
  s_mul_i32 s51, s3, 110592
  s_add_u32 m0, s53, 16384
  s_nop 0
  buffer_load_dwordx4 v21, s[8:11], s51 offen lds
  s_add_u32 s50, s51, 55296
  s_add_u32 m0, s53, 20480
  s_nop 0
  buffer_load_dwordx4 v21, s[8:11], s50 offen lds
  s_add_u32 s50, s51, 13824
  s_add_u32 m0, s53, 24576
  s_nop 0
  buffer_load_dwordx4 v21, s[8:11], s50 offen lds
  s_add_u32 s50, s51, 69120
  s_add_u32 m0, s53, 28672
  s_nop 0
  buffer_load_dwordx4 v21, s[8:11], s50 offen lds
  s_add_u32 s3, s3, 1
  s_cmp_eq_u32 s3, 18
  s_cselect_b32 s3, 0, s3
  s_mul_i32 s51, s3, 110592
  s_add_u32 m0, s53, 32768
  s_nop 0
  buffer_load_dwordx4 v21, s[8:11], s51 offen lds
  s_add_u32 s50, s51, 55296
  s_add_u32 m0, s53, 36864
  s_nop 0
  buffer_load_dwordx4 v21, s[8:11], s50 offen lds
  s_add_u32 s50, s51, 13824
  s_add_u32 m0, s53, 40960
  s_nop 0
  buffer_load_dwordx4 v21, s[8:11], s50 offen lds
  s_add_u32 s50, s51, 69120
  s_add_u32 m0, s53, 45056
  s_nop 0
  buffer_load_dwordx4 v21, s[8:11], s50 offen lds
  s_add_u32 s3, s3, 1
  s_cmp_eq_u32 s3, 18
  s_cselect_b32 s3, 0, s3
  s_branch L_pc1
L_pc0:
  s_cmp_eq_u32 s42, 1
  s_waitcnt lgkmcnt(0)
  s_mov_b32 s4, s64
  s_mov_b32 s5, s65
  s_cselect_b32 s8, s74, s66
  s_cselect_b32 s9, s75, s67
  s_cselect_b32 s32, s76, s68
  s_cselect_b32 s33, s77, s69
  s_mov_b32 s36, s80
  s_mov_b32 s37, s81
  s_mov_b32 s12, s86
  s_mov_b32 s13, s87
  s_mov_b32 s16, s70
  s_mov_b32 s17, s71
  s_mov_b32 s20, s78
  s_mov_b32 s21, s79
  s_mov_b32 s24, s82
  s_mov_b32 s25, s83
  s_mov_b32 s28, s84
  s_mov_b32 s29, s85
  s_mul_i32 s50, s43, 2592
  v_lshlrev_b32 v4, 1, v0
  buffer_load_ushort v32, v4, s[32:35], s50 offen offset:0
  buffer_load_ushort v33, v4, s[32:35], s50 offen offset:512
  buffer_load_ushort v34, v4, s[32:35], s50 offen offset:1024
  buffer_load_ushort v35, v4, s[32:35], s50 offen offset:1536
  buffer_load_ushort v36, v4, s[32:35], s50 offen offset:2048
  buffer_load_ushort v37, v4, s[32:35], s50 offen offset:2560
  v_lshlrev_b32 v4, 3, v0
  buffer_load_dwordx2 v[38:39], v4, s[36:39], 0 offen
  s_lshr_b32 s48, s2, 7
  s_bfe_u32 s49, s2, 0x30004
  s_and_b32 s50, s2, 15
  s_mul_i32 s50, s50, 36
  s_mul_i32 s91, s49, 144
  s_mul_i32 s92, s49, 165888
  s_mul_i32 s51, s48, 4608
  s_add_u32 s92, s92, s51
  s_add_u32 s92, s92, 14680064
  v_add_u32 v4, 0, v0
  v_min_u32 v4, 323, v4
  s_mov_b32 s51, 0xE38F
  v_mul_u32_u24 v5, s51, v4
  v_lshrrev_b32 v5, 19, v5
  v_mul_u32_u24 v6, 9, v5
  v_sub_u32 v6, v4, v6
  v_add_u32 v5, s50, v5
  s_movk_i32 s51, 1152
  v_mul_u32_u24 v7, s51, v5
  v_lshl_add_u32 v7, v6, 4, v7
  s_cmp_eq_u32 s48, 1
  s_nop 0
  s_cbranch_scc1 L_cwB0
  buffer_load_dwordx4 v[144:147], v7, s[16:19], s91 offen
  s_branch L_cwD0
L_cwB0:
  buffer_load_dwordx4 v[144:147], v7, s[20:23], s91 offen
L_cwD0:
  v_lshrrev_b32 v8, 5, v5
  s_movk_i32 s51, 9216
  v_mul_u32_u24 v8, s51, v8
  v_bfe_u32 v9, v5, 2, 1
  s_movk_i32 s51, 2304
  v_mad_u32_u24 v8, v9, s51, v8
  v_bfe_u32 v9, v5, 3, 2
  v_and_b32 v10, 3, v5
  v_lshl_add_u32 v9, v9, 2, v10
  s_movk_i32 s51, 144
  v_mad_u32_u24 v8, v9, s51, v8
  v_lshl_add_u32 v8, v6, 4, v8
  v_add_u32 v152, s92, v8
  v_add_u32 v4, 256, v0
  v_min_u32 v4, 323, v4
  s_mov_b32 s51, 0xE38F
  v_mul_u32_u24 v5, s51, v4
  v_lshrrev_b32 v5, 19, v5
  v_mul_u32_u24 v6, 9, v5
  v_sub_u32 v6, v4, v6
  v_add_u32 v5, s50, v5
  s_movk_i32 s51, 1152
  v_mul_u32_u24 v7, s51, v5
  v_lshl_add_u32 v7, v6, 4, v7
  s_cmp_eq_u32 s48, 1
  s_nop 0
  s_cbranch_scc1 L_cwB1
  buffer_load_dwordx4 v[148:151], v7, s[16:19], s91 offen
  s_branch L_cwD1
L_cwB1:
  buffer_load_dwordx4 v[148:151], v7, s[20:23], s91 offen
L_cwD1:
  v_lshrrev_b32 v8, 5, v5
  s_movk_i32 s51, 9216
  v_mul_u32_u24 v8, s51, v8
  v_bfe_u32 v9, v5, 2, 1
  s_movk_i32 s51, 2304
  v_mad_u32_u24 v8, v9, s51, v8
  v_bfe_u32 v9, v5, 3, 2
  v_and_b32 v10, 3, v5
  v_lshl_add_u32 v9, v9, 2, v10
  s_movk_i32 s51, 144
  v_mad_u32_u24 v8, v9, s51, v8
  v_lshl_add_u32 v8, v6, 4, v8
  v_add_u32 v153, s92, v8
  v_add_u32 v9, 0, v0
  s_mov_b32 s51, 0xCA46
  v_mul_u32_u24 v10, s51, v9
  v_lshrrev_b32 v10, 24, v10
  s_movk_i32 s51, 324
  v_mul_u32_u24 v11, s51, v10
  v_sub_u32 v11, v9, v11
  s_mov_b32 s51, 0xE38F
  v_mul_u32_u24 v12, s51, v11
  v_lshrrev_b32 v12, 20, v12
  v_mul_u32_u24 v13, 18, v12
  v_sub_u32 v13, v11, v13
  v_mul_u32_u24 v14, 20, v10
  v_add_u32 v14, v14, v13
  v_mul_u32_u24 v14, 48, v14
  v_and_b32 v10, 1, v10
  v_lshl_add_u32 v12, v10, 1, v12
  v_lshl_add_u32 v14, v12, 1, v14
  v_add_u32 v40, 156672, v14
  v_add_u32 v9, 256, v0
  s_mov_b32 s51, 0xCA46
  v_mul_u32_u24 v10, s51, v9
  v_lshrrev_b32 v10, 24, v10
  s_movk_i32 s51, 324
  v_mul_u32_u24 v11, s51, v10
  v_sub_u32 v11, v9, v11
  s_mov_b32 s51, 0xE38F
  v_mul_u32_u24 v12, s51, v11
  v_lshrrev_b32 v12, 20, v12
  v_mul_u32_u24 v13, 18, v12
  v_sub_u32 v13, v11, v13
  v_mul_u32_u24 v14, 20, v10
  v_add_u32 v14, v14, v13
  v_mul_u32_u24 v14, 48, v14
  v_and_b32 v10, 1, v10
  v_lshl_add_u32 v12, v10, 1, v12
  v_lshl_add_u32 v14, v12, 1, v14
  v_add_u32 v41, 156672, v14
  v_add_u32 v9, 512, v0
  s_mov_b32 s51, 0xCA46
  v_mul_u32_u24 v10, s51, v9
  v_lshrrev_b32 v10, 24, v10
  s_movk_i32 s51, 324
  v_mul_u32_u24 v11, s51, v10
  v_sub_u32 v11, v9, v11
  s_mov_b32 s51, 0xE38F
  v_mul_u32_u24 v12, s51, v11
  v_lshrrev_b32 v12, 20, v12
  v_mul_u32_u24 v13, 18, v12
  v_sub_u32 v13, v11, v13
  v_mul_u32_u24 v14, 20, v10
  v_add_u32 v14, v14, v13
  v_mul_u32_u24 v14, 48, v14
  v_and_b32 v10, 1, v10
  v_lshl_add_u32 v12, v10, 1, v12
  v_lshl_add_u32 v14, v12, 1, v14
  v_add_u32 v42, 156672, v14
  v_add_u32 v9, 768, v0
  s_mov_b32 s51, 0xCA46
  v_mul_u32_u24 v10, s51, v9
  v_lshrrev_b32 v10, 24, v10
  s_movk_i32 s51, 324
  v_mul_u32_u24 v11, s51, v10
  v_sub_u32 v11, v9, v11
  s_mov_b32 s51, 0xE38F
  v_mul_u32_u24 v12, s51, v11
  v_lshrrev_b32 v12, 20, v12
  v_mul_u32_u24 v13, 18, v12
  v_sub_u32 v13, v11, v13
  v_mul_u32_u24 v14, 20, v10
  v_add_u32 v14, v14, v13
  v_mul_u32_u24 v14, 48, v14
  v_and_b32 v10, 1, v10
  v_lshl_add_u32 v12, v10, 1, v12
  v_lshl_add_u32 v14, v12, 1, v14
  v_add_u32 v43, 156672, v14
  v_add_u32 v9, 1024, v0
  s_mov_b32 s51, 0xCA46
  v_mul_u32_u24 v10, s51, v9
  v_lshrrev_b32 v10, 24, v10
  s_movk_i32 s51, 324
  v_mul_u32_u24 v11, s51, v10
  v_sub_u32 v11, v9, v11
  s_mov_b32 s51, 0xE38F
  v_mul_u32_u24 v12, s51, v11
  v_lshrrev_b32 v12, 20, v12
  v_mul_u32_u24 v13, 18, v12
  v_sub_u32 v13, v11, v13
  v_mul_u32_u24 v14, 20, v10
  v_add_u32 v14, v14, v13
  v_mul_u32_u24 v14, 48, v14
  v_and_b32 v10, 1, v10
  v_lshl_add_u32 v12, v10, 1, v12
  v_lshl_add_u32 v14, v12, 1, v14
  v_add_u32 v44, 156672, v14
  v_add_u32 v9, 1280, v0
  s_mov_b32 s51, 0xCA46
  v_mul_u32_u24 v10, s51, v9
  v_lshrrev_b32 v10, 24, v10
  s_movk_i32 s51, 324
  v_mul_u32_u24 v11, s51, v10
  v_sub_u32 v11, v9, v11
  s_mov_b32 s51, 0xE38F
  v_mul_u32_u24 v12, s51, v11
  v_lshrrev_b32 v12, 20, v12
  v_mul_u32_u24 v13, 18, v12
  v_sub_u32 v13, v11, v13
  v_mul_u32_u24 v14, 20, v10
  v_add_u32 v14, v14, v13
  v_mul_u32_u24 v14, 48, v14
  v_and_b32 v10, 1, v10
  v_lshl_add_u32 v12, v10, 1, v12
  v_lshl_add_u32 v14, v12, 1, v14
  v_add_u32 v45, 156672, v14
  v_mov_b32 v4, 0
  v_mov_b32 v5, 0
  v_mov_b32 v6, 0
  v_mov_b32 v7, 0
  v_lshlrev_b32 v8, 4, v0
  v_add_u32 v8, 156672, v8
  v_cmp_gt_u32 vcc, 240, v0
  s_nop 0
  s_and_saveexec_b64 s[94:95], vcc
  ds_write_b128 v8, v[4:7]
  v_cmp_gt_u32 vcc, 100, v0
  s_nop 0
  s_and_b64 exec, exec, vcc
  ds_write_b128 v8, v[4:7] offset:4992
  s_mov_b64 exec, -1
  v_mov_b32 v46, v0
  s_nop 1
L_pc1:
  s_mov_b32 s12, s86
  s_mov_b32 s13, s87
  s_mov_b32 s16, s70
  s_mov_b32 s17, s71
  s_mov_b32 s20, s78
  s_mov_b32 s21, s79
  s_mov_b32 s24, s82
  s_mov_b32 s25, s83
  s_mov_b32 s28, s84
  s_mov_b32 s29, s85
  s_waitcnt lgkmcnt(0)
  s_barrier
  s_lshl_b32 s50, s44, 6
  v_add_u32 v0, s50, v1
  s_or_b32 s50, s2, s98
  s_cmp_lg_u32 s50, 0
  s_cbranch_scc1 L_nononce
  s_memrealtime s[94:95]
  s_waitcnt lgkmcnt(0)
  s_or_b32 s94, s94, 1
  s_xor_b32 s95, s95, 0x5bd1e995
  v_mov_b32 v10, s94
  v_mov_b32 v11, s95
  v_mov_b32 v9, 0
  s_mov_b64 exec, 1
  buffer_store_dwordx2 v[10:11], v9, s[28:31], 0 offen sc1
  s_mov_b64 exec, -1
L_nononce:
  s_lshl_b32 s93, s40, 3
  s_lshl_b32 s50, s45, 1
  s_add_u32 s93, s93, s50
  s_add_u32 s93, s93, s46
  s_lshl_b32 s50, s42, 7
  s_add_u32 s50, s50, s93
  s_mul_i32 s50, s50, 18432
  s_add_u32 s50, s50, 4194304
  s_mul_i32 s51, s43, 9
  v_add_u32 v4, 0, v3
  v_add_u32 v5, s51, v4
  v_lshlrev_b32 v5, 8, v5
  v_lshl_add_u32 v5, v2, 4, v5
  v_add_u32 v28, s50, v5
  v_add_u32 v4, 4, v3
  v_add_u32 v5, s51, v4
  v_lshlrev_b32 v5, 8, v5
  v_lshl_add_u32 v5, v2, 4, v5
  v_add_u32 v29, s50, v5
  v_add_u32 v4, 8, v3
  v_add_u32 v5, s51, v4
  v_lshlrev_b32 v5, 8, v5
  v_lshl_add_u32 v5, v2, 4, v5
  v_add_u32 v30, s50, v5
  v_cmp_lt_u32 vcc, 0, v3
  v_mov_b32 v4, 2147418112
  s_nop 0
  v_cndmask_b32 v30, v30, v4, vcc
  s_lshl_b32 s96, s41, 4
  s_add_u32 s96, s96, s40
  s_lshl_b32 s96, s96, 14
  s_mul_i32 s50, s45, 36
  v_add_u32 v11, s50, v1
  v_min_u32 v11, 143, v11
  s_mov_b32 s51, 58255
  v_mul_u32_u24 v7, s51, v11
  v_lshrrev_b32 v7, 19, v7
  v_mul_u32_u24 v8, 9, v7
  v_sub_u32 v8, v11, v8
  v_bfe_u32 v9, v7, 2, 2
  v_lshlrev_b32 v9, 3, v9
  v_lshrrev_b32 v10, 4, v7
  v_lshl_add_u32 v9, v10, 2, v9
  v_and_b32 v10, 3, v7
  v_add_u32 v9, v9, v10
  s_movk_i32 s51, 3456
  v_mul_u32_u24 v12, s51, v9
  v_lshl_add_u32 v12, v8, 4, v12
  v_add_u32 v19, s97, v12
  s_movk_i32 s51, 1152
  v_mul_u32_u24 v12, s51, v9
  v_lshl_add_u32 v12, v8, 4, v12
  s_mul_i32 s51, s58, 144
  v_add_u32 v20, s51, v12
  s_mul_i32 s55, s45, 576
  s_lshl_b32 s54, s45, 10
  s_mul_i32 s66, s58, 165888
  s_add_u32 s66, s66, s54
  s_add_u32 s66, s66, 14680064
  s_mov_b32 s60, 0x3fb8aa3b
  s_mov_b32 s61, 0x3fb8aa3b
  s_mov_b32 s62, 0xbfb8aa3b
  s_mov_b32 s63, 0xbfb8aa3b
  s_mov_b32 s88, 0x00f0000f
  s_mov_b32 s89, 0xf0000f00
  v_lshlrev_b32 v250, 4, v1
  v_mul_u32_u24 v248, 20, v3
  v_and_b32 v5, 3, v2
  v_add_u32 v248, v248, v5
  v_mul_u32_u24 v248, 48, v248
  v_add_u32 v248, 156672, v248
  v_mov_b32 v5, 161664
  v_cndmask_b32 v248, v5, v248, s[88:89]
  v_mul_u32_u24 v249, 19, v3
  v_and_b32 v5, 3, v2
  v_add_u32 v249, v249, v5
  v_mul_u32_u24 v249, 80, v249
  v_add_u32 v249, 0, v249
  v_mov_b32 v5, 161664
  v_cndmask_b32 v249, v5, v249, s[88:89]
  v_add_u32 v252, s54, v250
  s_cmp_eq_u32 s46, 1
  s_nop 0
  s_cbranch_scc1 L_noKc
  s_and_b32 s91, s45, 1
  s_lshr_b32 s92, s45, 1
  v_bfe_u32 v4, v1, 2, 2
  v_lshl_add_u32 v4, v3, 2, v4
  s_movk_i32 s50, 320
  v_mul_u32_u24 v4, s50, v4
  v_bfe_u32 v5, v1, 1, 1
  v_mul_u32_u24 v5, 80, v5
  v_and_b32 v6, 1, v1
  v_lshl_add_u32 v5, v6, 3, v5
  s_mul_i32 s50, s91, 160
  s_lshl_b32 s51, s92, 4
  s_add_u32 s50, s50, s51
  v_add3_u32 v227, v4, v5, s50
  s_mul_i32 s50, s91, 3072
  s_add_u32 s50, s50, 135680
  v_add_u32 v228, s50, v250
  v_add_u32 v229, 137728, v250
  s_lshl_b32 s49, s91, 1
  v_lshrrev_b32 v11, 1, v3
  v_add_u32 v11, s49, v11
  v_and_b32 v13, 1, v3
  v_lshlrev_b32 v13, 3, v13
  s_lshl_b32 s49, s92, 4
  s_add_u32 s49, s49, 0
  v_add_u32 v13, s49, v13
  v_cmp_lt_u32 s[100:101], 7, v2
  s_mul_i32 s50, s91, 48
  s_mov_b32 s51, 0
  v_mov_b32 v8, s51
  v_cndmask_b32 v8, 0, v8, s[100:101]
  v_add3_u32 v8, v8, v2, s50
  v_mul_u32_u24 v9, 57, v8
  v_lshrrev_b32 v9, 10, v9
  v_mul_u32_u24 v10, 18, v9
  v_sub_u32 v10, v8, v10
  v_mul_u32_u24 v12, 19, v11
  v_add_u32 v12, v12, v10
  s_movk_i32 s50, 72
  v_mad_u32_u24 v12, v12, s50, v13
  v_cmp_eq_u32 vcc, v9, v11
  v_mov_b32 v14, 5504
  s_nop 0
  v_cndmask_b32 v224, v14, v12, vcc
  s_mul_i32 s50, s91, 24
  s_add_u32 s50, s50, 16
  s_lshl_b32 s51, s91, 4
  v_mov_b32 v8, s51
  v_cndmask_b32 v8, 0, v8, s[100:101]
  v_add3_u32 v8, v8, v2, s50
  v_mul_u32_u24 v9, 57, v8
  v_lshrrev_b32 v9, 10, v9
  v_mul_u32_u24 v10, 18, v9
  v_sub_u32 v10, v8, v10
  v_mul_u32_u24 v12, 19, v11
  v_add_u32 v12, v12, v10
  s_movk_i32 s50, 72
  v_mad_u32_u24 v12, v12, s50, v13
  v_cmp_eq_u32 vcc, v9, v11
  v_mov_b32 v14, 5504
  s_nop 0
  v_cndmask_b32 v225, v14, v12, vcc
  s_mov_b32 s50, 32
  s_movk_i32 s51, 200
  v_mov_b32 v8, s51
  v_cndmask_b32 v8, 0, v8, s[100:101]
  v_add3_u32 v8, v8, v2, s50
  v_mul_u32_u24 v9, 57, v8
  v_lshrrev_b32 v9, 10, v9
  v_mul_u32_u24 v10, 18, v9
  v_sub_u32 v10, v8, v10
  v_cmp_eq_u32 vcc, 240, v8
  s_nop 1
  v_cndmask_b32 v9, v9, v11, vcc
  v_cndmask_b32 v10, v10, 18, vcc
  v_mul_u32_u24 v12, 19, v11
  v_add_u32 v12, v12, v10
  s_movk_i32 s50, 72
  v_mad_u32_u24 v12, v12, s50, v13
  v_cmp_eq_u32 vcc, v9, v11
  v_mov_b32 v14, 5504
  s_nop 0
  v_cndmask_b32 v226, v14, v12, vcc
  v_lshlrev_b32 v238, 3, v1
  v_add_u32 v7, 0, v0
  v_lshlrev_b32 v232, 4, v7
  v_lshl_add_u32 v4, v7, 1, 0
  s_mov_b32 s51, 0xE38F
  v_mul_u32_u24 v5, s51, v4
  v_lshrrev_b32 v5, 19, v5
  v_mul_u32_u24 v6, 9, v5
  v_sub_u32 v6, v4, v6
  v_mul_u32_u24 v240, 80, v5
  v_lshl_add_u32 v240, v6, 3, v240
  v_add_u32 v240, 0, v240
  v_lshl_add_u32 v4, v7, 1, 1
  s_mov_b32 s51, 0xE38F
  v_mul_u32_u24 v5, s51, v4
  v_lshrrev_b32 v5, 19, v5
  v_mul_u32_u24 v6, 9, v5
  v_sub_u32 v6, v4, v6
  v_mul_u32_u24 v241, 80, v5
  v_lshl_add_u32 v241, v6, 3, v241
  v_add_u32 v241, 0, v241
  v_add_u32 v7, 256, v0
  v_lshlrev_b32 v233, 4, v7
  v_lshl_add_u32 v4, v7, 1, 0
  s_mov_b32 s51, 0xE38F
  v_mul_u32_u24 v5, s51, v4
  v_lshrrev_b32 v5, 19, v5
  v_mul_u32_u24 v6, 9, v5
  v_sub_u32 v6, v4, v6
  v_mul_u32_u24 v242, 80, v5
  v_lshl_add_u32 v242, v6, 3, v242
  v_add_u32 v242, 0, v242
  v_lshl_add_u32 v4, v7, 1, 1
  s_mov_b32 s51, 0xE38F
  v_mul_u32_u24 v5, s51, v4
  v_lshrrev_b32 v5, 19, v5
  v_mul_u32_u24 v6, 9, v5
  v_sub_u32 v6, v4, v6
  v_mul_u32_u24 v243, 80, v5
  v_lshl_add_u32 v243, v6, 3, v243
  v_add_u32 v243, 0, v243
  v_cmp_gt_u32 vcc, 86, v0
  v_mov_b32 v4, 2147418112
  s_nop 0
  v_cndmask_b32 v233, v4, v233, vcc
  s_mul_i32 s50, s45, 10240
  s_movk_i32 s51, 320
  v_mul_u32_u24 v4, s51, v2
  v_mul_u32_u24 v5, 80, v3
  v_add3_u32 v251, v4, v5, s50
  s_nop 1
L_noKc:
  s_cmp_ge_u32 s98, 4
  s_cbranch_scc1 L_loader
  s_cmp_ge_u32 s98, 2
  s_cbranch_scc1 L_vcomp
  v_lshrrev_b32 v4, 1, v2
  v_xor_b32 v4, v4, v3
  v_lshlrev_b32 v4, 4, v4
  v_lshl_add_u32 v4, v2, 7, v4
  s_lshl_b32 s50, s99, 13
  v_add_u32 v26, s50, v4
  v_xor_b32 v27, 64, v26
  v_bfe_u32 v4, v1, 2, 2
  v_lshl_add_u32 v5, v3, 2, v4
  v_and_b32 v6, 3, v1
  v_and_b32 v7, 1, v4
  v_lshlrev_b32 v7, 1, v7
  v_and_b32 v8, 7, v5
  v_lshl_add_u32 v7, v8, 2, v7
  v_lshlrev_b32 v8, 9, v5
  v_add_u32 v8, 49152, v8
  v_lshlrev_b32 v6, 3, v6
  s_mov_b32 s51, 218694656
  v_lshrrev_b32 v4, v6, s51
  v_and_b32 v4, 0xff, v4
  v_xor_b32 v4, v4, v7
  v_lshl_add_u32 v21, v4, 3, v8
  s_mov_b32 s51, 235537665
  v_lshrrev_b32 v4, v6, s51
  v_and_b32 v4, 0xff, v4
  v_xor_b32 v4, v4, v7
  v_lshl_add_u32 v22, v4, 3, v8
  s_mov_b32 s51, 252380674
  v_lshrrev_b32 v4, v6, s51
  v_and_b32 v4, 0xff, v4
  v_xor_b32 v4, v4, v7
  v_lshl_add_u32 v23, v4, 3, v8
  s_mov_b32 s51, 269223683
  v_lshrrev_b32 v4, v6, s51
  v_and_b32 v4, 0xff, v4
  v_xor_b32 v4, v4, v7
  v_lshl_add_u32 v24, v4, 3, v8
  s_mov_b32 s51, 286066692
  v_lshrrev_b32 v4, v6, s51
  v_and_b32 v4, 0xff, v4
  v_xor_b32 v4, v4, v7
  v_lshl_add_u32 v25, v4, 3, v8
  s_waitcnt vmcnt(2)
  ds_write_b16 v40, v32
  ds_write_b16 v41, v33
  ds_write_b16 v42, v34
  ds_write_b16 v43, v35
  ds_write_b16 v44, v36
  v_cmp_gt_u32 vcc, 16, v46
  s_nop 0
  s_and_saveexec_b64 s[94:95], vcc
  ds_write_b16 v45, v37
  s_mov_b64 exec, -1
  v_lshlrev_b32 v9, 3, v46
  v_add_u32 v9, 160512, v9
  v_cmp_gt_u32 vcc, 144, v46
  s_nop 0
  s_and_saveexec_b64 s[94:95], vcc
  ds_write_b64 v9, v[38:39]
  s_mov_b64 exec, -1
  s_waitcnt lgkmcnt(0)
  s_barrier
  ds_read_b128 v[32:35], v26 offset:0
  ds_read_b128 v[36:39], v26 offset:2048
  ds_read_b128 v[40:43], v26 offset:4096
  ds_read_b128 v[44:47], v26 offset:6144
  ds_read_b64_tr_b16 v[204:205], v21 offset:16384
  ds_read_b64_tr_b16 v[206:207], v21 offset:24576
  ds_read_b64_tr_b16 v[208:209], v22 offset:16384
  ds_read_b64_tr_b16 v[210:211], v22 offset:24576
  ds_read_b64_tr_b16 v[212:213], v23 offset:16384
  ds_read_b64_tr_b16 v[214:215], v23 offset:24576
  ds_read_b64_tr_b16 v[216:217], v24 offset:16384
  ds_read_b64_tr_b16 v[218:219], v24 offset:24576
  s_waitcnt lgkmcnt(6)
  v_mfma_f32_16x16x32_bf16 v[64:67], v[204:207], v[32:35], 0
  ds_read_b64_tr_b16 v[220:221], v25 offset:16384
  v_mfma_f32_16x16x32_bf16 v[68:71], v[204:207], v[36:39], 0
  ds_read_b64_tr_b16 v[222:223], v25 offset:24576
  v_mfma_f32_16x16x32_bf16 v[72:75], v[204:207], v[40:43], 0
  v_mfma_f32_16x16x32_bf16 v[76:79], v[204:207], v[44:47], 0
  s_waitcnt lgkmcnt(6)
  s_barrier
  v_mfma_f32_16x16x32_bf16 v[80:83], v[208:211], v[32:35], 0
  ds_read_b128 v[48:51], v27 offset:0
  v_mfma_f32_16x16x32_bf16 v[84:87], v[208:211], v[36:39], 0
  ds_read_b128 v[52:55], v27 offset:2048
  v_mfma_f32_16x16x32_bf16 v[88:91], v[208:211], v[40:43], 0
  ds_read_b64_tr_b16 v[204:205], v21 offset:32768
  v_mfma_f32_16x16x32_bf16 v[92:95], v[208:211], v[44:47], 0
  ds_read_b64_tr_b16 v[206:207], v21 offset:40960
  s_waitcnt lgkmcnt(8)
  v_mfma_f32_16x16x32_bf16 v[96:99], v[212:215], v[32:35], 0
  ds_read_b128 v[56:59], v27 offset:4096
  v_mfma_f32_16x16x32_bf16 v[100:103], v[212:215], v[36:39], 0
  ds_read_b128 v[60:63], v27 offset:6144
  v_mfma_f32_16x16x32_bf16 v[104:107], v[212:215], v[40:43], 0
  ds_read_b64_tr_b16 v[208:209], v22 offset:32768
  v_mfma_f32_16x16x32_bf16 v[108:111], v[212:215], v[44:47], 0
  ds_read_b64_tr_b16 v[210:211], v22 offset:40960
  s_waitcnt lgkmcnt(10)
  v_mfma_f32_16x16x32_bf16 v[112:115], v[216:219], v[32:35], 0
  ds_read_b64_tr_b16 v[212:213], v23 offset:32768
  v_mfma_f32_16x16x32_bf16 v[116:119], v[216:219], v[36:39], 0
  ds_read_b64_tr_b16 v[214:215], v23 offset:40960
  v_mfma_f32_16x16x32_bf16 v[120:123], v[216:219], v[40:43], 0
  v_mfma_f32_16x16x32_bf16 v[124:127], v[216:219], v[44:47], 0
  s_waitcnt lgkmcnt(10)
  v_mfma_f32_16x16x32_bf16 v[128:131], v[220:223], v[32:35], 0
  ds_read_b64_tr_b16 v[216:217], v24 offset:32768
  v_mfma_f32_16x16x32_bf16 v[132:135], v[220:223], v[36:39], 0
  ds_read_b64_tr_b16 v[218:219], v24 offset:40960
  v_mfma_f32_16x16x32_bf16 v[136:139], v[220:223], v[40:43], 0
  v_mfma_f32_16x16x32_bf16 v[140:143], v[220:223], v[44:47], 0
  s_waitcnt lgkmcnt(6)
  v_mfma_f32_16x16x32_bf16 v[64:67], v[204:207], v[48:51], v[64:67]
  ds_read_b64_tr_b16 v[220:221], v25 offset:32768
  v_mfma_f32_16x16x32_bf16 v[68:71], v[204:207], v[52:55], v[68:71]
  ds_read_b64_tr_b16 v[222:223], v25 offset:40960
  v_mfma_f32_16x16x32_bf16 v[72:75], v[204:207], v[56:59], v[72:75]
  v_mfma_f32_16x16x32_bf16 v[76:79], v[204:207], v[60:63], v[76:79]
  s_waitcnt lgkmcnt(6)
  s_barrier
  v_mfma_f32_16x16x32_bf16 v[80:83], v[208:211], v[48:51], v[80:83]
  ds_read_b128 v[32:35], v26 offset:16384
  v_mfma_f32_16x16x32_bf16 v[84:87], v[208:211], v[52:55], v[84:87]
  ds_read_b128 v[36:39], v26 offset:18432
  v_mfma_f32_16x16x32_bf16 v[88:91], v[208:211], v[56:59], v[88:91]
  v_add_u32 v21, 49152, v21
  v_mfma_f32_16x16x32_bf16 v[92:95], v[208:211], v[60:63], v[92:95]
  v_add_u32 v22, 49152, v22
  s_waitcnt lgkmcnt(6)
  v_mfma_f32_16x16x32_bf16 v[96:99], v[212:215], v[48:51], v[96:99]
  v_add_u32 v23, 49152, v23
  v_mfma_f32_16x16x32_bf16 v[100:103], v[212:215], v[52:55], v[100:103]
  v_add_u32 v24, 49152, v24
  v_mfma_f32_16x16x32_bf16 v[104:107], v[212:215], v[56:59], v[104:107]
  v_add_u32 v25, 49152, v25
  v_mfma_f32_16x16x32_bf16 v[108:111], v[212:215], v[60:63], v[108:111]
  ds_read_b64_tr_b16 v[204:205], v21 offset:0
  s_waitcnt lgkmcnt(5)
  s_waitcnt vmcnt(0)
  buffer_store_dwordx4 v[144:147], v152, s[12:15], 0 offen sc1
  buffer_store_dwordx4 v[148:151], v153, s[12:15], 0 offen sc1
  v_mov_b32 v9, 0
  buffer_load_dwordx2 v[12:13], v9, s[28:31], 0 offen sc1
  v_mfma_f32_16x16x32_bf16 v[112:115], v[216:219], v[48:51], v[112:115]
  ds_read_b64_tr_b16 v[206:207], v21 offset:8192
  v_mfma_f32_16x16x32_bf16 v[116:119], v[216:219], v[52:55], v[116:119]
  ds_read_b128 v[40:43], v26 offset:20480
  v_mfma_f32_16x16x32_bf16 v[120:123], v[216:219], v[56:59], v[120:123]
  ds_read_b128 v[44:47], v26 offset:22528
  v_mfma_f32_16x16x32_bf16 v[124:127], v[216:219], v[60:63], v[124:127]
  ds_read_b64_tr_b16 v[208:209], v22 offset:0
  s_waitcnt lgkmcnt(7)
  v_mfma_f32_16x16x32_bf16 v[128:131], v[220:223], v[48:51], v[128:131]
  ds_read_b64_tr_b16 v[210:211], v22 offset:8192
  v_mfma_f32_16x16x32_bf16 v[132:135], v[220:223], v[52:55], v[132:135]
  ds_read_b64_tr_b16 v[212:213], v23 offset:0
  v_mfma_f32_16x16x32_bf16 v[136:139], v[220:223], v[56:59], v[136:139]
  ds_read_b64_tr_b16 v[214:215], v23 offset:8192
  v_mfma_f32_16x16x32_bf16 v[140:143], v[220:223], v[60:63], v[140:143]
  ds_read_b64_tr_b16 v[216:217], v24 offset:0
  s_waitcnt lgkmcnt(5)
  v_mfma_f32_16x16x32_bf16 v[64:67], v[204:207], v[32:35], v[64:67]
  ds_read_b64_tr_b16 v[218:219], v24 offset:8192
  v_mfma_f32_16x16x32_bf16 v[68:71], v[204:207], v[36:39], v[68:71]
  ds_read_b64_tr_b16 v[220:221], v25 offset:0
  v_mfma_f32_16x16x32_bf16 v[72:75], v[204:207], v[40:43], v[72:75]
  ds_read_b64_tr_b16 v[222:223], v25 offset:8192
  v_mfma_f32_16x16x32_bf16 v[76:79], v[204:207], v[44:47], v[76:79]
  s_waitcnt lgkmcnt(6)
  s_barrier
  v_mfma_f32_16x16x32_bf16 v[80:83], v[208:211], v[32:35], v[80:83]
  ds_read_b128 v[48:51], v27 offset:16384
  v_mfma_f32_16x16x32_bf16 v[84:87], v[208:211], v[36:39], v[84:87]
  ds_read_b128 v[52:55], v27 offset:18432
  v_mfma_f32_16x16x32_bf16 v[88:91], v[208:211], v[40:43], v[88:91]
  ds_read_b64_tr_b16 v[204:205], v21 offset:16384
  v_mfma_f32_16x16x32_bf16 v[92:95], v[208:211], v[44:47], v[92:95]
  ds_read_b64_tr_b16 v[206:207], v21 offset:24576
  s_waitcnt lgkmcnt(8)
  v_mfma_f32_16x16x32_bf16 v[96:99], v[212:215], v[32:35], v[96:99]
  ds_read_b128 v[56:59], v27 offset:20480
  v_mfma_f32_16x16x32_bf16 v[100:103], v[212:215], v[36:39], v[100:103]
  ds_read_b128 v[60:63], v27 offset:22528
  v_mfma_f32_16x16x32_bf16 v[104:107], v[212:215], v[40:43], v[104:107]
  ds_read_b64_tr_b16 v[208:209], v22 offset:16384
  v_mfma_f32_16x16x32_bf16 v[108:111], v[212:215], v[44:47], v[108:111]
  ds_read_b64_tr_b16 v[210:211], v22 offset:24576
  s_waitcnt lgkmcnt(10)
  v_mfma_f32_16x16x32_bf16 v[112:115], v[216:219], v[32:35], v[112:115]
  ds_read_b64_tr_b16 v[212:213], v23 offset:16384
  v_mfma_f32_16x16x32_bf16 v[116:119], v[216:219], v[36:39], v[116:119]
  ds_read_b64_tr_b16 v[214:215], v23 offset:24576
  v_mfma_f32_16x16x32_bf16 v[120:123], v[216:219], v[40:43], v[120:123]
  v_mfma_f32_16x16x32_bf16 v[124:127], v[216:219], v[44:47], v[124:127]
  s_waitcnt lgkmcnt(10)
  v_mfma_f32_16x16x32_bf16 v[128:131], v[220:223], v[32:35], v[128:131]
  ds_read_b64_tr_b16 v[216:217], v24 offset:16384
  v_mfma_f32_16x16x32_bf16 v[132:135], v[220:223], v[36:39], v[132:135]
  ds_read_b64_tr_b16 v[218:219], v24 offset:24576
  v_mfma_f32_16x16x32_bf16 v[136:139], v[220:223], v[40:43], v[136:139]
  v_mfma_f32_16x16x32_bf16 v[140:143], v[220:223], v[44:47], v[140:143]
  s_waitcnt lgkmcnt(6)
  v_mfma_f32_16x16x32_bf16 v[64:67], v[204:207], v[48:51], v[64:67]
  ds_read_b64_tr_b16 v[220:221], v25 offset:16384
  v_mfma_f32_16x16x32_bf16 v[68:71], v[204:207], v[52:55], v[68:71]
  ds_read_b64_tr_b16 v[222:223], v25 offset:24576
  v_mfma_f32_16x16x32_bf16 v[72:75], v[204:207], v[56:59], v[72:75]
  v_mfma_f32_16x16x32_bf16 v[76:79], v[204:207], v[60:63], v[76:79]
  s_waitcnt lgkmcnt(6)
  s_barrier
  v_mfma_f32_16x16x32_bf16 v[80:83], v[208:211], v[48:51], v[80:83]
  ds_read_b128 v[32:35], v26 offset:32768
  v_mfma_f32_16x16x32_bf16 v[84:87], v[208:211], v[52:55], v[84:87]
  ds_read_b128 v[36:39], v26 offset:34816
  v_mfma_f32_16x16x32_bf16 v[88:91], v[208:211], v[56:59], v[88:91]
  ds_read_b64_tr_b16 v[204:205], v21 offset:32768
  v_mfma_f32_16x16x32_bf16 v[92:95], v[208:211], v[60:63], v[92:95]
  ds_read_b64_tr_b16 v[206:207], v21 offset:40960
  s_waitcnt lgkmcnt(8)
  v_mfma_f32_16x16x32_bf16 v[96:99], v[212:215], v[48:51], v[96:99]
  ds_read_b128 v[40:43], v26 offset:36864
  v_mfma_f32_16x16x32_bf16 v[100:103], v[212:215], v[52:55], v[100:103]
  ds_read_b128 v[44:47], v26 offset:38912
  v_mfma_f32_16x16x32_bf16 v[104:107], v[212:215], v[56:59], v[104:107]
  ds_read_b64_tr_b16 v[208:209], v22 offset:32768
  v_mfma_f32_16x16x32_bf16 v[108:111], v[212:215], v[60:63], v[108:111]
  ds_read_b64_tr_b16 v[210:211], v22 offset:40960
  s_waitcnt lgkmcnt(10)
  v_mfma_f32_16x16x32_bf16 v[112:115], v[216:219], v[48:51], v[112:115]
  ds_read_b64_tr_b16 v[212:213], v23 offset:32768
  v_mfma_f32_16x16x32_bf16 v[116:119], v[216:219], v[52:55], v[116:119]
  ds_read_b64_tr_b16 v[214:215], v23 offset:40960
  v_mfma_f32_16x16x32_bf16 v[120:123], v[216:219], v[56:59], v[120:123]
  v_mfma_f32_16x16x32_bf16 v[124:127], v[216:219], v[60:63], v[124:127]
  s_waitcnt lgkmcnt(10)
  v_mfma_f32_16x16x32_bf16 v[128:131], v[220:223], v[48:51], v[128:131]
  ds_read_b64_tr_b16 v[216:217], v24 offset:32768
  v_mfma_f32_16x16x32_bf16 v[132:135], v[220:223], v[52:55], v[132:135]
  ds_read_b64_tr_b16 v[218:219], v24 offset:40960
  v_mfma_f32_16x16x32_bf16 v[136:139], v[220:223], v[56:59], v[136:139]
  v_mfma_f32_16x16x32_bf16 v[140:143], v[220:223], v[60:63], v[140:143]
  s_waitcnt lgkmcnt(6)
  v_mfma_f32_16x16x32_bf16 v[64:67], v[204:207], v[32:35], v[64:67]
  ds_read_b64_tr_b16 v[220:221], v25 offset:32768
  v_mfma_f32_16x16x32_bf16 v[68:71], v[204:207], v[36:39], v[68:71]
  ds_read_b64_tr_b16 v[222:223], v25 offset:40960
  v_mfma_f32_16x16x32_bf16 v[72:75], v[204:207], v[40:43], v[72:75]
  ds_read_b128 v[144:147], v248 offset:0
  v_mfma_f32_16x16x32_bf16 v[76:79], v[204:207], v[44:47], v[76:79]
  s_waitcnt lgkmcnt(7)
  s_barrier
  v_mfma_f32_16x16x32_bf16 v[80:83], v[208:211], v[32:35], v[80:83]
  ds_read_b128 v[48:51], v27 offset:32768
  v_mfma_f32_16x16x32_bf16 v[84:87], v[208:211], v[36:39], v[84:87]
  ds_read_b128 v[52:55], v27 offset:34816
  v_mfma_f32_16x16x32_bf16 v[88:91], v[208:211], v[40:43], v[88:91]
  v_subrev_u32 v21, 49152, v21
  v_mfma_f32_16x16x32_bf16 v[92:95], v[208:211], v[44:47], v[92:95]
  v_subrev_u32 v22, 49152, v22
  s_waitcnt lgkmcnt(7)
  v_mfma_f32_16x16x32_bf16 v[96:99], v[212:215], v[32:35], v[96:99]
  v_subrev_u32 v23, 49152, v23
  v_mfma_f32_16x16x32_bf16 v[100:103], v[212:215], v[36:39], v[100:103]
  v_subrev_u32 v24, 49152, v24
  v_mfma_f32_16x16x32_bf16 v[104:107], v[212:215], v[40:43], v[104:107]
  v_subrev_u32 v25, 49152, v25
  v_mfma_f32_16x16x32_bf16 v[108:111], v[212:215], v[44:47], v[108:111]
  ds_read_b64_tr_b16 v[204:205], v21 offset:0
  s_waitcnt lgkmcnt(6)
  v_mfma_f32_16x16x32_bf16 v[112:115], v[216:219], v[32:35], v[112:115]
  ds_read_b64_tr_b16 v[206:207], v21 offset:8192
  v_mfma_f32_16x16x32_bf16 v[116:119], v[216:219], v[36:39], v[116:119]
  ds_read_b128 v[148:151], v248 offset:16
  v_mfma_f32_16x16x32_bf16 v[120:123], v[216:219], v[40:43], v[120:123]
  ds_read_b128 v[56:59], v27 offset:36864
  v_mfma_f32_16x16x32_bf16 v[124:127], v[216:219], v[44:47], v[124:127]
  ds_read_b128 v[60:63], v27 offset:38912
  s_waitcnt lgkmcnt(8)
  v_mfma_f32_16x16x32_bf16 v[128:131], v[220:223], v[32:35], v[128:131]
  ds_read_b64_tr_b16 v[208:209], v22 offset:0
  v_mfma_f32_16x16x32_bf16 v[132:135], v[220:223], v[36:39], v[132:135]
  ds_read_b64_tr_b16 v[210:211], v22 offset:8192
  v_mfma_f32_16x16x32_bf16 v[136:139], v[220:223], v[40:43], v[136:139]
  ds_read_b128 v[152:155], v248 offset:32
  v_mfma_f32_16x16x32_bf16 v[140:143], v[220:223], v[44:47], v[140:143]
  ds_read_b64_tr_b16 v[212:213], v23 offset:0
  s_waitcnt lgkmcnt(4)
  v_mfma_f32_16x16x32_bf16 v[64:67], v[204:207], v[48:51], v[64:67]
  ds_read_b64_tr_b16 v[214:215], v23 offset:8192
  v_mfma_f32_16x16x32_bf16 v[68:71], v[204:207], v[52:55], v[68:71]
  ds_read_b128 v[156:159], v248 offset:192
  v_mfma_f32_16x16x32_bf16 v[72:75], v[204:207], v[56:59], v[72:75]
  ds_read_b64_tr_b16 v[216:217], v24 offset:0
  v_mfma_f32_16x16x32_bf16 v[76:79], v[204:207], v[60:63], v[76:79]
  ds_read_b64_tr_b16 v[218:219], v24 offset:8192
  s_waitcnt lgkmcnt(6)
  ds_read_b128 v[160:163], v248 offset:208
  ds_read_b64_tr_b16 v[220:221], v25 offset:0
  ds_read_b64_tr_b16 v[222:223], v25 offset:8192
  ds_read_b128 v[164:167], v248 offset:224
  s_barrier
  v_mfma_f32_16x16x32_bf16 v[80:83], v[208:211], v[48:51], v[80:83]
  ds_read_b128 v[32:35], v26 offset:0
  v_mfma_f32_16x16x32_bf16 v[84:87], v[208:211], v[52:55], v[84:87]
  ds_read_b128 v[36:39], v26 offset:2048
  v_mfma_f32_16x16x32_bf16 v[88:91], v[208:211], v[56:59], v[88:91]
  ds_read_b64_tr_b16 v[204:205], v21 offset:16384
  v_mfma_f32_16x16x32_bf16 v[92:95], v[208:211], v[60:63], v[92:95]
  ds_read_b64_tr_b16 v[206:207], v21 offset:24576
  s_waitcnt lgkmcnt(11)
  v_mfma_f32_16x16x32_bf16 v[96:99], v[212:215], v[48:51], v[96:99]
  ds_read_b128 v[168:171], v248 offset:384
  v_mfma_f32_16x16x32_bf16 v[100:103], v[212:215], v[52:55], v[100:103]
  ds_read_b128 v[40:43], v26 offset:4096
  v_mfma_f32_16x16x32_bf16 v[104:107], v[212:215], v[56:59], v[104:107]
  ds_read_b128 v[44:47], v26 offset:6144
  v_mfma_f32_16x16x32_bf16 v[108:111], v[212:215], v[60:63], v[108:111]
  ds_read_b64_tr_b16 v[208:209], v22 offset:16384
  s_waitcnt lgkmcnt(12)
  v_mfma_f32_16x16x32_bf16 v[112:115], v[216:219], v[48:51], v[112:115]
  ds_read_b64_tr_b16 v[210:211], v22 offset:24576
  v_mfma_f32_16x16x32_bf16 v[116:119], v[216:219], v[52:55], v[116:119]
  ds_read_b128 v[172:175], v248 offset:400
  v_mfma_f32_16x16x32_bf16 v[120:123], v[216:219], v[56:59], v[120:123]
  ds_read_b64_tr_b16 v[212:213], v23 offset:16384
  v_mfma_f32_16x16x32_bf16 v[124:127], v[216:219], v[60:63], v[124:127]
  ds_read_b64_tr_b16 v[214:215], v23 offset:24576
  s_waitcnt lgkmcnt(13)
  v_mfma_f32_16x16x32_bf16 v[128:131], v[220:223], v[48:51], v[128:131]
  ds_read_b128 v[176:179], v248 offset:416
  v_mfma_f32_16x16x32_bf16 v[132:135], v[220:223], v[52:55], v[132:135]
  ds_read_b64_tr_b16 v[216:217], v24 offset:16384
  v_mfma_f32_16x16x32_bf16 v[136:139], v[220:223], v[56:59], v[136:139]
  ds_read_b64_tr_b16 v[218:219], v24 offset:24576
  v_mfma_f32_16x16x32_bf16 v[140:143], v[220:223], v[60:63], v[140:143]
  ds_read_b128 v[180:183], v248 offset:576
  s_waitcnt lgkmcnt(9)
  v_mfma_f32_16x16x32_bf16 v[64:67], v[204:207], v[32:35], v[64:67]
  ds_read_b64_tr_b16 v[220:221], v25 offset:16384
  v_mfma_f32_16x16x32_bf16 v[68:71], v[204:207], v[36:39], v[68:71]
  ds_read_b64_tr_b16 v[222:223], v25 offset:24576
  v_mfma_f32_16x16x32_bf16 v[72:75], v[204:207], v[40:43], v[72:75]
  ds_read_b128 v[184:187], v248 offset:592
  v_mfma_f32_16x16x32_bf16 v[76:79], v[204:207], v[44:47], v[76:79]
  s_waitcnt lgkmcnt(10)
  s_barrier
  v_mfma_f32_16x16x32_bf16 v[80:83], v[208:211], v[32:35], v[80:83]
  ds_read_b128 v[48:51], v27 offset:0
  v_mfma_f32_16x16x32_bf16 v[84:87], v[208:211], v[36:39], v[84:87]
  ds_read_b128 v[52:55], v27 offset:2048
  v_mfma_f32_16x16x32_bf16 v[88:91], v[208:211], v[40:43], v[88:91]
  ds_read_b64_tr_b16 v[204:205], v21 offset:32768
  v_mfma_f32_16x16x32_bf16 v[92:95], v[208:211], v[44:47], v[92:95]
  ds_read_b64_tr_b16 v[206:207], v21 offset:40960
  s_waitcnt lgkmcnt(11)
  v_mfma_f32_16x16x32_bf16 v[96:99], v[212:215], v[32:35], v[96:99]
  ds_read_b128 v[188:191], v248 offset:608
  v_mfma_f32_16x16x32_bf16 v[100:103], v[212:215], v[36:39], v[100:103]
  ds_read_b128 v[56:59], v27 offset:4096
  v_mfma_f32_16x16x32_bf16 v[104:107], v[212:215], v[40:43], v[104:107]
  ds_read_b128 v[60:63], v27 offset:6144
  v_mfma_f32_16x16x32_bf16 v[108:111], v[212:215], v[44:47], v[108:111]
  ds_read_b64_tr_b16 v[208:209], v22 offset:32768
  s_waitcnt lgkmcnt(12)
  v_mfma_f32_16x16x32_bf16 v[112:115], v[216:219], v[32:35], v[112:115]
  ds_read_b64_tr_b16 v[210:211], v22 offset:40960
  v_mfma_f32_16x16x32_bf16 v[116:119], v[216:219], v[36:39], v[116:119]
  ds_read_b128 v[192:195], v248 offset:768
  v_mfma_f32_16x16x32_bf16 v[120:123], v[216:219], v[40:43], v[120:123]
  ds_read_b64_tr_b16 v[212:213], v23 offset:32768
  v_mfma_f32_16x16x32_bf16 v[124:127], v[216:219], v[44:47], v[124:127]
  ds_read_b64_tr_b16 v[214:215], v23 offset:40960
  s_waitcnt lgkmcnt(13)
  v_mfma_f32_16x16x32_bf16 v[128:131], v[220:223], v[32:35], v[128:131]
  ds_read_b128 v[196:199], v248 offset:784
  v_mfma_f32_16x16x32_bf16 v[132:135], v[220:223], v[36:39], v[132:135]
  ds_read_b64_tr_b16 v[216:217], v24 offset:32768
  v_mfma_f32_16x16x32_bf16 v[136:139], v[220:223], v[40:43], v[136:139]
  ds_read_b64_tr_b16 v[218:219], v24 offset:40960
  v_mfma_f32_16x16x32_bf16 v[140:143], v[220:223], v[44:47], v[140:143]
  ds_read_b128 v[200:203], v248 offset:800
  s_waitcnt lgkmcnt(9)
  v_mfma_f32_16x16x32_bf16 v[64:67], v[204:207], v[48:51], v[64:67]
  ds_read_b64_tr_b16 v[220:221], v25 offset:32768
  v_mfma_f32_16x16x32_bf16 v[68:71], v[204:207], v[52:55], v[68:71]
  ds_read_b64_tr_b16 v[222:223], v25 offset:40960
  v_mfma_f32_16x16x32_bf16 v[72:75], v[204:207], v[56:59], v[72:75]
  v_mfma_f32_16x16x32_bf16 v[76:79], v[204:207], v[60:63], v[76:79]
  s_waitcnt lgkmcnt(9)
  s_barrier
  s_waitcnt vmcnt(0)
  v_readfirstlane_b32 s80, v12
  v_readfirstlane_b32 s81, v13
  s_mov_b32 s59, 0
  s_cmp_lg_u32 s80, 0
  s_nop 2
  s_cbranch_scc1 L_non1d
L_non1:
  v_mov_b32 v9, 0
  buffer_load_dwordx2 v[12:13], v9, s[28:31], 0 offen sc1
  s_waitcnt vmcnt(0)
  v_readfirstlane_b32 s80, v12
  v_readfirstlane_b32 s81, v13
  s_add_u32 s59, s59, 1
  s_cmp_gt_u32 s59, 100000
  s_nop 2
  s_cbranch_scc1 L_non1d
  s_cmp_eq_u32 s80, 0
  s_cbranch_scc1 L_non1
L_non1d:
  s_bfe_u32 s51, s2, 0x30004
  s_lshl_b32 s51, s51, 10
  s_lshr_b32 s50, s2, 7
  s_lshl_b32 s50, s50, 9
  s_add_u32 s51, s51, s50
  s_and_b32 s50, s2, 15
  s_lshl_b32 s50, s50, 5
  s_add_u32 s51, s51, s50
  s_lshl_b32 s50, s98, 3
  s_add_u32 s51, s51, s50
  s_add_u32 s48, s51, 13631488
  v_mov_b32 v10, s80
  v_mov_b32 v11, s81
  v_lshlrev_b32 v9, 9, v1
  s_waitcnt vmcnt(0)
  s_mov_b64 exec, 1
  buffer_store_dwordx2 v[10:11], v9, s[12:15], s48 offen sc1
  s_mov_b64 exec, -1
  v_mfma_f32_16x16x32_bf16 v[80:83], v[208:211], v[48:51], v[80:83]
  ds_read_b128 v[32:35], v26 offset:16384
  v_mfma_f32_16x16x32_bf16 v[84:87], v[208:211], v[52:55], v[84:87]
  ds_read_b128 v[36:39], v26 offset:18432
  v_mfma_f32_16x16x32_bf16 v[88:91], v[208:211], v[56:59], v[88:91]
  v_add_u32 v21, 49152, v21
  v_mfma_f32_16x16x32_bf16 v[92:95], v[208:211], v[60:63], v[92:95]
  v_add_u32 v22, 49152, v22
  s_waitcnt lgkmcnt(8)
  v_mfma_f32_16x16x32_bf16 v[96:99], v[212:215], v[48:51], v[96:99]
  v_add_u32 v23, 49152, v23
  v_mfma_f32_16x16x32_bf16 v[100:103], v[212:215], v[52:55], v[100:103]
  v_add_u32 v24, 49152, v24
  v_mfma_f32_16x16x32_bf16 v[104:107], v[212:215], v[56:59], v[104:107]
  v_add_u32 v25, 49152, v25
  v_mfma_f32_16x16x32_bf16 v[108:111], v[212:215], v[60:63], v[108:111]
  ds_read_b64_tr_b16 v[204:205], v21 offset:0
  s_waitcnt lgkmcnt(6)
  v_mfma_f32_16x16x32_bf16 v[112:115], v[216:219], v[48:51], v[112:115]
  ds_read_b64_tr_b16 v[206:207], v21 offset:8192
  v_mfma_f32_16x16x32_bf16 v[116:119], v[216:219], v[52:55], v[116:119]
  ds_read_b128 v[40:43], v26 offset:20480
  v_mfma_f32_16x16x32_bf16 v[120:123], v[216:219], v[56:59], v[120:123]
  ds_read_b128 v[44:47], v26 offset:22528
  v_mfma_f32_16x16x32_bf16 v[124:127], v[216:219], v[60:63], v[124:127]
  ds_read_b64_tr_b16 v[208:209], v22 offset:0
  s_waitcnt lgkmcnt(7)
  v_mfma_f32_16x16x32_bf16 v[128:131], v[220:223], v[48:51], v[128:131]
  ds_read_b64_tr_b16 v[210:211], v22 offset:8192
  v_mfma_f32_16x16x32_bf16 v[132:135], v[220:223], v[52:55], v[132:135]
  ds_read_b64_tr_b16 v[212:213], v23 offset:0
  v_mfma_f32_16x16x32_bf16 v[136:139], v[220:223], v[56:59], v[136:139]
  ds_read_b64_tr_b16 v[214:215], v23 offset:8192
  v_mfma_f32_16x16x32_bf16 v[140:143], v[220:223], v[60:63], v[140:143]
  ds_read_b64_tr_b16 v[216:217], v24 offset:0
  s_waitcnt lgkmcnt(5)
  v_mfma_f32_16x16x32_bf16 v[64:67], v[204:207], v[32:35], v[64:67]
  ds_read_b64_tr_b16 v[218:219], v24 offset:8192
  v_mfma_f32_16x16x32_bf16 v[68:71], v[204:207], v[36:39], v[68:71]
  ds_read_b64_tr_b16 v[220:221], v25 offset:0
  v_mfma_f32_16x16x32_bf16 v[72:75], v[204:207], v[40:43], v[72:75]
  ds_read_b64_tr_b16 v[222:223], v25 offset:8192
  v_mfma_f32_16x16x32_bf16 v[76:79], v[204:207], v[44:47], v[76:79]
  s_waitcnt lgkmcnt(6)
  s_barrier
  v_mfma_f32_16x16x32_bf16 v[80:83], v[208:211], v[32:35], v[80:83]
  ds_read_b128 v[48:51], v27 offset:16384
  v_mfma_f32_16x16x32_bf16 v[84:87], v[208:211], v[36:39], v[84:87]
  ds_read_b128 v[52:55], v27 offset:18432
  v_mfma_f32_16x16x32_bf16 v[88:91], v[208:211], v[40:43], v[88:91]
  ds_read_b64_tr_b16 v[204:205], v21 offset:16384
  v_mfma_f32_16x16x32_bf16 v[92:95], v[208:211], v[44:47], v[92:95]
  ds_read_b64_tr_b16 v[206:207], v21 offset:24576
  s_waitcnt lgkmcnt(8)
  v_mfma_f32_16x16x32_bf16 v[96:99], v[212:215], v[32:35], v[96:99]
  ds_read_b128 v[56:59], v27 offset:20480
  v_mfma_f32_16x16x32_bf16 v[100:103], v[212:215], v[36:39], v[100:103]
  ds_read_b128 v[60:63], v27 offset:22528
  v_mfma_f32_16x16x32_bf16 v[104:107], v[212:215], v[40:43], v[104:107]
  ds_read_b64_tr_b16 v[208:209], v22 offset:16384
  v_mfma_f32_16x16x32_bf16 v[108:111], v[212:215], v[44:47], v[108:111]
  ds_read_b64_tr_b16 v[210:211], v22 offset:24576
  s_waitcnt lgkmcnt(10)
  v_mfma_f32_16x16x32_bf16 v[112:115], v[216:219], v[32:35], v[112:115]
  ds_read_b64_tr_b16 v[212:213], v23 offset:16384
  v_mfma_f32_16x16x32_bf16 v[116:119], v[216:219], v[36:39], v[116:119]
  ds_read_b64_tr_b16 v[214:215], v23 offset:24576
  v_mfma_f32_16x16x32_bf16 v[120:123], v[216:219], v[40:43], v[120:123]
  v_mfma_f32_16x16x32_bf16 v[124:127], v[216:219], v[44:47], v[124:127]
  s_waitcnt lgkmcnt(10)
  v_mfma_f32_16x16x32_bf16 v[128:131], v[220:223], v[32:35], v[128:131]
  ds_read_b64_tr_b16 v[216:217], v24 offset:16384
  v_mfma_f32_16x16x32_bf16 v[132:135], v[220:223], v[36:39], v[132:135]
  ds_read_b64_tr_b16 v[218:219], v24 offset:24576
  v_mfma_f32_16x16x32_bf16 v[136:139], v[220:223], v[40:43], v[136:139]
  v_mfma_f32_16x16x32_bf16 v[140:143], v[220:223], v[44:47], v[140:143]
  s_waitcnt lgkmcnt(6)
  v_mfma_f32_16x16x32_bf16 v[64:67], v[204:207], v[48:51], v[64:67]
  ds_read_b64_tr_b16 v[220:221], v25 offset:16384
  v_mfma_f32_16x16x32_bf16 v[68:71], v[204:207], v[52:55], v[68:71]
  ds_read_b64_tr_b16 v[222:223], v25 offset:24576
  v_mfma_f32_16x16x32_bf16 v[72:75], v[204:207], v[56:59], v[72:75]
  v_mfma_f32_16x16x32_bf16 v[76:79], v[204:207], v[60:63], v[76:79]
  s_waitcnt lgkmcnt(6)
  s_barrier
  v_mfma_f32_16x16x32_bf16 v[80:83], v[208:211], v[48:51], v[80:83]
  ds_read_b128 v[32:35], v26 offset:32768
  v_mfma_f32_16x16x32_bf16 v[84:87], v[208:211], v[52:55], v[84:87]
  ds_read_b128 v[36:39], v26 offset:34816
  v_mfma_f32_16x16x32_bf16 v[88:91], v[208:211], v[56:59], v[88:91]
  ds_read_b64_tr_b16 v[204:205], v21 offset:32768
  v_mfma_f32_16x16x32_bf16 v[92:95], v[208:211], v[60:63], v[92:95]
  ds_read_b64_tr_b16 v[206:207], v21 offset:40960
  s_waitcnt lgkmcnt(8)
  v_mfma_f32_16x16x32_bf16 v[96:99], v[212:215], v[48:51], v[96:99]
  ds_read_b128 v[40:43], v26 offset:36864
  v_mfma_f32_16x16x32_bf16 v[100:103], v[212:215], v[52:55], v[100:103]
  ds_read_b128 v[44:47], v26 offset:38912
  v_mfma_f32_16x16x32_bf16 v[104:107], v[212:215], v[56:59], v[104:107]
  ds_read_b64_tr_b16 v[208:209], v22 offset:32768
  v_mfma_f32_16x16x32_bf16 v[108:111], v[212:215], v[60:63], v[108:111]
  ds_read_b64_tr_b16 v[210:211], v22 offset:40960
  s_waitcnt lgkmcnt(10)
  v_mfma_f32_16x16x32_bf16 v[112:115], v[216:219], v[48:51], v[112:115]
  ds_read_b64_tr_b16 v[212:213], v23 offset:32768
  v_mfma_f32_16x16x32_bf16 v[116:119], v[216:219], v[52:55], v[116:119]
  ds_read_b64_tr_b16 v[214:215], v23 offset:40960
  v_mfma_f32_16x16x32_bf16 v[120:123], v[216:219], v[56:59], v[120:123]
  v_mfma_f32_16x16x32_bf16 v[124:127], v[216:219], v[60:63], v[124:127]
  s_waitcnt lgkmcnt(10)
  v_mfma_f32_16x16x32_bf16 v[128:131], v[220:223], v[48:51], v[128:131]
  ds_read_b64_tr_b16 v[216:217], v24 offset:32768
  v_mfma_f32_16x16x32_bf16 v[132:135], v[220:223], v[52:55], v[132:135]
  ds_read_b64_tr_b16 v[218:219], v24 offset:40960
  v_mfma_f32_16x16x32_bf16 v[136:139], v[220:223], v[56:59], v[136:139]
  v_mfma_f32_16x16x32_bf16 v[140:143], v[220:223], v[60:63], v[140:143]
  s_waitcnt lgkmcnt(6)
  v_mfma_f32_16x16x32_bf16 v[64:67], v[204:207], v[32:35], v[64:67]
  ds_read_b64_tr_b16 v[220:221], v25 offset:32768
  v_mfma_f32_16x16x32_bf16 v[68:71], v[204:207], v[36:39], v[68:71]
  ds_read_b64_tr_b16 v[222:223], v25 offset:40960
  v_mfma_f32_16x16x32_bf16 v[72:75], v[204:207], v[40:43], v[72:75]
  v_mfma_f32_16x16x32_bf16 v[76:79], v[204:207], v[44:47], v[76:79]
  s_waitcnt lgkmcnt(6)
  s_barrier
  v_mfma_f32_16x16x32_bf16 v[80:83], v[208:211], v[32:35], v[80:83]
  ds_read_b128 v[48:51], v27 offset:32768
  v_mfma_f32_16x16x32_bf16 v[84:87], v[208:211], v[36:39], v[84:87]
  ds_read_b128 v[52:55], v27 offset:34816
  v_mfma_f32_16x16x32_bf16 v[88:91], v[208:211], v[40:43], v[88:91]
  v_subrev_u32 v21, 49152, v21
  v_mfma_f32_16x16x32_bf16 v[92:95], v[208:211], v[44:47], v[92:95]
  v_subrev_u32 v22, 49152, v22
  s_waitcnt lgkmcnt(6)
  v_mfma_f32_16x16x32_bf16 v[96:99], v[212:215], v[32:35], v[96:99]
  v_subrev_u32 v23, 49152, v23
  v_mfma_f32_16x16x32_bf16 v[100:103], v[212:215], v[36:39], v[100:103]
  v_subrev_u32 v24, 49152, v24
  v_mfma_f32_16x16x32_bf16 v[104:107], v[212:215], v[40:43], v[104:107]
  v_subrev_u32 v25, 49152, v25
  v_mfma_f32_16x16x32_bf16 v[108:111], v[212:215], v[44:47], v[108:111]
  ds_read_b64_tr_b16 v[204:205], v21 offset:0
  s_waitcnt lgkmcnt(5)
  v_mfma_f32_16x16x32_bf16 v[112:115], v[216:219], v[32:35], v[112:115]
  ds_read_b64_tr_b16 v[206:207], v21 offset:8192
  v_mfma_f32_16x16x32_bf16 v[116:119], v[216:219], v[36:39], v[116:119]
  ds_read_b128 v[56:59], v27 offset:36864
  v_mfma_f32_16x16x32_bf16 v[120:123], v[216:219], v[40:43], v[120:123]
  ds_read_b128 v[60:63], v27 offset:38912
  v_mfma_f32_16x16x32_bf16 v[124:127], v[216:219], v[44:47], v[124:127]
  ds_read_b64_tr_b16 v[208:209], v22 offset:0
  s_waitcnt lgkmcnt(7)
  v_mfma_f32_16x16x32_bf16 v[128:131], v[220:223], v[32:35], v[128:131]
  ds_read_b64_tr_b16 v[210:211], v22 offset:8192
  v_mfma_f32_16x16x32_bf16 v[132:135], v[220:223], v[36:39], v[132:135]
  ds_read_b64_tr_b16 v[212:213], v23 offset:0
  v_mfma_f32_16x16x32_bf16 v[136:139], v[220:223], v[40:43], v[136:139]
  ds_read_b64_tr_b16 v[214:215], v23 offset:8192
  v_mfma_f32_16x16x32_bf16 v[140:143], v[220:223], v[44:47], v[140:143]
  ds_read_b64_tr_b16 v[216:217], v24 offset:0
  s_waitcnt lgkmcnt(5)
  v_mfma_f32_16x16x32_bf16 v[64:67], v[204:207], v[48:51], v[64:67]
  ds_read_b64_tr_b16 v[218:219], v24 offset:8192
  v_mfma_f32_16x16x32_bf16 v[68:71], v[204:207], v[52:55], v[68:71]
  ds_read_b64_tr_b16 v[220:221], v25 offset:0
  v_mfma_f32_16x16x32_bf16 v[72:75], v[204:207], v[56:59], v[72:75]
  ds_read_b64_tr_b16 v[222:223], v25 offset:8192
  v_mfma_f32_16x16x32_bf16 v[76:79], v[204:207], v[60:63], v[76:79]
  s_waitcnt lgkmcnt(6)
  s_barrier
  v_mfma_f32_16x16x32_bf16 v[80:83], v[208:211], v[48:51], v[80:83]
  ds_read_b128 v[32:35], v26 offset:0
  v_mfma_f32_16x16x32_bf16 v[84:87], v[208:211], v[52:55], v[84:87]
  ds_read_b128 v[36:39], v26 offset:2048
  v_mfma_f32_16x16x32_bf16 v[88:91], v[208:211], v[56:59], v[88:91]
  ds_read_b64_tr_b16 v[204:205], v21 offset:16384
  v_mfma_f32_16x16x32_bf16 v[92:95], v[208:211], v[60:63], v[92:95]
  ds_read_b64_tr_b16 v[206:207], v21 offset:24576
  s_waitcnt lgkmcnt(8)
  v_mfma_f32_16x16x32_bf16 v[96:99], v[212:215], v[48:51], v[96:99]
  ds_read_b128 v[40:43], v26 offset:4096
  v_mfma_f32_16x16x32_bf16 v[100:103], v[212:215], v[52:55], v[100:103]
  ds_read_b128 v[44:47], v26 offset:6144
  v_mfma_f32_16x16x32_bf16 v[104:107], v[212:215], v[56:59], v[104:107]
  ds_read_b64_tr_b16 v[208:209], v22 offset:16384
  v_mfma_f32_16x16x32_bf16 v[108:111], v[212:215], v[60:63], v[108:111]
  ds_read_b64_tr_b16 v[210:211], v22 offset:24576
  s_waitcnt lgkmcnt(10)
  v_mfma_f32_16x16x32_bf16 v[112:115], v[216:219], v[48:51], v[112:115]
  ds_read_b64_tr_b16 v[212:213], v23 offset:16384
  v_mfma_f32_16x16x32_bf16 v[116:119], v[216:219], v[52:55], v[116:119]
  ds_read_b64_tr_b16 v[214:215], v23 offset:24576
  v_mfma_f32_16x16x32_bf16 v[120:123], v[216:219], v[56:59], v[120:123]
  v_mfma_f32_16x16x32_bf16 v[124:127], v[216:219], v[60:63], v[124:127]
  s_waitcnt lgkmcnt(10)
  v_mfma_f32_16x16x32_bf16 v[128:131], v[220:223], v[48:51], v[128:131]
  ds_read_b64_tr_b16 v[216:217], v24 offset:16384
  v_mfma_f32_16x16x32_bf16 v[132:135], v[220:223], v[52:55], v[132:135]
  ds_read_b64_tr_b16 v[218:219], v24 offset:24576
  v_mfma_f32_16x16x32_bf16 v[136:139], v[220:223], v[56:59], v[136:139]
  v_mfma_f32_16x16x32_bf16 v[140:143], v[220:223], v[60:63], v[140:143]
  s_waitcnt lgkmcnt(6)
  v_mfma_f32_16x16x32_bf16 v[64:67], v[204:207], v[32:35], v[64:67]
  ds_read_b64_tr_b16 v[220:221], v25 offset:16384
  v_mfma_f32_16x16x32_bf16 v[68:71], v[204:207], v[36:39], v[68:71]
  ds_read_b64_tr_b16 v[222:223], v25 offset:24576
  v_mfma_f32_16x16x32_bf16 v[72:75], v[204:207], v[40:43], v[72:75]
  v_mfma_f32_16x16x32_bf16 v[76:79], v[204:207], v[44:47], v[76:79]
  s_waitcnt lgkmcnt(6)
  s_barrier
  v_mfma_f32_16x16x32_bf16 v[80:83], v[208:211], v[32:35], v[80:83]
  ds_read_b128 v[48:51], v27 offset:0
  v_mfma_f32_16x16x32_bf16 v[84:87], v[208:211], v[36:39], v[84:87]
  ds_read_b128 v[52:55], v27 offset:2048
  v_mfma_f32_16x16x32_bf16 v[88:91], v[208:211], v[40:43], v[88:91]
  ds_read_b64_tr_b16 v[204:205], v21 offset:32768
  v_mfma_f32_16x16x32_bf16 v[92:95], v[208:211], v[44:47], v[92:95]
  ds_read_b64_tr_b16 v[206:207], v21 offset:40960
  s_waitcnt lgkmcnt(8)
  v_mfma_f32_16x16x32_bf16 v[96:99], v[212:215], v[32:35], v[96:99]
  ds_read_b128 v[56:59], v27 offset:4096
  v_mfma_f32_16x16x32_bf16 v[100:103], v[212:215], v[36:39], v[100:103]
  ds_read_b128 v[60:63], v27 offset:6144
  v_mfma_f32_16x16x32_bf16 v[104:107], v[212:215], v[40:43], v[104:107]
  ds_read_b64_tr_b16 v[208:209], v22 offset:32768
  v_mfma_f32_16x16x32_bf16 v[108:111], v[212:215], v[44:47], v[108:111]
  ds_read_b64_tr_b16 v[210:211], v22 offset:40960
  s_waitcnt lgkmcnt(10)
  v_mfma_f32_16x16x32_bf16 v[112:115], v[216:219], v[32:35], v[112:115]
  ds_read_b64_tr_b16 v[212:213], v23 offset:32768
  v_mfma_f32_16x16x32_bf16 v[116:119], v[216:219], v[36:39], v[116:119]
  ds_read_b64_tr_b16 v[214:215], v23 offset:40960
  v_mfma_f32_16x16x32_bf16 v[120:123], v[216:219], v[40:43], v[120:123]
  v_mfma_f32_16x16x32_bf16 v[124:127], v[216:219], v[44:47], v[124:127]
  s_waitcnt lgkmcnt(10)
  v_mfma_f32_16x16x32_bf16 v[128:131], v[220:223], v[32:35], v[128:131]
  ds_read_b64_tr_b16 v[216:217], v24 offset:32768
  v_mfma_f32_16x16x32_bf16 v[132:135], v[220:223], v[36:39], v[132:135]
  ds_read_b64_tr_b16 v[218:219], v24 offset:40960
  v_mfma_f32_16x16x32_bf16 v[136:139], v[220:223], v[40:43], v[136:139]
  v_mfma_f32_16x16x32_bf16 v[140:143], v[220:223], v[44:47], v[140:143]
  s_waitcnt lgkmcnt(6)
  v_mfma_f32_16x16x32_bf16 v[64:67], v[204:207], v[48:51], v[64:67]
  ds_read_b64_tr_b16 v[220:221], v25 offset:32768
  v_mfma_f32_16x16x32_bf16 v[68:71], v[204:207], v[52:55], v[68:71]
  ds_read_b64_tr_b16 v[222:223], v25 offset:40960
  v_mfma_f32_16x16x32_bf16 v[72:75], v[204:207], v[56:59], v[72:75]
  v_mfma_f32_16x16x32_bf16 v[76:79], v[204:207], v[60:63], v[76:79]
  s_waitcnt lgkmcnt(6)
  s_barrier
  v_mfma_f32_16x16x32_bf16 v[80:83], v[208:211], v[48:51], v[80:83]
  ds_read_b128 v[32:35], v26 offset:16384
  v_mfma_f32_16x16x32_bf16 v[84:87], v[208:211], v[52:55], v[84:87]
  ds_read_b128 v[36:39], v26 offset:18432
  v_mfma_f32_16x16x32_bf16 v[88:91], v[208:211], v[56:59], v[88:91]
  v_add_u32 v21, 49152, v21
  v_mfma_f32_16x16x32_bf16 v[92:95], v[208:211], v[60:63], v[92:95]
  v_add_u32 v22, 49152, v22
  s_waitcnt lgkmcnt(6)
  v_mfma_f32_16x16x32_bf16 v[96:99], v[212:215], v[48:51], v[96:99]
  v_add_u32 v23, 49152, v23
  v_mfma_f32_16x16x32_bf16 v[100:103], v[212:215], v[52:55], v[100:103]
  v_add_u32 v24, 49152, v24
  v_mfma_f32_16x16x32_bf16 v[104:107], v[212:215], v[56:59], v[104:107]
  v_add_u32 v25, 49152, v25
  v_mfma_f32_16x16x32_bf16 v[108:111], v[212:215], v[60:63], v[108:111]
  ds_read_b64_tr_b16 v[204:205], v21 offset:0
  s_waitcnt lgkmcnt(5)
  v_mfma_f32_16x16x32_bf16 v[112:115], v[216:219], v[48:51], v[112:115]
  ds_read_b64_tr_b16 v[206:207], v21 offset:8192
  v_mfma_f32_16x16x32_bf16 v[116:119], v[216:219], v[52:55], v[116:119]
  ds_read_b128 v[40:43], v26 offset:20480
  v_mfma_f32_16x16x32_bf16 v[120:123], v[216:219], v[56:59], v[120:123]
  ds_read_b128 v[44:47], v26 offset:22528
  v_mfma_f32_16x16x32_bf16 v[124:127], v[216:219], v[60:63], v[124:127]
  ds_read_b64_tr_b16 v[208:209], v22 offset:0
  s_waitcnt lgkmcnt(7)
  v_mfma_f32_16x16x32_bf16 v[128:131], v[220:223], v[48:51], v[128:131]
  ds_read_b64_tr_b16 v[210:211], v22 offset:8192
  v_mfma_f32_16x16x32_bf16 v[132:135], v[220:223], v[52:55], v[132:135]
  ds_read_b64_tr_b16 v[212:213], v23 offset:0
  v_mfma_f32_16x16x32_bf16 v[136:139], v[220:223], v[56:59], v[136:139]
  ds_read_b64_tr_b16 v[214:215], v23 offset:8192
  v_mfma_f32_16x16x32_bf16 v[140:143], v[220:223], v[60:63], v[140:143]
  ds_read_b64_tr_b16 v[216:217], v24 offset:0
  s_waitcnt lgkmcnt(5)
  v_mfma_f32_16x16x32_bf16 v[64:67], v[204:207], v[32:35], v[64:67]
  ds_read_b64_tr_b16 v[218:219], v24 offset:8192
  v_mfma_f32_16x16x32_bf16 v[68:71], v[204:207], v[36:39], v[68:71]
  ds_read_b64_tr_b16 v[220:221], v25 offset:0
  v_mfma_f32_16x16x32_bf16 v[72:75], v[204:207], v[40:43], v[72:75]
  ds_read_b64_tr_b16 v[222:223], v25 offset:8192
  v_mfma_f32_16x16x32_bf16 v[76:79], v[204:207], v[44:47], v[76:79]
  s_waitcnt lgkmcnt(6)
  s_barrier
  v_mfma_f32_16x16x32_bf16 v[80:83], v[208:211], v[32:35], v[80:83]
  ds_read_b128 v[48:51], v27 offset:16384
  v_mfma_f32_16x16x32_bf16 v[84:87], v[208:211], v[36:39], v[84:87]
  ds_read_b128 v[52:55], v27 offset:18432
  v_mfma_f32_16x16x32_bf16 v[88:91], v[208:211], v[40:43], v[88:91]
  ds_read_b64_tr_b16 v[204:205], v21 offset:16384
  v_mfma_f32_16x16x32_bf16 v[92:95], v[208:211], v[44:47], v[92:95]
  ds_read_b64_tr_b16 v[206:207], v21 offset:24576
  s_waitcnt lgkmcnt(8)
  v_mfma_f32_16x16x32_bf16 v[96:99], v[212:215], v[32:35], v[96:99]
  ds_read_b128 v[56:59], v27 offset:20480
  v_mfma_f32_16x16x32_bf16 v[100:103], v[212:215], v[36:39], v[100:103]
  ds_read_b128 v[60:63], v27 offset:22528
  v_mfma_f32_16x16x32_bf16 v[104:107], v[212:215], v[40:43], v[104:107]
  ds_read_b64_tr_b16 v[208:209], v22 offset:16384
  v_mfma_f32_16x16x32_bf16 v[108:111], v[212:215], v[44:47], v[108:111]
  ds_read_b64_tr_b16 v[210:211], v22 offset:24576
  s_waitcnt lgkmcnt(10)
  v_mfma_f32_16x16x32_bf16 v[112:115], v[216:219], v[32:35], v[112:115]
  ds_read_b64_tr_b16 v[212:213], v23 offset:16384
  v_mfma_f32_16x16x32_bf16 v[116:119], v[216:219], v[36:39], v[116:119]
  ds_read_b64_tr_b16 v[214:215], v23 offset:24576
  v_mfma_f32_16x16x32_bf16 v[120:123], v[216:219], v[40:43], v[120:123]
  v_mfma_f32_16x16x32_bf16 v[124:127], v[216:219], v[44:47], v[124:127]
  s_waitcnt lgkmcnt(10)
  v_mfma_f32_16x16x32_bf16 v[128:131], v[220:223], v[32:35], v[128:131]
  ds_read_b64_tr_b16 v[216:217], v24 offset:16384
  v_mfma_f32_16x16x32_bf16 v[132:135], v[220:223], v[36:39], v[132:135]
  ds_read_b64_tr_b16 v[218:219], v24 offset:24576
  v_mfma_f32_16x16x32_bf16 v[136:139], v[220:223], v[40:43], v[136:139]
  v_mfma_f32_16x16x32_bf16 v[140:143], v[220:223], v[44:47], v[140:143]
  s_waitcnt lgkmcnt(6)
  v_mfma_f32_16x16x32_bf16 v[64:67], v[204:207], v[48:51], v[64:67]
  ds_read_b64_tr_b16 v[220:221], v25 offset:16384
  v_mfma_f32_16x16x32_bf16 v[68:71], v[204:207], v[52:55], v[68:71]
  ds_read_b64_tr_b16 v[222:223], v25 offset:24576
  v_mfma_f32_16x16x32_bf16 v[72:75], v[204:207], v[56:59], v[72:75]
  v_mfma_f32_16x16x32_bf16 v[76:79], v[204:207], v[60:63], v[76:79]
  s_waitcnt lgkmcnt(6)
  s_barrier
  v_mfma_f32_16x16x32_bf16 v[80:83], v[208:211], v[48:51], v[80:83]
  ds_read_b128 v[32:35], v26 offset:32768
  v_mfma_f32_16x16x32_bf16 v[84:87], v[208:211], v[52:55], v[84:87]
  ds_read_b128 v[36:39], v26 offset:34816
  v_mfma_f32_16x16x32_bf16 v[88:91], v[208:211], v[56:59], v[88:91]
  ds_read_b64_tr_b16 v[204:205], v21 offset:32768
  v_mfma_f32_16x16x32_bf16 v[92:95], v[208:211], v[60:63], v[92:95]
  ds_read_b64_tr_b16 v[206:207], v21 offset:40960
  s_waitcnt lgkmcnt(8)
  v_mfma_f32_16x16x32_bf16 v[96:99], v[212:215], v[48:51], v[96:99]
  ds_read_b128 v[40:43], v26 offset:36864
  v_mfma_f32_16x16x32_bf16 v[100:103], v[212:215], v[52:55], v[100:103]
  ds_read_b128 v[44:47], v26 offset:38912
  v_mfma_f32_16x16x32_bf16 v[104:107], v[212:215], v[56:59], v[104:107]
  ds_read_b64_tr_b16 v[208:209], v22 offset:32768
  v_mfma_f32_16x16x32_bf16 v[108:111], v[212:215], v[60:63], v[108:111]
  ds_read_b64_tr_b16 v[210:211], v22 offset:40960
  s_waitcnt lgkmcnt(10)
  v_mfma_f32_16x16x32_bf16 v[112:115], v[216:219], v[48:51], v[112:115]
  ds_read_b64_tr_b16 v[212:213], v23 offset:32768
  v_mfma_f32_16x16x32_bf16 v[116:119], v[216:219], v[52:55], v[116:119]
  ds_read_b64_tr_b16 v[214:215], v23 offset:40960
  v_mfma_f32_16x16x32_bf16 v[120:123], v[216:219], v[56:59], v[120:123]
  v_mfma_f32_16x16x32_bf16 v[124:127], v[216:219], v[60:63], v[124:127]
  s_waitcnt lgkmcnt(10)
  v_mfma_f32_16x16x32_bf16 v[128:131], v[220:223], v[48:51], v[128:131]
  ds_read_b64_tr_b16 v[216:217], v24 offset:32768
  v_mfma_f32_16x16x32_bf16 v[132:135], v[220:223], v[52:55], v[132:135]
  ds_read_b64_tr_b16 v[218:219], v24 offset:40960
  v_mfma_f32_16x16x32_bf16 v[136:139], v[220:223], v[56:59], v[136:139]
  v_mfma_f32_16x16x32_bf16 v[140:143], v[220:223], v[60:63], v[140:143]
  s_waitcnt lgkmcnt(6)
  v_mfma_f32_16x16x32_bf16 v[64:67], v[204:207], v[32:35], v[64:67]
  ds_read_b64_tr_b16 v[220:221], v25 offset:32768
  v_mfma_f32_16x16x32_bf16 v[68:71], v[204:207], v[36:39], v[68:71]
  ds_read_b64_tr_b16 v[222:223], v25 offset:40960
  v_mfma_f32_16x16x32_bf16 v[72:75], v[204:207], v[40:43], v[72:75]
  v_mfma_f32_16x16x32_bf16 v[76:79], v[204:207], v[44:47], v[76:79]
  s_waitcnt lgkmcnt(6)
  s_barrier
  v_mfma_f32_16x16x32_bf16 v[80:83], v[208:211], v[32:35], v[80:83]
  ds_read_b128 v[48:51], v27 offset:32768
  v_mfma_f32_16x16x32_bf16 v[84:87], v[208:211], v[36:39], v[84:87]
  ds_read_b128 v[52:55], v27 offset:34816
  v_mfma_f32_16x16x32_bf16 v[88:91], v[208:211], v[40:43], v[88:91]
  v_subrev_u32 v21, 49152, v21
  v_mfma_f32_16x16x32_bf16 v[92:95], v[208:211], v[44:47], v[92:95]
  v_subrev_u32 v22, 49152, v22
  s_waitcnt lgkmcnt(6)
  v_mfma_f32_16x16x32_bf16 v[96:99], v[212:215], v[32:35], v[96:99]
  v_subrev_u32 v23, 49152, v23
  v_mfma_f32_16x16x32_bf16 v[100:103], v[212:215], v[36:39], v[100:103]
  v_subrev_u32 v24, 49152, v24
  v_mfma_f32_16x16x32_bf16 v[104:107], v[212:215], v[40:43], v[104:107]
  v_subrev_u32 v25, 49152, v25
  v_mfma_f32_16x16x32_bf16 v[108:111], v[212:215], v[44:47], v[108:111]
  ds_read_b64_tr_b16 v[204:205], v21 offset:0
  s_waitcnt lgkmcnt(5)
  v_mfma_f32_16x16x32_bf16 v[112:115], v[216:219], v[32:35], v[112:115]
  ds_read_b64_tr_b16 v[206:207], v21 offset:8192
  v_mfma_f32_16x16x32_bf16 v[116:119], v[216:219], v[36:39], v[116:119]
  ds_read_b128 v[56:59], v27 offset:36864
  v_mfma_f32_16x16x32_bf16 v[120:123], v[216:219], v[40:43], v[120:123]
  ds_read_b128 v[60:63], v27 offset:38912
  v_mfma_f32_16x16x32_bf16 v[124:127], v[216:219], v[44:47], v[124:127]
  ds_read_b64_tr_b16 v[208:209], v22 offset:0
  s_waitcnt lgkmcnt(7)
  v_mfma_f32_16x16x32_bf16 v[128:131], v[220:223], v[32:35], v[128:131]
  ds_read_b64_tr_b16 v[210:211], v22 offset:8192
  v_mfma_f32_16x16x32_bf16 v[132:135], v[220:223], v[36:39], v[132:135]
  ds_read_b64_tr_b16 v[212:213], v23 offset:0
  v_mfma_f32_16x16x32_bf16 v[136:139], v[220:223], v[40:43], v[136:139]
  ds_read_b64_tr_b16 v[214:215], v23 offset:8192
  v_mfma_f32_16x16x32_bf16 v[140:143], v[220:223], v[44:47], v[140:143]
  ds_read_b64_tr_b16 v[216:217], v24 offset:0
  s_waitcnt lgkmcnt(5)
  v_mfma_f32_16x16x32_bf16 v[64:67], v[204:207], v[48:51], v[64:67]
  ds_read_b64_tr_b16 v[218:219], v24 offset:8192
  v_mfma_f32_16x16x32_bf16 v[68:71], v[204:207], v[52:55], v[68:71]
  ds_read_b64_tr_b16 v[220:221], v25 offset:0
  v_mfma_f32_16x16x32_bf16 v[72:75], v[204:207], v[56:59], v[72:75]
  ds_read_b64_tr_b16 v[222:223], v25 offset:8192
  v_mfma_f32_16x16x32_bf16 v[76:79], v[204:207], v[60:63], v[76:79]
  s_waitcnt lgkmcnt(6)
  s_barrier
  v_mfma_f32_16x16x32_bf16 v[80:83], v[208:211], v[48:51], v[80:83]
  v_mfma_f32_16x16x32_bf16 v[84:87], v[208:211], v[52:55], v[84:87]
  v_mfma_f32_16x16x32_bf16 v[88:91], v[208:211], v[56:59], v[88:91]
  v_mfma_f32_16x16x32_bf16 v[92:95], v[208:211], v[60:63], v[92:95]
  s_waitcnt lgkmcnt(4)
  v_mfma_f32_16x16x32_bf16 v[96:99], v[212:215], v[48:51], v[96:99]
  v_mfma_f32_16x16x32_bf16 v[100:103], v[212:215], v[52:55], v[100:103]
  v_mfma_f32_16x16x32_bf16 v[104:107], v[212:215], v[56:59], v[104:107]
  v_mfma_f32_16x16x32_bf16 v[108:111], v[212:215], v[60:63], v[108:111]
  s_waitcnt lgkmcnt(2)
  v_mfma_f32_16x16x32_bf16 v[112:115], v[216:219], v[48:51], v[112:115]
  v_mfma_f32_16x16x32_bf16 v[116:119], v[216:219], v[52:55], v[116:119]
  v_mfma_f32_16x16x32_bf16 v[120:123], v[216:219], v[56:59], v[120:123]
  v_mfma_f32_16x16x32_bf16 v[124:127], v[216:219], v[60:63], v[124:127]
  s_waitcnt lgkmcnt(0)
  v_mfma_f32_16x16x32_bf16 v[128:131], v[220:223], v[48:51], v[128:131]
  v_mfma_f32_16x16x32_bf16 v[132:135], v[220:223], v[52:55], v[132:135]
  v_mfma_f32_16x16x32_bf16 v[136:139], v[220:223], v[56:59], v[136:139]
  v_mfma_f32_16x16x32_bf16 v[140:143], v[220:223], v[60:63], v[140:143]
  s_setprio 3
  s_mul_i32 s50, s99, 5120
  v_add_u32 v6, s50, v250
  v_lshlrev_b32 v7, 3, v1
  v_add_u32 v7, s50, v7
  v_cvt_pk_bf16_f32 v204, v72, v73
  v_cvt_pk_bf16_f32 v205, v74, v75
  v_cvt_pk_bf16_f32 v206, v88, v89
  v_cvt_pk_bf16_f32 v207, v90, v91
  v_cvt_pk_bf16_f32 v208, v104, v105
  v_cvt_pk_bf16_f32 v209, v106, v107
  v_cvt_pk_bf16_f32 v210, v120, v121
  v_cvt_pk_bf16_f32 v211, v122, v123
  v_cvt_pk_bf16_f32 v212, v136, v137
  v_cvt_pk_bf16_f32 v213, v138, v139
  ds_write_b128 v6, v[204:207] offset:0
  ds_write_b128 v6, v[208:211] offset:1024
  ds_write_b64 v7, v[212:213] offset:2048
  v_cvt_pk_bf16_f32 v214, v76, v77
  v_cvt_pk_bf16_f32 v215, v78, v79
  v_cvt_pk_bf16_f32 v216, v92, v93
  v_cvt_pk_bf16_f32 v217, v94, v95
  v_cvt_pk_bf16_f32 v218, v108, v109
  v_cvt_pk_bf16_f32 v219, v110, v111
  v_cvt_pk_bf16_f32 v220, v124, v125
  v_cvt_pk_bf16_f32 v221, v126, v127
  v_cvt_pk_bf16_f32 v222, v140, v141
  v_cvt_pk_bf16_f32 v223, v142, v143
  ds_write_b128 v6, v[214:217] offset:2560
  ds_write_b128 v6, v[218:221] offset:3584
  ds_write_b64 v7, v[222:223] offset:4608
  v_cvt_pk_bf16_f32 v32, v64, v65
  v_cvt_pk_bf16_f32 v33, v66, v67
  v_cvt_pk_bf16_f32 v34, v80, v81
  v_cvt_pk_bf16_f32 v35, v82, v83
  v_cvt_pk_bf16_f32 v36, v96, v97
  v_cvt_pk_bf16_f32 v37, v98, v99
  v_cvt_pk_bf16_f32 v38, v112, v113
  v_cvt_pk_bf16_f32 v39, v114, v115
  v_cvt_pk_bf16_f32 v40, v128, v129
  v_cvt_pk_bf16_f32 v41, v130, v131
  v_mov_b32 v42, 0
  v_mov_b32 v43, 0
  s_waitcnt lgkmcnt(0)
  v_mov_b32 v4, 163096
  v_mov_b32 v5, 1
  s_mov_b64 exec, 1
  ds_add_u32 v4, v5
  s_mov_b64 exec, -1
  v_mov_b32 v4, 163072
  v_mov_b32 v5, 1
  s_mov_b64 exec, 1
  ds_add_u32 v4, v5
  s_mov_b64 exec, -1
  v_cvt_pk_bf16_f32 v44, v68, v69
  v_cvt_pk_bf16_f32 v45, v70, v71
  v_cvt_pk_bf16_f32 v46, v84, v85
  v_cvt_pk_bf16_f32 v47, v86, v87
  v_cvt_pk_bf16_f32 v48, v100, v101
  v_cvt_pk_bf16_f32 v49, v102, v103
  v_cvt_pk_bf16_f32 v50, v116, v117
  v_cvt_pk_bf16_f32 v51, v118, v119
  v_cvt_pk_bf16_f32 v52, v132, v133
  v_cvt_pk_bf16_f32 v53, v134, v135
  v_mov_b32 v54, 0
  v_mov_b32 v55, 0
  s_nop 1
  s_branch L_kpost
L_vcomp:
  v_lshrrev_b32 v4, 1, v2
  v_xor_b32 v4, v4, v3
  v_lshlrev_b32 v4, 4, v4
  v_lshl_add_u32 v4, v2, 7, v4
  s_lshl_b32 s50, s99, 13
  v_add_u32 v26, s50, v4
  v_xor_b32 v27, 64, v26
  v_bfe_u32 v4, v1, 2, 2
  v_lshl_add_u32 v5, v3, 2, v4
  v_and_b32 v6, 3, v1
  v_and_b32 v7, 1, v4
  v_lshlrev_b32 v7, 1, v7
  v_and_b32 v8, 7, v5
  v_lshl_add_u32 v7, v8, 2, v7
  v_lshlrev_b32 v8, 9, v5
  v_add_u32 v8, 49152, v8
  v_lshlrev_b32 v6, 3, v6
  s_mov_b32 s51, 589439264
  v_lshrrev_b32 v4, v6, s51
  v_and_b32 v4, 0xff, v4
  v_xor_b32 v4, v4, v7
  v_lshl_add_u32 v21, v4, 3, v8
  s_mov_b32 s51, 656811300
  v_lshrrev_b32 v4, v6, s51
  v_and_b32 v4, 0xff, v4
  v_xor_b32 v4, v4, v7
  v_lshl_add_u32 v22, v4, 3, v8
  s_mov_b32 s51, 724183336
  v_lshrrev_b32 v4, v6, s51
  v_and_b32 v4, 0xff, v4
  v_xor_b32 v4, v4, v7
  v_lshl_add_u32 v23, v4, 3, v8
  s_mov_b32 s51, 791555372
  v_lshrrev_b32 v4, v6, s51
  v_and_b32 v4, 0xff, v4
  v_xor_b32 v4, v4, v7
  v_lshl_add_u32 v24, v4, 3, v8
  s_mov_b32 s51, 825240362
  v_lshrrev_b32 v4, v6, s51
  v_and_b32 v4, 0xff, v4
  v_xor_b32 v4, v4, v7
  v_lshl_add_u32 v25, v4, 3, v8
  s_waitcnt vmcnt(2)
  ds_write_b16 v40, v32
  ds_write_b16 v41, v33
  ds_write_b16 v42, v34
  ds_write_b16 v43, v35
  ds_write_b16 v44, v36
  v_cmp_gt_u32 vcc, 16, v46
  s_nop 0
  s_and_saveexec_b64 s[94:95], vcc
  ds_write_b16 v45, v37
  s_mov_b64 exec, -1
  v_lshlrev_b32 v9, 3, v46
  v_add_u32 v9, 160512, v9
  v_cmp_gt_u32 vcc, 144, v46
  s_nop 0
  s_and_saveexec_b64 s[94:95], vcc
  ds_write_b64 v9, v[38:39]
  s_mov_b64 exec, -1
  s_waitcnt lgkmcnt(0)
  s_barrier
  ds_read_b128 v[32:35], v26 offset:0
  ds_read_b128 v[36:39], v26 offset:2048
  ds_read_b128 v[40:43], v26 offset:4096
  ds_read_b128 v[44:47], v26 offset:6144
  ds_read_b64_tr_b16 v[204:205], v21 offset:16384
  ds_read_b64_tr_b16 v[206:207], v21 offset:24576
  ds_read_b64_tr_b16 v[208:209], v22 offset:16384
  ds_read_b64_tr_b16 v[210:211], v22 offset:24576
  ds_read_b64_tr_b16 v[212:213], v23 offset:16384
  ds_read_b64_tr_b16 v[214:215], v23 offset:24576
  ds_read_b64_tr_b16 v[216:217], v24 offset:16384
  ds_read_b64_tr_b16 v[218:219], v24 offset:24576
  s_waitcnt lgkmcnt(6)
  v_mfma_f32_16x16x32_bf16 v[64:67], v[32:35], v[204:207], 0
  ds_read_b64_tr_b16 v[220:221], v25 offset:16384
  v_mfma_f32_16x16x32_bf16 v[68:71], v[36:39], v[204:207], 0
  ds_read_b64_tr_b16 v[222:223], v25 offset:24576
  v_mfma_f32_16x16x32_bf16 v[72:75], v[40:43], v[204:207], 0
  v_mfma_f32_16x16x32_bf16 v[76:79], v[44:47], v[204:207], 0
  s_waitcnt lgkmcnt(6)
  s_barrier
  v_mfma_f32_16x16x32_bf16 v[80:83], v[32:35], v[208:211], 0
  ds_read_b128 v[48:51], v27 offset:0
  v_mfma_f32_16x16x32_bf16 v[84:87], v[36:39], v[208:211], 0
  ds_read_b128 v[52:55], v27 offset:2048
  v_mfma_f32_16x16x32_bf16 v[88:91], v[40:43], v[208:211], 0
  ds_read_b64_tr_b16 v[204:205], v21 offset:32768
  v_mfma_f32_16x16x32_bf16 v[92:95], v[44:47], v[208:211], 0
  ds_read_b64_tr_b16 v[206:207], v21 offset:40960
  s_waitcnt lgkmcnt(8)
  v_mfma_f32_16x16x32_bf16 v[96:99], v[32:35], v[212:215], 0
  ds_read_b128 v[56:59], v27 offset:4096
  v_mfma_f32_16x16x32_bf16 v[100:103], v[36:39], v[212:215], 0
  ds_read_b128 v[60:63], v27 offset:6144
  v_mfma_f32_16x16x32_bf16 v[104:107], v[40:43], v[212:215], 0
  ds_read_b64_tr_b16 v[208:209], v22 offset:32768
  v_mfma_f32_16x16x32_bf16 v[108:111], v[44:47], v[212:215], 0
  ds_read_b64_tr_b16 v[210:211], v22 offset:40960
  s_waitcnt lgkmcnt(10)
  v_mfma_f32_16x16x32_bf16 v[112:115], v[32:35], v[216:219], 0
  ds_read_b64_tr_b16 v[212:213], v23 offset:32768
  v_mfma_f32_16x16x32_bf16 v[116:119], v[36:39], v[216:219], 0
  ds_read_b64_tr_b16 v[214:215], v23 offset:40960
  v_mfma_f32_16x16x32_bf16 v[120:123], v[40:43], v[216:219], 0
  v_mfma_f32_16x16x32_bf16 v[124:127], v[44:47], v[216:219], 0
  s_waitcnt lgkmcnt(10)
  v_mfma_f32_16x16x32_bf16 v[128:131], v[32:35], v[220:223], 0
  ds_read_b64_tr_b16 v[216:217], v24 offset:32768
  v_mfma_f32_16x16x32_bf16 v[132:135], v[36:39], v[220:223], 0
  ds_read_b64_tr_b16 v[218:219], v24 offset:40960
  v_mfma_f32_16x16x32_bf16 v[136:139], v[40:43], v[220:223], 0
  v_mfma_f32_16x16x32_bf16 v[140:143], v[44:47], v[220:223], 0
  s_waitcnt lgkmcnt(6)
  v_mfma_f32_16x16x32_bf16 v[64:67], v[48:51], v[204:207], v[64:67]
  ds_read_b64_tr_b16 v[220:221], v25 offset:32768
  v_mfma_f32_16x16x32_bf16 v[68:71], v[52:55], v[204:207], v[68:71]
  ds_read_b64_tr_b16 v[222:223], v25 offset:40960
  v_mfma_f32_16x16x32_bf16 v[72:75], v[56:59], v[204:207], v[72:75]
  v_mfma_f32_16x16x32_bf16 v[76:79], v[60:63], v[204:207], v[76:79]
  s_waitcnt lgkmcnt(6)
  s_barrier
  v_mfma_f32_16x16x32_bf16 v[80:83], v[48:51], v[208:211], v[80:83]
  ds_read_b128 v[32:35], v26 offset:16384
  v_mfma_f32_16x16x32_bf16 v[84:87], v[52:55], v[208:211], v[84:87]
  ds_read_b128 v[36:39], v26 offset:18432
  v_mfma_f32_16x16x32_bf16 v[88:91], v[56:59], v[208:211], v[88:91]
  v_add_u32 v21, 49152, v21
  v_mfma_f32_16x16x32_bf16 v[92:95], v[60:63], v[208:211], v[92:95]
  v_add_u32 v22, 49152, v22
  s_waitcnt lgkmcnt(6)
  v_mfma_f32_16x16x32_bf16 v[96:99], v[48:51], v[212:215], v[96:99]
  v_add_u32 v23, 49152, v23
  v_mfma_f32_16x16x32_bf16 v[100:103], v[52:55], v[212:215], v[100:103]
  v_add_u32 v24, 49152, v24
  v_mfma_f32_16x16x32_bf16 v[104:107], v[56:59], v[212:215], v[104:107]
  v_add_u32 v25, 49152, v25
  v_mfma_f32_16x16x32_bf16 v[108:111], v[60:63], v[212:215], v[108:111]
  ds_read_b64_tr_b16 v[204:205], v21 offset:0
  s_waitcnt lgkmcnt(5)
  s_waitcnt vmcnt(0)
  buffer_store_dwordx4 v[144:147], v152, s[12:15], 0 offen sc1
  buffer_store_dwordx4 v[148:151], v153, s[12:15], 0 offen sc1
  v_mov_b32 v9, 0
  buffer_load_dwordx2 v[12:13], v9, s[28:31], 0 offen sc1
  v_mfma_f32_16x16x32_bf16 v[112:115], v[48:51], v[216:219], v[112:115]
  ds_read_b64_tr_b16 v[206:207], v21 offset:8192
  v_mfma_f32_16x16x32_bf16 v[116:119], v[52:55], v[216:219], v[116:119]
  ds_read_b128 v[40:43], v26 offset:20480
  v_mfma_f32_16x16x32_bf16 v[120:123], v[56:59], v[216:219], v[120:123]
  ds_read_b128 v[44:47], v26 offset:22528
  v_mfma_f32_16x16x32_bf16 v[124:127], v[60:63], v[216:219], v[124:127]
  ds_read_b64_tr_b16 v[208:209], v22 offset:0
  s_waitcnt lgkmcnt(7)
  v_mfma_f32_16x16x32_bf16 v[128:131], v[48:51], v[220:223], v[128:131]
  ds_read_b64_tr_b16 v[210:211], v22 offset:8192
  v_mfma_f32_16x16x32_bf16 v[132:135], v[52:55], v[220:223], v[132:135]
  ds_read_b64_tr_b16 v[212:213], v23 offset:0
  v_mfma_f32_16x16x32_bf16 v[136:139], v[56:59], v[220:223], v[136:139]
  ds_read_b64_tr_b16 v[214:215], v23 offset:8192
  v_mfma_f32_16x16x32_bf16 v[140:143], v[60:63], v[220:223], v[140:143]
  ds_read_b64_tr_b16 v[216:217], v24 offset:0
  s_waitcnt lgkmcnt(5)
  v_mfma_f32_16x16x32_bf16 v[64:67], v[32:35], v[204:207], v[64:67]
  ds_read_b64_tr_b16 v[218:219], v24 offset:8192
  v_mfma_f32_16x16x32_bf16 v[68:71], v[36:39], v[204:207], v[68:71]
  ds_read_b64_tr_b16 v[220:221], v25 offset:0
  v_mfma_f32_16x16x32_bf16 v[72:75], v[40:43], v[204:207], v[72:75]
  ds_read_b64_tr_b16 v[222:223], v25 offset:8192
  v_mfma_f32_16x16x32_bf16 v[76:79], v[44:47], v[204:207], v[76:79]
  s_waitcnt lgkmcnt(6)
  s_barrier
  v_mfma_f32_16x16x32_bf16 v[80:83], v[32:35], v[208:211], v[80:83]
  ds_read_b128 v[48:51], v27 offset:16384
  v_mfma_f32_16x16x32_bf16 v[84:87], v[36:39], v[208:211], v[84:87]
  ds_read_b128 v[52:55], v27 offset:18432
  v_mfma_f32_16x16x32_bf16 v[88:91], v[40:43], v[208:211], v[88:91]
  ds_read_b64_tr_b16 v[204:205], v21 offset:16384
  v_mfma_f32_16x16x32_bf16 v[92:95], v[44:47], v[208:211], v[92:95]
  ds_read_b64_tr_b16 v[206:207], v21 offset:24576
  s_waitcnt lgkmcnt(8)
  v_mfma_f32_16x16x32_bf16 v[96:99], v[32:35], v[212:215], v[96:99]
  ds_read_b128 v[56:59], v27 offset:20480
  v_mfma_f32_16x16x32_bf16 v[100:103], v[36:39], v[212:215], v[100:103]
  ds_read_b128 v[60:63], v27 offset:22528
  v_mfma_f32_16x16x32_bf16 v[104:107], v[40:43], v[212:215], v[104:107]
  ds_read_b64_tr_b16 v[208:209], v22 offset:16384
  v_mfma_f32_16x16x32_bf16 v[108:111], v[44:47], v[212:215], v[108:111]
  ds_read_b64_tr_b16 v[210:211], v22 offset:24576
  s_waitcnt lgkmcnt(10)
  v_mfma_f32_16x16x32_bf16 v[112:115], v[32:35], v[216:219], v[112:115]
  ds_read_b64_tr_b16 v[212:213], v23 offset:16384
  v_mfma_f32_16x16x32_bf16 v[116:119], v[36:39], v[216:219], v[116:119]
  ds_read_b64_tr_b16 v[214:215], v23 offset:24576
  v_mfma_f32_16x16x32_bf16 v[120:123], v[40:43], v[216:219], v[120:123]
  v_mfma_f32_16x16x32_bf16 v[124:127], v[44:47], v[216:219], v[124:127]
  s_waitcnt lgkmcnt(10)
  v_mfma_f32_16x16x32_bf16 v[128:131], v[32:35], v[220:223], v[128:131]
  ds_read_b64_tr_b16 v[216:217], v24 offset:16384
  v_mfma_f32_16x16x32_bf16 v[132:135], v[36:39], v[220:223], v[132:135]
  ds_read_b64_tr_b16 v[218:219], v24 offset:24576
  v_mfma_f32_16x16x32_bf16 v[136:139], v[40:43], v[220:223], v[136:139]
  v_mfma_f32_16x16x32_bf16 v[140:143], v[44:47], v[220:223], v[140:143]
  s_waitcnt lgkmcnt(6)
  v_mfma_f32_16x16x32_bf16 v[64:67], v[48:51], v[204:207], v[64:67]
  ds_read_b64_tr_b16 v[220:221], v25 offset:16384
  v_mfma_f32_16x16x32_bf16 v[68:71], v[52:55], v[204:207], v[68:71]
  ds_read_b64_tr_b16 v[222:223], v25 offset:24576
  v_mfma_f32_16x16x32_bf16 v[72:75], v[56:59], v[204:207], v[72:75]
  v_mfma_f32_16x16x32_bf16 v[76:79], v[60:63], v[204:207], v[76:79]
  s_waitcnt lgkmcnt(6)
  s_barrier
  v_mfma_f32_16x16x32_bf16 v[80:83], v[48:51], v[208:211], v[80:83]
  ds_read_b128 v[32:35], v26 offset:32768
  v_mfma_f32_16x16x32_bf16 v[84:87], v[52:55], v[208:211], v[84:87]
  ds_read_b128 v[36:39], v26 offset:34816
  v_mfma_f32_16x16x32_bf16 v[88:91], v[56:59], v[208:211], v[88:91]
  ds_read_b64_tr_b16 v[204:205], v21 offset:32768
  v_mfma_f32_16x16x32_bf16 v[92:95], v[60:63], v[208:211], v[92:95]
  ds_read_b64_tr_b16 v[206:207], v21 offset:40960
  s_waitcnt lgkmcnt(8)
  v_mfma_f32_16x16x32_bf16 v[96:99], v[48:51], v[212:215], v[96:99]
  ds_read_b128 v[40:43], v26 offset:36864
  v_mfma_f32_16x16x32_bf16 v[100:103], v[52:55], v[212:215], v[100:103]
  ds_read_b128 v[44:47], v26 offset:38912
  v_mfma_f32_16x16x32_bf16 v[104:107], v[56:59], v[212:215], v[104:107]
  ds_read_b64_tr_b16 v[208:209], v22 offset:32768
  v_mfma_f32_16x16x32_bf16 v[108:111], v[60:63], v[212:215], v[108:111]
  ds_read_b64_tr_b16 v[210:211], v22 offset:40960
  s_waitcnt lgkmcnt(10)
  v_mfma_f32_16x16x32_bf16 v[112:115], v[48:51], v[216:219], v[112:115]
  ds_read_b64_tr_b16 v[212:213], v23 offset:32768
  v_mfma_f32_16x16x32_bf16 v[116:119], v[52:55], v[216:219], v[116:119]
  ds_read_b64_tr_b16 v[214:215], v23 offset:40960
  v_mfma_f32_16x16x32_bf16 v[120:123], v[56:59], v[216:219], v[120:123]
  v_mfma_f32_16x16x32_bf16 v[124:127], v[60:63], v[216:219], v[124:127]
  s_waitcnt lgkmcnt(10)
  v_mfma_f32_16x16x32_bf16 v[128:131], v[48:51], v[220:223], v[128:131]
  ds_read_b64_tr_b16 v[216:217], v24 offset:32768
  v_mfma_f32_16x16x32_bf16 v[132:135], v[52:55], v[220:223], v[132:135]
  ds_read_b64_tr_b16 v[218:219], v24 offset:40960
  v_mfma_f32_16x16x32_bf16 v[136:139], v[56:59], v[220:223], v[136:139]
  v_mfma_f32_16x16x32_bf16 v[140:143], v[60:63], v[220:223], v[140:143]
  s_waitcnt lgkmcnt(6)
  v_mfma_f32_16x16x32_bf16 v[64:67], v[32:35], v[204:207], v[64:67]
  ds_read_b64_tr_b16 v[220:221], v25 offset:32768
  v_mfma_f32_16x16x32_bf16 v[68:71], v[36:39], v[204:207], v[68:71]
  ds_read_b64_tr_b16 v[222:223], v25 offset:40960
  v_mfma_f32_16x16x32_bf16 v[72:75], v[40:43], v[204:207], v[72:75]
  ds_read_b128 v[144:147], v248 offset:0
  v_mfma_f32_16x16x32_bf16 v[76:79], v[44:47], v[204:207], v[76:79]
  s_waitcnt lgkmcnt(7)
  s_barrier
  v_mfma_f32_16x16x32_bf16 v[80:83], v[32:35], v[208:211], v[80:83]
  ds_read_b128 v[48:51], v27 offset:32768
  v_mfma_f32_16x16x32_bf16 v[84:87], v[36:39], v[208:211], v[84:87]
  ds_read_b128 v[52:55], v27 offset:34816
  v_mfma_f32_16x16x32_bf16 v[88:91], v[40:43], v[208:211], v[88:91]
  v_subrev_u32 v21, 49152, v21
  v_mfma_f32_16x16x32_bf16 v[92:95], v[44:47], v[208:211], v[92:95]
  v_subrev_u32 v22, 49152, v22
  s_waitcnt lgkmcnt(7)
  v_mfma_f32_16x16x32_bf16 v[96:99], v[32:35], v[212:215], v[96:99]
  v_subrev_u32 v23, 49152, v23
  v_mfma_f32_16x16x32_bf16 v[100:103], v[36:39], v[212:215], v[100:103]
  v_subrev_u32 v24, 49152, v24
  v_mfma_f32_16x16x32_bf16 v[104:107], v[40:43], v[212:215], v[104:107]
  v_subrev_u32 v25, 49152, v25
  v_mfma_f32_16x16x32_bf16 v[108:111], v[44:47], v[212:215], v[108:111]
  ds_read_b64_tr_b16 v[204:205], v21 offset:0
  s_waitcnt lgkmcnt(6)
  v_mfma_f32_16x16x32_bf16 v[112:115], v[32:35], v[216:219], v[112:115]
  ds_read_b64_tr_b16 v[206:207], v21 offset:8192
  v_mfma_f32_16x16x32_bf16 v[116:119], v[36:39], v[216:219], v[116:119]
  ds_read_b128 v[148:151], v248 offset:16
  v_mfma_f32_16x16x32_bf16 v[120:123], v[40:43], v[216:219], v[120:123]
  ds_read_b128 v[56:59], v27 offset:36864
  v_mfma_f32_16x16x32_bf16 v[124:127], v[44:47], v[216:219], v[124:127]
  ds_read_b128 v[60:63], v27 offset:38912
  s_waitcnt lgkmcnt(8)
  v_mfma_f32_16x16x32_bf16 v[128:131], v[32:35], v[220:223], v[128:131]
  ds_read_b64_tr_b16 v[208:209], v22 offset:0
  v_mfma_f32_16x16x32_bf16 v[132:135], v[36:39], v[220:223], v[132:135]
  ds_read_b64_tr_b16 v[210:211], v22 offset:8192
  v_mfma_f32_16x16x32_bf16 v[136:139], v[40:43], v[220:223], v[136:139]
  ds_read_b128 v[152:155], v248 offset:32
  v_mfma_f32_16x16x32_bf16 v[140:143], v[44:47], v[220:223], v[140:143]
  ds_read_b64_tr_b16 v[212:213], v23 offset:0
  s_waitcnt lgkmcnt(4)
  v_mfma_f32_16x16x32_bf16 v[64:67], v[48:51], v[204:207], v[64:67]
  ds_read_b64_tr_b16 v[214:215], v23 offset:8192
  v_mfma_f32_16x16x32_bf16 v[68:71], v[52:55], v[204:207], v[68:71]
  ds_read_b128 v[156:159], v248 offset:192
  v_mfma_f32_16x16x32_bf16 v[72:75], v[56:59], v[204:207], v[72:75]
  ds_read_b64_tr_b16 v[216:217], v24 offset:0
  v_mfma_f32_16x16x32_bf16 v[76:79], v[60:63], v[204:207], v[76:79]
  ds_read_b64_tr_b16 v[218:219], v24 offset:8192
  s_waitcnt lgkmcnt(6)
  ds_read_b128 v[160:163], v248 offset:208
  ds_read_b64_tr_b16 v[220:221], v25 offset:0
  ds_read_b64_tr_b16 v[222:223], v25 offset:8192
  ds_read_b128 v[164:167], v248 offset:224
  s_barrier
  v_mfma_f32_16x16x32_bf16 v[80:83], v[48:51], v[208:211], v[80:83]
  ds_read_b128 v[32:35], v26 offset:0
  v_mfma_f32_16x16x32_bf16 v[84:87], v[52:55], v[208:211], v[84:87]
  ds_read_b128 v[36:39], v26 offset:2048
  v_mfma_f32_16x16x32_bf16 v[88:91], v[56:59], v[208:211], v[88:91]
  ds_read_b64_tr_b16 v[204:205], v21 offset:16384
  v_mfma_f32_16x16x32_bf16 v[92:95], v[60:63], v[208:211], v[92:95]
  ds_read_b64_tr_b16 v[206:207], v21 offset:24576
  s_waitcnt lgkmcnt(11)
  v_mfma_f32_16x16x32_bf16 v[96:99], v[48:51], v[212:215], v[96:99]
  ds_read_b128 v[168:171], v248 offset:384
  v_mfma_f32_16x16x32_bf16 v[100:103], v[52:55], v[212:215], v[100:103]
  ds_read_b128 v[40:43], v26 offset:4096
  v_mfma_f32_16x16x32_bf16 v[104:107], v[56:59], v[212:215], v[104:107]
  ds_read_b128 v[44:47], v26 offset:6144
  v_mfma_f32_16x16x32_bf16 v[108:111], v[60:63], v[212:215], v[108:111]
  ds_read_b64_tr_b16 v[208:209], v22 offset:16384
  s_waitcnt lgkmcnt(12)
  v_mfma_f32_16x16x32_bf16 v[112:115], v[48:51], v[216:219], v[112:115]
  ds_read_b64_tr_b16 v[210:211], v22 offset:24576
  v_mfma_f32_16x16x32_bf16 v[116:119], v[52:55], v[216:219], v[116:119]
  ds_read_b128 v[172:175], v248 offset:400
  v_mfma_f32_16x16x32_bf16 v[120:123], v[56:59], v[216:219], v[120:123]
  ds_read_b64_tr_b16 v[212:213], v23 offset:16384
  v_mfma_f32_16x16x32_bf16 v[124:127], v[60:63], v[216:219], v[124:127]
  ds_read_b64_tr_b16 v[214:215], v23 offset:24576
  s_waitcnt lgkmcnt(13)
  v_mfma_f32_16x16x32_bf16 v[128:131], v[48:51], v[220:223], v[128:131]
  ds_read_b128 v[176:179], v248 offset:416
  v_mfma_f32_16x16x32_bf16 v[132:135], v[52:55], v[220:223], v[132:135]
  ds_read_b64_tr_b16 v[216:217], v24 offset:16384
  v_mfma_f32_16x16x32_bf16 v[136:139], v[56:59], v[220:223], v[136:139]
  ds_read_b64_tr_b16 v[218:219], v24 offset:24576
  v_mfma_f32_16x16x32_bf16 v[140:143], v[60:63], v[220:223], v[140:143]
  ds_read_b128 v[180:183], v248 offset:576
  s_waitcnt lgkmcnt(9)
  v_mfma_f32_16x16x32_bf16 v[64:67], v[32:35], v[204:207], v[64:67]
  ds_read_b64_tr_b16 v[220:221], v25 offset:16384
  v_mfma_f32_16x16x32_bf16 v[68:71], v[36:39], v[204:207], v[68:71]
  ds_read_b64_tr_b16 v[222:223], v25 offset:24576
  v_mfma_f32_16x16x32_bf16 v[72:75], v[40:43], v[204:207], v[72:75]
  ds_read_b128 v[184:187], v248 offset:592
  v_mfma_f32_16x16x32_bf16 v[76:79], v[44:47], v[204:207], v[76:79]
  s_waitcnt lgkmcnt(10)
  s_barrier
  v_mfma_f32_16x16x32_bf16 v[80:83], v[32:35], v[208:211], v[80:83]
  ds_read_b128 v[48:51], v27 offset:0
  v_mfma_f32_16x16x32_bf16 v[84:87], v[36:39], v[208:211], v[84:87]
  ds_read_b128 v[52:55], v27 offset:2048
  v_mfma_f32_16x16x32_bf16 v[88:91], v[40:43], v[208:211], v[88:91]
  ds_read_b64_tr_b16 v[204:205], v21 offset:32768
  v_mfma_f32_16x16x32_bf16 v[92:95], v[44:47], v[208:211], v[92:95]
  ds_read_b64_tr_b16 v[206:207], v21 offset:40960
  s_waitcnt lgkmcnt(11)
  v_mfma_f32_16x16x32_bf16 v[96:99], v[32:35], v[212:215], v[96:99]
  ds_read_b128 v[188:191], v248 offset:608
  v_mfma_f32_16x16x32_bf16 v[100:103], v[36:39], v[212:215], v[100:103]
  ds_read_b128 v[56:59], v27 offset:4096
  v_mfma_f32_16x16x32_bf16 v[104:107], v[40:43], v[212:215], v[104:107]
  ds_read_b128 v[60:63], v27 offset:6144
  v_mfma_f32_16x16x32_bf16 v[108:111], v[44:47], v[212:215], v[108:111]
  ds_read_b64_tr_b16 v[208:209], v22 offset:32768
  s_waitcnt lgkmcnt(12)
  v_mfma_f32_16x16x32_bf16 v[112:115], v[32:35], v[216:219], v[112:115]
  ds_read_b64_tr_b16 v[210:211], v22 offset:40960
  v_mfma_f32_16x16x32_bf16 v[116:119], v[36:39], v[216:219], v[116:119]
  ds_read_b128 v[192:195], v248 offset:768
  v_mfma_f32_16x16x32_bf16 v[120:123], v[40:43], v[216:219], v[120:123]
  ds_read_b64_tr_b16 v[212:213], v23 offset:32768
  v_mfma_f32_16x16x32_bf16 v[124:127], v[44:47], v[216:219], v[124:127]
  ds_read_b64_tr_b16 v[214:215], v23 offset:40960
  s_waitcnt lgkmcnt(13)
  v_mfma_f32_16x16x32_bf16 v[128:131], v[32:35], v[220:223], v[128:131]
  ds_read_b128 v[196:199], v248 offset:784
  v_mfma_f32_16x16x32_bf16 v[132:135], v[36:39], v[220:223], v[132:135]
  ds_read_b64_tr_b16 v[216:217], v24 offset:32768
  v_mfma_f32_16x16x32_bf16 v[136:139], v[40:43], v[220:223], v[136:139]
  ds_read_b64_tr_b16 v[218:219], v24 offset:40960
  v_mfma_f32_16x16x32_bf16 v[140:143], v[44:47], v[220:223], v[140:143]
  ds_read_b128 v[200:203], v248 offset:800
  s_waitcnt lgkmcnt(9)
  v_mfma_f32_16x16x32_bf16 v[64:67], v[48:51], v[204:207], v[64:67]
  ds_read_b64_tr_b16 v[220:221], v25 offset:32768
  v_mfma_f32_16x16x32_bf16 v[68:71], v[52:55], v[204:207], v[68:71]
  ds_read_b64_tr_b16 v[222:223], v25 offset:40960
  v_mfma_f32_16x16x32_bf16 v[72:75], v[56:59], v[204:207], v[72:75]
  v_mfma_f32_16x16x32_bf16 v[76:79], v[60:63], v[204:207], v[76:79]
  s_waitcnt lgkmcnt(9)
  s_barrier
  s_waitcnt vmcnt(0)
  v_readfirstlane_b32 s80, v12
  v_readfirstlane_b32 s81, v13
  s_mov_b32 s59, 0
  s_cmp_lg_u32 s80, 0
  s_nop 2
  s_cbranch_scc1 L_non2d
L_non2:
  v_mov_b32 v9, 0
  buffer_load_dwordx2 v[12:13], v9, s[28:31], 0 offen sc1
  s_waitcnt vmcnt(0)
  v_readfirstlane_b32 s80, v12
  v_readfirstlane_b32 s81, v13
  s_add_u32 s59, s59, 1
  s_cmp_gt_u32 s59, 100000
  s_nop 2
  s_cbranch_scc1 L_non2d
  s_cmp_eq_u32 s80, 0
  s_cbranch_scc1 L_non2
L_non2d:
  s_bfe_u32 s51, s2, 0x30004
  s_lshl_b32 s51, s51, 10
  s_lshr_b32 s50, s2, 7
  s_lshl_b32 s50, s50, 9
  s_add_u32 s51, s51, s50
  s_and_b32 s50, s2, 15
  s_lshl_b32 s50, s50, 5
  s_add_u32 s51, s51, s50
  s_lshl_b32 s50, s98, 3
  s_add_u32 s51, s51, s50
  s_add_u32 s48, s51, 13631488
  v_mov_b32 v10, s80
  v_mov_b32 v11, s81
  v_lshlrev_b32 v9, 9, v1
  s_waitcnt vmcnt(0)
  s_mov_b64 exec, 1
  buffer_store_dwordx2 v[10:11], v9, s[12:15], s48 offen sc1
  s_mov_b64 exec, -1
  v_mfma_f32_16x16x32_bf16 v[80:83], v[48:51], v[208:211], v[80:83]
  ds_read_b128 v[32:35], v26 offset:16384
  v_mfma_f32_16x16x32_bf16 v[84:87], v[52:55], v[208:211], v[84:87]
  ds_read_b128 v[36:39], v26 offset:18432
  v_mfma_f32_16x16x32_bf16 v[88:91], v[56:59], v[208:211], v[88:91]
  v_add_u32 v21, 49152, v21
  v_mfma_f32_16x16x32_bf16 v[92:95], v[60:63], v[208:211], v[92:95]
  v_add_u32 v22, 49152, v22
  s_waitcnt lgkmcnt(8)
  v_mfma_f32_16x16x32_bf16 v[96:99], v[48:51], v[212:215], v[96:99]
  v_add_u32 v23, 49152, v23
  v_mfma_f32_16x16x32_bf16 v[100:103], v[52:55], v[212:215], v[100:103]
  v_add_u32 v24, 49152, v24
  v_mfma_f32_16x16x32_bf16 v[104:107], v[56:59], v[212:215], v[104:107]
  v_add_u32 v25, 49152, v25
  v_mfma_f32_16x16x32_bf16 v[108:111], v[60:63], v[212:215], v[108:111]
  ds_read_b64_tr_b16 v[204:205], v21 offset:0
  s_waitcnt lgkmcnt(6)
  v_mfma_f32_16x16x32_bf16 v[112:115], v[48:51], v[216:219], v[112:115]
  ds_read_b64_tr_b16 v[206:207], v21 offset:8192
  v_mfma_f32_16x16x32_bf16 v[116:119], v[52:55], v[216:219], v[116:119]
  ds_read_b128 v[40:43], v26 offset:20480
  v_mfma_f32_16x16x32_bf16 v[120:123], v[56:59], v[216:219], v[120:123]
  ds_read_b128 v[44:47], v26 offset:22528
  v_mfma_f32_16x16x32_bf16 v[124:127], v[60:63], v[216:219], v[124:127]
  ds_read_b64_tr_b16 v[208:209], v22 offset:0
  s_waitcnt lgkmcnt(7)
  v_mfma_f32_16x16x32_bf16 v[128:131], v[48:51], v[220:223], v[128:131]
  ds_read_b64_tr_b16 v[210:211], v22 offset:8192
  v_mfma_f32_16x16x32_bf16 v[132:135], v[52:55], v[220:223], v[132:135]
  ds_read_b64_tr_b16 v[212:213], v23 offset:0
  v_mfma_f32_16x16x32_bf16 v[136:139], v[56:59], v[220:223], v[136:139]
  ds_read_b64_tr_b16 v[214:215], v23 offset:8192
  v_mfma_f32_16x16x32_bf16 v[140:143], v[60:63], v[220:223], v[140:143]
  ds_read_b64_tr_b16 v[216:217], v24 offset:0
  s_waitcnt lgkmcnt(5)
  v_mfma_f32_16x16x32_bf16 v[64:67], v[32:35], v[204:207], v[64:67]
  ds_read_b64_tr_b16 v[218:219], v24 offset:8192
  v_mfma_f32_16x16x32_bf16 v[68:71], v[36:39], v[204:207], v[68:71]
  ds_read_b64_tr_b16 v[220:221], v25 offset:0
  v_mfma_f32_16x16x32_bf16 v[72:75], v[40:43], v[204:207], v[72:75]
  ds_read_b64_tr_b16 v[222:223], v25 offset:8192
  v_mfma_f32_16x16x32_bf16 v[76:79], v[44:47], v[204:207], v[76:79]
  s_waitcnt lgkmcnt(6)
  s_barrier
  v_mfma_f32_16x16x32_bf16 v[80:83], v[32:35], v[208:211], v[80:83]
  ds_read_b128 v[48:51], v27 offset:16384
  v_mfma_f32_16x16x32_bf16 v[84:87], v[36:39], v[208:211], v[84:87]
  ds_read_b128 v[52:55], v27 offset:18432
  v_mfma_f32_16x16x32_bf16 v[88:91], v[40:43], v[208:211], v[88:91]
  ds_read_b64_tr_b16 v[204:205], v21 offset:16384
  v_mfma_f32_16x16x32_bf16 v[92:95], v[44:47], v[208:211], v[92:95]
  ds_read_b64_tr_b16 v[206:207], v21 offset:24576
  s_waitcnt lgkmcnt(8)
  v_mfma_f32_16x16x32_bf16 v[96:99], v[32:35], v[212:215], v[96:99]
  ds_read_b128 v[56:59], v27 offset:20480
  v_mfma_f32_16x16x32_bf16 v[100:103], v[36:39], v[212:215], v[100:103]
  ds_read_b128 v[60:63], v27 offset:22528
  v_mfma_f32_16x16x32_bf16 v[104:107], v[40:43], v[212:215], v[104:107]
  ds_read_b64_tr_b16 v[208:209], v22 offset:16384
  v_mfma_f32_16x16x32_bf16 v[108:111], v[44:47], v[212:215], v[108:111]
  ds_read_b64_tr_b16 v[210:211], v22 offset:24576
  s_waitcnt lgkmcnt(10)
  v_mfma_f32_16x16x32_bf16 v[112:115], v[32:35], v[216:219], v[112:115]
  ds_read_b64_tr_b16 v[212:213], v23 offset:16384
  v_mfma_f32_16x16x32_bf16 v[116:119], v[36:39], v[216:219], v[116:119]
  ds_read_b64_tr_b16 v[214:215], v23 offset:24576
  v_mfma_f32_16x16x32_bf16 v[120:123], v[40:43], v[216:219], v[120:123]
  v_mfma_f32_16x16x32_bf16 v[124:127], v[44:47], v[216:219], v[124:127]
  s_waitcnt lgkmcnt(10)
  v_mfma_f32_16x16x32_bf16 v[128:131], v[32:35], v[220:223], v[128:131]
  ds_read_b64_tr_b16 v[216:217], v24 offset:16384
  v_mfma_f32_16x16x32_bf16 v[132:135], v[36:39], v[220:223], v[132:135]
  ds_read_b64_tr_b16 v[218:219], v24 offset:24576
  v_mfma_f32_16x16x32_bf16 v[136:139], v[40:43], v[220:223], v[136:139]
  v_mfma_f32_16x16x32_bf16 v[140:143], v[44:47], v[220:223], v[140:143]
  s_waitcnt lgkmcnt(6)
  v_mfma_f32_16x16x32_bf16 v[64:67], v[48:51], v[204:207], v[64:67]
  ds_read_b64_tr_b16 v[220:221], v25 offset:16384
  v_mfma_f32_16x16x32_bf16 v[68:71], v[52:55], v[204:207], v[68:71]
  ds_read_b64_tr_b16 v[222:223], v25 offset:24576
  v_mfma_f32_16x16x32_bf16 v[72:75], v[56:59], v[204:207], v[72:75]
  v_mfma_f32_16x16x32_bf16 v[76:79], v[60:63], v[204:207], v[76:79]
  s_waitcnt lgkmcnt(6)
  s_barrier
  v_mfma_f32_16x16x32_bf16 v[80:83], v[48:51], v[208:211], v[80:83]
  ds_read_b128 v[32:35], v26 offset:32768
  v_mfma_f32_16x16x32_bf16 v[84:87], v[52:55], v[208:211], v[84:87]
  ds_read_b128 v[36:39], v26 offset:34816
  v_mfma_f32_16x16x32_bf16 v[88:91], v[56:59], v[208:211], v[88:91]
  ds_read_b64_tr_b16 v[204:205], v21 offset:32768
  v_mfma_f32_16x16x32_bf16 v[92:95], v[60:63], v[208:211], v[92:95]
  ds_read_b64_tr_b16 v[206:207], v21 offset:40960
  s_waitcnt lgkmcnt(8)
  v_mfma_f32_16x16x32_bf16 v[96:99], v[48:51], v[212:215], v[96:99]
  ds_read_b128 v[40:43], v26 offset:36864
  v_mfma_f32_16x16x32_bf16 v[100:103], v[52:55], v[212:215], v[100:103]
  ds_read_b128 v[44:47], v26 offset:38912
  v_mfma_f32_16x16x32_bf16 v[104:107], v[56:59], v[212:215], v[104:107]
  ds_read_b64_tr_b16 v[208:209], v22 offset:32768
  v_mfma_f32_16x16x32_bf16 v[108:111], v[60:63], v[212:215], v[108:111]
  ds_read_b64_tr_b16 v[210:211], v22 offset:40960
  s_waitcnt lgkmcnt(10)
  v_mfma_f32_16x16x32_bf16 v[112:115], v[48:51], v[216:219], v[112:115]
  ds_read_b64_tr_b16 v[212:213], v23 offset:32768
  v_mfma_f32_16x16x32_bf16 v[116:119], v[52:55], v[216:219], v[116:119]
  ds_read_b64_tr_b16 v[214:215], v23 offset:40960
  v_mfma_f32_16x16x32_bf16 v[120:123], v[56:59], v[216:219], v[120:123]
  v_mfma_f32_16x16x32_bf16 v[124:127], v[60:63], v[216:219], v[124:127]
  s_waitcnt lgkmcnt(10)
  v_mfma_f32_16x16x32_bf16 v[128:131], v[48:51], v[220:223], v[128:131]
  ds_read_b64_tr_b16 v[216:217], v24 offset:32768
  v_mfma_f32_16x16x32_bf16 v[132:135], v[52:55], v[220:223], v[132:135]
  ds_read_b64_tr_b16 v[218:219], v24 offset:40960
  v_mfma_f32_16x16x32_bf16 v[136:139], v[56:59], v[220:223], v[136:139]
  v_mfma_f32_16x16x32_bf16 v[140:143], v[60:63], v[220:223], v[140:143]
  s_waitcnt lgkmcnt(6)
  v_mfma_f32_16x16x32_bf16 v[64:67], v[32:35], v[204:207], v[64:67]
  ds_read_b64_tr_b16 v[220:221], v25 offset:32768
  v_mfma_f32_16x16x32_bf16 v[68:71], v[36:39], v[204:207], v[68:71]
  ds_read_b64_tr_b16 v[222:223], v25 offset:40960
  v_mfma_f32_16x16x32_bf16 v[72:75], v[40:43], v[204:207], v[72:75]
  v_mfma_f32_16x16x32_bf16 v[76:79], v[44:47], v[204:207], v[76:79]
  s_waitcnt lgkmcnt(6)
  s_barrier
  v_mfma_f32_16x16x32_bf16 v[80:83], v[32:35], v[208:211], v[80:83]
  ds_read_b128 v[48:51], v27 offset:32768
  v_mfma_f32_16x16x32_bf16 v[84:87], v[36:39], v[208:211], v[84:87]
  ds_read_b128 v[52:55], v27 offset:34816
  v_mfma_f32_16x16x32_bf16 v[88:91], v[40:43], v[208:211], v[88:91]
  v_subrev_u32 v21, 49152, v21
  v_mfma_f32_16x16x32_bf16 v[92:95], v[44:47], v[208:211], v[92:95]
  v_subrev_u32 v22, 49152, v22
  s_waitcnt lgkmcnt(6)
  v_mfma_f32_16x16x32_bf16 v[96:99], v[32:35], v[212:215], v[96:99]
  v_subrev_u32 v23, 49152, v23
  v_mfma_f32_16x16x32_bf16 v[100:103], v[36:39], v[212:215], v[100:103]
  v_subrev_u32 v24, 49152, v24
  v_mfma_f32_16x16x32_bf16 v[104:107], v[40:43], v[212:215], v[104:107]
  v_subrev_u32 v25, 49152, v25
  v_mfma_f32_16x16x32_bf16 v[108:111], v[44:47], v[212:215], v[108:111]
  ds_read_b64_tr_b16 v[204:205], v21 offset:0
  s_waitcnt lgkmcnt(5)
  v_mfma_f32_16x16x32_bf16 v[112:115], v[32:35], v[216:219], v[112:115]
  ds_read_b64_tr_b16 v[206:207], v21 offset:8192
  v_mfma_f32_16x16x32_bf16 v[116:119], v[36:39], v[216:219], v[116:119]
  ds_read_b128 v[56:59], v27 offset:36864
  v_mfma_f32_16x16x32_bf16 v[120:123], v[40:43], v[216:219], v[120:123]
  ds_read_b128 v[60:63], v27 offset:38912
  v_mfma_f32_16x16x32_bf16 v[124:127], v[44:47], v[216:219], v[124:127]
  ds_read_b64_tr_b16 v[208:209], v22 offset:0
  s_waitcnt lgkmcnt(7)
  v_mfma_f32_16x16x32_bf16 v[128:131], v[32:35], v[220:223], v[128:131]
  ds_read_b64_tr_b16 v[210:211], v22 offset:8192
  v_mfma_f32_16x16x32_bf16 v[132:135], v[36:39], v[220:223], v[132:135]
  ds_read_b64_tr_b16 v[212:213], v23 offset:0
  v_mfma_f32_16x16x32_bf16 v[136:139], v[40:43], v[220:223], v[136:139]
  ds_read_b64_tr_b16 v[214:215], v23 offset:8192
  v_mfma_f32_16x16x32_bf16 v[140:143], v[44:47], v[220:223], v[140:143]
  ds_read_b64_tr_b16 v[216:217], v24 offset:0
  s_waitcnt lgkmcnt(5)
  v_mfma_f32_16x16x32_bf16 v[64:67], v[48:51], v[204:207], v[64:67]
  ds_read_b64_tr_b16 v[218:219], v24 offset:8192
  v_mfma_f32_16x16x32_bf16 v[68:71], v[52:55], v[204:207], v[68:71]
  ds_read_b64_tr_b16 v[220:221], v25 offset:0
  v_mfma_f32_16x16x32_bf16 v[72:75], v[56:59], v[204:207], v[72:75]
  ds_read_b64_tr_b16 v[222:223], v25 offset:8192
  v_mfma_f32_16x16x32_bf16 v[76:79], v[60:63], v[204:207], v[76:79]
  s_waitcnt lgkmcnt(6)
  s_barrier
  v_mfma_f32_16x16x32_bf16 v[80:83], v[48:51], v[208:211], v[80:83]
  ds_read_b128 v[32:35], v26 offset:0
  v_mfma_f32_16x16x32_bf16 v[84:87], v[52:55], v[208:211], v[84:87]
  ds_read_b128 v[36:39], v26 offset:2048
  v_mfma_f32_16x16x32_bf16 v[88:91], v[56:59], v[208:211], v[88:91]
  ds_read_b64_tr_b16 v[204:205], v21 offset:16384
  v_mfma_f32_16x16x32_bf16 v[92:95], v[60:63], v[208:211], v[92:95]
  ds_read_b64_tr_b16 v[206:207], v21 offset:24576
  s_waitcnt lgkmcnt(8)
  v_mfma_f32_16x16x32_bf16 v[96:99], v[48:51], v[212:215], v[96:99]
  ds_read_b128 v[40:43], v26 offset:4096
  v_mfma_f32_16x16x32_bf16 v[100:103], v[52:55], v[212:215], v[100:103]
  ds_read_b128 v[44:47], v26 offset:6144
  v_mfma_f32_16x16x32_bf16 v[104:107], v[56:59], v[212:215], v[104:107]
  ds_read_b64_tr_b16 v[208:209], v22 offset:16384
  v_mfma_f32_16x16x32_bf16 v[108:111], v[60:63], v[212:215], v[108:111]
  ds_read_b64_tr_b16 v[210:211], v22 offset:24576
  s_waitcnt lgkmcnt(10)
  v_mfma_f32_16x16x32_bf16 v[112:115], v[48:51], v[216:219], v[112:115]
  ds_read_b64_tr_b16 v[212:213], v23 offset:16384
  v_mfma_f32_16x16x32_bf16 v[116:119], v[52:55], v[216:219], v[116:119]
  ds_read_b64_tr_b16 v[214:215], v23 offset:24576
  v_mfma_f32_16x16x32_bf16 v[120:123], v[56:59], v[216:219], v[120:123]
  v_mfma_f32_16x16x32_bf16 v[124:127], v[60:63], v[216:219], v[124:127]
  s_waitcnt lgkmcnt(10)
  v_mfma_f32_16x16x32_bf16 v[128:131], v[48:51], v[220:223], v[128:131]
  ds_read_b64_tr_b16 v[216:217], v24 offset:16384
  v_mfma_f32_16x16x32_bf16 v[132:135], v[52:55], v[220:223], v[132:135]
  ds_read_b64_tr_b16 v[218:219], v24 offset:24576
  v_mfma_f32_16x16x32_bf16 v[136:139], v[56:59], v[220:223], v[136:139]
  v_mfma_f32_16x16x32_bf16 v[140:143], v[60:63], v[220:223], v[140:143]
  s_waitcnt lgkmcnt(6)
  v_mfma_f32_16x16x32_bf16 v[64:67], v[32:35], v[204:207], v[64:67]
  ds_read_b64_tr_b16 v[220:221], v25 offset:16384
  v_mfma_f32_16x16x32_bf16 v[68:71], v[36:39], v[204:207], v[68:71]
  ds_read_b64_tr_b16 v[222:223], v25 offset:24576
  v_mfma_f32_16x16x32_bf16 v[72:75], v[40:43], v[204:207], v[72:75]
  v_mfma_f32_16x16x32_bf16 v[76:79], v[44:47], v[204:207], v[76:79]
  s_waitcnt lgkmcnt(6)
  s_barrier
  v_mfma_f32_16x16x32_bf16 v[80:83], v[32:35], v[208:211], v[80:83]
  ds_read_b128 v[48:51], v27 offset:0
  v_mfma_f32_16x16x32_bf16 v[84:87], v[36:39], v[208:211], v[84:87]
  ds_read_b128 v[52:55], v27 offset:2048
  v_mfma_f32_16x16x32_bf16 v[88:91], v[40:43], v[208:211], v[88:91]
  ds_read_b64_tr_b16 v[204:205], v21 offset:32768
  v_mfma_f32_16x16x32_bf16 v[92:95], v[44:47], v[208:211], v[92:95]
  ds_read_b64_tr_b16 v[206:207], v21 offset:40960
  s_waitcnt lgkmcnt(8)
  v_mfma_f32_16x16x32_bf16 v[96:99], v[32:35], v[212:215], v[96:99]
  ds_read_b128 v[56:59], v27 offset:4096
  v_mfma_f32_16x16x32_bf16 v[100:103], v[36:39], v[212:215], v[100:103]
  ds_read_b128 v[60:63], v27 offset:6144
  v_mfma_f32_16x16x32_bf16 v[104:107], v[40:43], v[212:215], v[104:107]
  ds_read_b64_tr_b16 v[208:209], v22 offset:32768
  v_mfma_f32_16x16x32_bf16 v[108:111], v[44:47], v[212:215], v[108:111]
  ds_read_b64_tr_b16 v[210:211], v22 offset:40960
  s_waitcnt lgkmcnt(10)
  v_mfma_f32_16x16x32_bf16 v[112:115], v[32:35], v[216:219], v[112:115]
  ds_read_b64_tr_b16 v[212:213], v23 offset:32768
  v_mfma_f32_16x16x32_bf16 v[116:119], v[36:39], v[216:219], v[116:119]
  ds_read_b64_tr_b16 v[214:215], v23 offset:40960
  v_mfma_f32_16x16x32_bf16 v[120:123], v[40:43], v[216:219], v[120:123]
  v_mfma_f32_16x16x32_bf16 v[124:127], v[44:47], v[216:219], v[124:127]
  s_waitcnt lgkmcnt(10)
  v_mfma_f32_16x16x32_bf16 v[128:131], v[32:35], v[220:223], v[128:131]
  ds_read_b64_tr_b16 v[216:217], v24 offset:32768
  v_mfma_f32_16x16x32_bf16 v[132:135], v[36:39], v[220:223], v[132:135]
  ds_read_b64_tr_b16 v[218:219], v24 offset:40960
  v_mfma_f32_16x16x32_bf16 v[136:139], v[40:43], v[220:223], v[136:139]
  v_mfma_f32_16x16x32_bf16 v[140:143], v[44:47], v[220:223], v[140:143]
  s_waitcnt lgkmcnt(6)
  v_mfma_f32_16x16x32_bf16 v[64:67], v[48:51], v[204:207], v[64:67]
  ds_read_b64_tr_b16 v[220:221], v25 offset:32768
  v_mfma_f32_16x16x32_bf16 v[68:71], v[52:55], v[204:207], v[68:71]
  ds_read_b64_tr_b16 v[222:223], v25 offset:40960
  v_mfma_f32_16x16x32_bf16 v[72:75], v[56:59], v[204:207], v[72:75]
  v_mfma_f32_16x16x32_bf16 v[76:79], v[60:63], v[204:207], v[76:79]
  s_waitcnt lgkmcnt(6)
  s_barrier
  v_mfma_f32_16x16x32_bf16 v[80:83], v[48:51], v[208:211], v[80:83]
  ds_read_b128 v[32:35], v26 offset:16384
  v_mfma_f32_16x16x32_bf16 v[84:87], v[52:55], v[208:211], v[84:87]
  ds_read_b128 v[36:39], v26 offset:18432
  v_mfma_f32_16x16x32_bf16 v[88:91], v[56:59], v[208:211], v[88:91]
  v_add_u32 v21, 49152, v21
  v_mfma_f32_16x16x32_bf16 v[92:95], v[60:63], v[208:211], v[92:95]
  v_add_u32 v22, 49152, v22
  s_waitcnt lgkmcnt(6)
  v_mfma_f32_16x16x32_bf16 v[96:99], v[48:51], v[212:215], v[96:99]
  v_add_u32 v23, 49152, v23
  v_mfma_f32_16x16x32_bf16 v[100:103], v[52:55], v[212:215], v[100:103]
  v_add_u32 v24, 49152, v24
  v_mfma_f32_16x16x32_bf16 v[104:107], v[56:59], v[212:215], v[104:107]
  v_add_u32 v25, 49152, v25
  v_mfma_f32_16x16x32_bf16 v[108:111], v[60:63], v[212:215], v[108:111]
  ds_read_b64_tr_b16 v[204:205], v21 offset:0
  s_waitcnt lgkmcnt(5)
  v_mfma_f32_16x16x32_bf16 v[112:115], v[48:51], v[216:219], v[112:115]
  ds_read_b64_tr_b16 v[206:207], v21 offset:8192
  v_mfma_f32_16x16x32_bf16 v[116:119], v[52:55], v[216:219], v[116:119]
  ds_read_b128 v[40:43], v26 offset:20480
  v_mfma_f32_16x16x32_bf16 v[120:123], v[56:59], v[216:219], v[120:123]
  ds_read_b128 v[44:47], v26 offset:22528
  v_mfma_f32_16x16x32_bf16 v[124:127], v[60:63], v[216:219], v[124:127]
  ds_read_b64_tr_b16 v[208:209], v22 offset:0
  s_waitcnt lgkmcnt(7)
  v_mfma_f32_16x16x32_bf16 v[128:131], v[48:51], v[220:223], v[128:131]
  ds_read_b64_tr_b16 v[210:211], v22 offset:8192
  v_mfma_f32_16x16x32_bf16 v[132:135], v[52:55], v[220:223], v[132:135]
  ds_read_b64_tr_b16 v[212:213], v23 offset:0
  v_mfma_f32_16x16x32_bf16 v[136:139], v[56:59], v[220:223], v[136:139]
  ds_read_b64_tr_b16 v[214:215], v23 offset:8192
  v_mfma_f32_16x16x32_bf16 v[140:143], v[60:63], v[220:223], v[140:143]
  ds_read_b64_tr_b16 v[216:217], v24 offset:0
  s_waitcnt lgkmcnt(5)
  v_mfma_f32_16x16x32_bf16 v[64:67], v[32:35], v[204:207], v[64:67]
  ds_read_b64_tr_b16 v[218:219], v24 offset:8192
  v_mfma_f32_16x16x32_bf16 v[68:71], v[36:39], v[204:207], v[68:71]
  ds_read_b64_tr_b16 v[220:221], v25 offset:0
  v_mfma_f32_16x16x32_bf16 v[72:75], v[40:43], v[204:207], v[72:75]
  ds_read_b64_tr_b16 v[222:223], v25 offset:8192
  v_mfma_f32_16x16x32_bf16 v[76:79], v[44:47], v[204:207], v[76:79]
  s_waitcnt lgkmcnt(6)
  s_barrier
  v_mfma_f32_16x16x32_bf16 v[80:83], v[32:35], v[208:211], v[80:83]
  ds_read_b128 v[48:51], v27 offset:16384
  v_mfma_f32_16x16x32_bf16 v[84:87], v[36:39], v[208:211], v[84:87]
  ds_read_b128 v[52:55], v27 offset:18432
  v_mfma_f32_16x16x32_bf16 v[88:91], v[40:43], v[208:211], v[88:91]
  ds_read_b64_tr_b16 v[204:205], v21 offset:16384
  v_mfma_f32_16x16x32_bf16 v[92:95], v[44:47], v[208:211], v[92:95]
  ds_read_b64_tr_b16 v[206:207], v21 offset:24576
  s_waitcnt lgkmcnt(8)
  v_mfma_f32_16x16x32_bf16 v[96:99], v[32:35], v[212:215], v[96:99]
  ds_read_b128 v[56:59], v27 offset:20480
  v_mfma_f32_16x16x32_bf16 v[100:103], v[36:39], v[212:215], v[100:103]
  ds_read_b128 v[60:63], v27 offset:22528
  v_mfma_f32_16x16x32_bf16 v[104:107], v[40:43], v[212:215], v[104:107]
  ds_read_b64_tr_b16 v[208:209], v22 offset:16384
  v_mfma_f32_16x16x32_bf16 v[108:111], v[44:47], v[212:215], v[108:111]
  ds_read_b64_tr_b16 v[210:211], v22 offset:24576
  s_waitcnt lgkmcnt(10)
  v_mfma_f32_16x16x32_bf16 v[112:115], v[32:35], v[216:219], v[112:115]
  ds_read_b64_tr_b16 v[212:213], v23 offset:16384
  v_mfma_f32_16x16x32_bf16 v[116:119], v[36:39], v[216:219], v[116:119]
  ds_read_b64_tr_b16 v[214:215], v23 offset:24576
  v_mfma_f32_16x16x32_bf16 v[120:123], v[40:43], v[216:219], v[120:123]
  v_mfma_f32_16x16x32_bf16 v[124:127], v[44:47], v[216:219], v[124:127]
  s_waitcnt lgkmcnt(10)
  v_mfma_f32_16x16x32_bf16 v[128:131], v[32:35], v[220:223], v[128:131]
  ds_read_b64_tr_b16 v[216:217], v24 offset:16384
  v_mfma_f32_16x16x32_bf16 v[132:135], v[36:39], v[220:223], v[132:135]
  ds_read_b64_tr_b16 v[218:219], v24 offset:24576
  v_mfma_f32_16x16x32_bf16 v[136:139], v[40:43], v[220:223], v[136:139]
  v_mfma_f32_16x16x32_bf16 v[140:143], v[44:47], v[220:223], v[140:143]
  s_waitcnt lgkmcnt(6)
  v_mfma_f32_16x16x32_bf16 v[64:67], v[48:51], v[204:207], v[64:67]
  ds_read_b64_tr_b16 v[220:221], v25 offset:16384
  v_mfma_f32_16x16x32_bf16 v[68:71], v[52:55], v[204:207], v[68:71]
  ds_read_b64_tr_b16 v[222:223], v25 offset:24576
  v_mfma_f32_16x16x32_bf16 v[72:75], v[56:59], v[204:207], v[72:75]
  v_mfma_f32_16x16x32_bf16 v[76:79], v[60:63], v[204:207], v[76:79]
  s_waitcnt lgkmcnt(6)
  s_barrier
  v_mfma_f32_16x16x32_bf16 v[80:83], v[48:51], v[208:211], v[80:83]
  ds_read_b128 v[32:35], v26 offset:32768
  v_mfma_f32_16x16x32_bf16 v[84:87], v[52:55], v[208:211], v[84:87]
  ds_read_b128 v[36:39], v26 offset:34816
  v_mfma_f32_16x16x32_bf16 v[88:91], v[56:59], v[208:211], v[88:91]
  ds_read_b64_tr_b16 v[204:205], v21 offset:32768
  v_mfma_f32_16x16x32_bf16 v[92:95], v[60:63], v[208:211], v[92:95]
  ds_read_b64_tr_b16 v[206:207], v21 offset:40960
  s_waitcnt lgkmcnt(8)
  v_mfma_f32_16x16x32_bf16 v[96:99], v[48:51], v[212:215], v[96:99]
  ds_read_b128 v[40:43], v26 offset:36864
  v_mfma_f32_16x16x32_bf16 v[100:103], v[52:55], v[212:215], v[100:103]
  ds_read_b128 v[44:47], v26 offset:38912
  v_mfma_f32_16x16x32_bf16 v[104:107], v[56:59], v[212:215], v[104:107]
  ds_read_b64_tr_b16 v[208:209], v22 offset:32768
  v_mfma_f32_16x16x32_bf16 v[108:111], v[60:63], v[212:215], v[108:111]
  ds_read_b64_tr_b16 v[210:211], v22 offset:40960
  s_waitcnt lgkmcnt(10)
  v_mfma_f32_16x16x32_bf16 v[112:115], v[48:51], v[216:219], v[112:115]
  ds_read_b64_tr_b16 v[212:213], v23 offset:32768
  v_mfma_f32_16x16x32_bf16 v[116:119], v[52:55], v[216:219], v[116:119]
  ds_read_b64_tr_b16 v[214:215], v23 offset:40960
  v_mfma_f32_16x16x32_bf16 v[120:123], v[56:59], v[216:219], v[120:123]
  v_mfma_f32_16x16x32_bf16 v[124:127], v[60:63], v[216:219], v[124:127]
  s_waitcnt lgkmcnt(10)
  v_mfma_f32_16x16x32_bf16 v[128:131], v[48:51], v[220:223], v[128:131]
  ds_read_b64_tr_b16 v[216:217], v24 offset:32768
  v_mfma_f32_16x16x32_bf16 v[132:135], v[52:55], v[220:223], v[132:135]
  ds_read_b64_tr_b16 v[218:219], v24 offset:40960
  v_mfma_f32_16x16x32_bf16 v[136:139], v[56:59], v[220:223], v[136:139]
  v_mfma_f32_16x16x32_bf16 v[140:143], v[60:63], v[220:223], v[140:143]
  s_waitcnt lgkmcnt(6)
  v_mfma_f32_16x16x32_bf16 v[64:67], v[32:35], v[204:207], v[64:67]
  ds_read_b64_tr_b16 v[220:221], v25 offset:32768
  v_mfma_f32_16x16x32_bf16 v[68:71], v[36:39], v[204:207], v[68:71]
  ds_read_b64_tr_b16 v[222:223], v25 offset:40960
  v_mfma_f32_16x16x32_bf16 v[72:75], v[40:43], v[204:207], v[72:75]
  v_mfma_f32_16x16x32_bf16 v[76:79], v[44:47], v[204:207], v[76:79]
  s_waitcnt lgkmcnt(6)
  s_barrier
  v_mfma_f32_16x16x32_bf16 v[80:83], v[32:35], v[208:211], v[80:83]
  ds_read_b128 v[48:51], v27 offset:32768
  v_mfma_f32_16x16x32_bf16 v[84:87], v[36:39], v[208:211], v[84:87]
  ds_read_b128 v[52:55], v27 offset:34816
  v_mfma_f32_16x16x32_bf16 v[88:91], v[40:43], v[208:211], v[88:91]
  v_subrev_u32 v21, 49152, v21
  v_mfma_f32_16x16x32_bf16 v[92:95], v[44:47], v[208:211], v[92:95]
  v_subrev_u32 v22, 49152, v22
  s_waitcnt lgkmcnt(6)
  v_mfma_f32_16x16x32_bf16 v[96:99], v[32:35], v[212:215], v[96:99]
  v_subrev_u32 v23, 49152, v23
  v_mfma_f32_16x16x32_bf16 v[100:103], v[36:39], v[212:215], v[100:103]
  v_subrev_u32 v24, 49152, v24
  v_mfma_f32_16x16x32_bf16 v[104:107], v[40:43], v[212:215], v[104:107]
  v_subrev_u32 v25, 49152, v25
  v_mfma_f32_16x16x32_bf16 v[108:111], v[44:47], v[212:215], v[108:111]
  ds_read_b64_tr_b16 v[204:205], v21 offset:0
  s_waitcnt lgkmcnt(5)
  v_mfma_f32_16x16x32_bf16 v[112:115], v[32:35], v[216:219], v[112:115]
  ds_read_b64_tr_b16 v[206:207], v21 offset:8192
  v_mfma_f32_16x16x32_bf16 v[116:119], v[36:39], v[216:219], v[116:119]
  ds_read_b128 v[56:59], v27 offset:36864
  v_mfma_f32_16x16x32_bf16 v[120:123], v[40:43], v[216:219], v[120:123]
  ds_read_b128 v[60:63], v27 offset:38912
  v_mfma_f32_16x16x32_bf16 v[124:127], v[44:47], v[216:219], v[124:127]
  ds_read_b64_tr_b16 v[208:209], v22 offset:0
  s_waitcnt lgkmcnt(7)
  v_mfma_f32_16x16x32_bf16 v[128:131], v[32:35], v[220:223], v[128:131]
  ds_read_b64_tr_b16 v[210:211], v22 offset:8192
  v_mfma_f32_16x16x32_bf16 v[132:135], v[36:39], v[220:223], v[132:135]
  ds_read_b64_tr_b16 v[212:213], v23 offset:0
  v_mfma_f32_16x16x32_bf16 v[136:139], v[40:43], v[220:223], v[136:139]
  ds_read_b64_tr_b16 v[214:215], v23 offset:8192
  v_mfma_f32_16x16x32_bf16 v[140:143], v[44:47], v[220:223], v[140:143]
  ds_read_b64_tr_b16 v[216:217], v24 offset:0
  s_waitcnt lgkmcnt(5)
  v_mfma_f32_16x16x32_bf16 v[64:67], v[48:51], v[204:207], v[64:67]
  ds_read_b64_tr_b16 v[218:219], v24 offset:8192
  v_mfma_f32_16x16x32_bf16 v[68:71], v[52:55], v[204:207], v[68:71]
  ds_read_b64_tr_b16 v[220:221], v25 offset:0
  v_mfma_f32_16x16x32_bf16 v[72:75], v[56:59], v[204:207], v[72:75]
  ds_read_b64_tr_b16 v[222:223], v25 offset:8192
  v_mfma_f32_16x16x32_bf16 v[76:79], v[60:63], v[204:207], v[76:79]
  s_waitcnt lgkmcnt(6)
  s_barrier
  v_mfma_f32_16x16x32_bf16 v[80:83], v[48:51], v[208:211], v[80:83]
  v_mfma_f32_16x16x32_bf16 v[84:87], v[52:55], v[208:211], v[84:87]
  v_mfma_f32_16x16x32_bf16 v[88:91], v[56:59], v[208:211], v[88:91]
  v_mfma_f32_16x16x32_bf16 v[92:95], v[60:63], v[208:211], v[92:95]
  s_waitcnt lgkmcnt(4)
  v_mfma_f32_16x16x32_bf16 v[96:99], v[48:51], v[212:215], v[96:99]
  v_mfma_f32_16x16x32_bf16 v[100:103], v[52:55], v[212:215], v[100:103]
  v_mfma_f32_16x16x32_bf16 v[104:107], v[56:59], v[212:215], v[104:107]
  v_mfma_f32_16x16x32_bf16 v[108:111], v[60:63], v[212:215], v[108:111]
  s_waitcnt lgkmcnt(2)
  v_mfma_f32_16x16x32_bf16 v[112:115], v[48:51], v[216:219], v[112:115]
  v_mfma_f32_16x16x32_bf16 v[116:119], v[52:55], v[216:219], v[116:119]
  v_mfma_f32_16x16x32_bf16 v[120:123], v[56:59], v[216:219], v[120:123]
  v_mfma_f32_16x16x32_bf16 v[124:127], v[60:63], v[216:219], v[124:127]
  s_waitcnt lgkmcnt(0)
  v_mfma_f32_16x16x32_bf16 v[128:131], v[48:51], v[220:223], v[128:131]
  v_mfma_f32_16x16x32_bf16 v[132:135], v[52:55], v[220:223], v[132:135]
  v_mfma_f32_16x16x32_bf16 v[136:139], v[56:59], v[220:223], v[136:139]
  v_mfma_f32_16x16x32_bf16 v[140:143], v[60:63], v[220:223], v[140:143]
  s_setprio 3
  s_mul_i32 s50, s99, 10240
  s_add_u32 s50, s50, 135680
  v_add_u32 v8, s50, v250
  v_cmp_eq_u32 vcc, 8, v2
  v_mov_b32 v9, 0x3f803f80
  v_cvt_pk_bf16_f32 v64, v64, v65
  v_cvt_pk_bf16_f32 v65, v66, v67
  v_cvt_pk_bf16_f32 v66, v68, v69
  v_cvt_pk_bf16_f32 v67, v70, v71
  ds_write_b128 v8, v[64:67] offset:0
  v_cvt_pk_bf16_f32 v72, v72, v73
  v_cvt_pk_bf16_f32 v73, v74, v75
  v_cvt_pk_bf16_f32 v74, v76, v77
  v_cvt_pk_bf16_f32 v75, v78, v79
  ds_write_b128 v8, v[72:75] offset:5120
  v_cvt_pk_bf16_f32 v80, v80, v81
  v_cvt_pk_bf16_f32 v81, v82, v83
  v_cvt_pk_bf16_f32 v82, v84, v85
  v_cvt_pk_bf16_f32 v83, v86, v87
  ds_write_b128 v8, v[80:83] offset:1024
  v_cvt_pk_bf16_f32 v88, v88, v89
  v_cvt_pk_bf16_f32 v89, v90, v91
  v_cvt_pk_bf16_f32 v90, v92, v93
  v_cvt_pk_bf16_f32 v91, v94, v95
  ds_write_b128 v8, v[88:91] offset:6144
  v_cvt_pk_bf16_f32 v96, v96, v97
  v_cvt_pk_bf16_f32 v97, v98, v99
  v_cvt_pk_bf16_f32 v98, v100, v101
  v_cvt_pk_bf16_f32 v99, v102, v103
  v_cndmask_b32 v96, v96, v9, vcc
  v_cndmask_b32 v97, v97, v9, vcc
  v_cndmask_b32 v98, v98, v9, vcc
  v_cndmask_b32 v99, v99, v9, vcc
  ds_write_b128 v8, v[96:99] offset:2048
  v_cvt_pk_bf16_f32 v104, v104, v105
  v_cvt_pk_bf16_f32 v105, v106, v107
  v_cvt_pk_bf16_f32 v106, v108, v109
  v_cvt_pk_bf16_f32 v107, v110, v111
  v_cndmask_b32 v104, v104, v9, vcc
  v_cndmask_b32 v105, v105, v9, vcc
  v_cndmask_b32 v106, v106, v9, vcc
  v_cndmask_b32 v107, v107, v9, vcc
  ds_write_b128 v8, v[104:107] offset:7168
  v_cvt_pk_bf16_f32 v112, v112, v113
  v_cvt_pk_bf16_f32 v113, v114, v115
  v_cvt_pk_bf16_f32 v114, v116, v117
  v_cvt_pk_bf16_f32 v115, v118, v119
  ds_write_b128 v8, v[112:115] offset:3072
  v_cvt_pk_bf16_f32 v120, v120, v121
  v_cvt_pk_bf16_f32 v121, v122, v123
  v_cvt_pk_bf16_f32 v122, v124, v125
  v_cvt_pk_bf16_f32 v123, v126, v127
  ds_write_b128 v8, v[120:123] offset:8192
  v_cvt_pk_bf16_f32 v128, v128, v129
  v_cvt_pk_bf16_f32 v129, v130, v131
  v_cvt_pk_bf16_f32 v130, v132, v133
  v_cvt_pk_bf16_f32 v131, v134, v135
  ds_write_b128 v8, v[128:131] offset:4096
  v_cvt_pk_bf16_f32 v136, v136, v137
  v_cvt_pk_bf16_f32 v137, v138, v139
  v_cvt_pk_bf16_f32 v138, v140, v141
  v_cvt_pk_bf16_f32 v139, v142, v143
  ds_write_b128 v8, v[136:139] offset:9216
  s_mul_i32 s50, s99, 5120
  v_add_u32 v6, s50, v250
  v_lshlrev_b32 v7, 3, v1
  v_add_u32 v7, s50, v7
  v_mov_b32 v4, 163096
  s_mov_b32 s59, 0
  s_nop 0
L_cw3:
  ds_read_b32 v5, v4
  s_waitcnt lgkmcnt(0)
  v_readfirstlane_b32 s50, v5
  s_add_u32 s59, s59, 1
  s_cmp_gt_u32 s59, 2000000
  s_nop 2
  s_cbranch_scc1 L_cw3d
  s_cmp_ge_u32 s50, 2
  s_cbranch_scc1 L_cw3d
  s_setprio 0
  s_sleep 1
  s_branch L_cw3
L_cw3d:
  s_setprio 3
  ds_read_b128 v[32:35], v6 offset:0
  ds_read_b128 v[36:39], v6 offset:1024
  ds_read_b64 v[40:41], v7 offset:2048
  v_mov_b32 v42, 0
  v_mov_b32 v43, 0
  ds_read_b128 v[44:47], v6 offset:2560
  ds_read_b128 v[48:51], v6 offset:3584
  ds_read_b64 v[52:53], v7 offset:4608
  v_mov_b32 v54, 0
  v_mov_b32 v55, 0
  s_waitcnt lgkmcnt(0)
  v_mov_b32 v4, 163072
  v_mov_b32 v5, 1
  s_mov_b64 exec, 1
  ds_add_u32 v4, v5
  s_mov_b64 exec, -1
L_kpost:
  s_waitcnt lgkmcnt(0)
  v_mfma_f32_16x16x32_bf16 v[64:67], v[144:147], v[32:35], 0
  v_mfma_f32_16x16x32_bf16 v[64:67], v[148:151], v[36:39], v[64:67]
  v_mfma_f32_16x16x32_bf16 v[64:67], v[152:155], v[40:43], v[64:67]
  v_mfma_f32_16x16x32_bf16 v[68:71], v[156:159], v[32:35], 0
  v_mfma_f32_16x16x32_bf16 v[68:71], v[160:163], v[36:39], v[68:71]
  v_mfma_f32_16x16x32_bf16 v[68:71], v[164:167], v[40:43], v[68:71]
  v_mfma_f32_16x16x32_bf16 v[72:75], v[168:171], v[32:35], 0
  v_mfma_f32_16x16x32_bf16 v[72:75], v[172:175], v[36:39], v[72:75]
  v_mfma_f32_16x16x32_bf16 v[72:75], v[176:179], v[40:43], v[72:75]
  v_mfma_f32_16x16x32_bf16 v[76:79], v[180:183], v[32:35], 0
  v_mfma_f32_16x16x32_bf16 v[76:79], v[184:187], v[36:39], v[76:79]
  v_mfma_f32_16x16x32_bf16 v[76:79], v[188:191], v[40:43], v[76:79]
  v_mfma_f32_16x16x32_bf16 v[80:83], v[192:195], v[32:35], 0
  v_mfma_f32_16x16x32_bf16 v[80:83], v[196:199], v[36:39], v[80:83]
  v_mfma_f32_16x16x32_bf16 v[80:83], v[200:203], v[40:43], v[80:83]
  v_mfma_f32_16x16x32_bf16 v[104:107], v[144:147], v[44:47], 0
  v_max3_f32 v4, v64, v65, v66
  v_min3_f32 v6, v64, v65, v66
  v_max3_f32 v8, v67, v68, v69
  v_mfma_f32_16x16x32_bf16 v[104:107], v[148:151], v[48:51], v[104:107]
  v_min3_f32 v9, v67, v68, v69
  v_max3_f32 v4, v4, v70, v71
  v_min3_f32 v6, v6, v70, v71
  v_mfma_f32_16x16x32_bf16 v[104:107], v[152:155], v[52:55], v[104:107]
  v_max3_f32 v8, v8, v72, v73
  v_min3_f32 v9, v9, v72, v73
  v_max3_f32 v4, v4, v74, v75
  v_mfma_f32_16x16x32_bf16 v[108:111], v[156:159], v[44:47], 0
  v_min3_f32 v6, v6, v74, v75
  v_max3_f32 v8, v8, v76, v77
  v_min3_f32 v9, v9, v76, v77
  v_mfma_f32_16x16x32_bf16 v[108:111], v[160:163], v[48:51], v[108:111]
  v_max3_f32 v4, v4, v78, v79
  v_min3_f32 v6, v6, v78, v79
  v_max3_f32 v8, v8, v80, v81
  v_mfma_f32_16x16x32_bf16 v[108:111], v[164:167], v[52:55], v[108:111]
  v_min3_f32 v9, v9, v80, v81
  v_max_f32 v4, v4, v8
  v_min_f32 v6, v6, v9
  v_mfma_f32_16x16x32_bf16 v[112:115], v[168:171], v[44:47], 0
  v_mul_f32 v4, s62, v4
  v_mul_f32 v6, s60, v6
  v_pk_fma_f32 v[84:85], v[64:65], s[60:61], v[4:5] op_sel_hi:[1,1,0]
  v_mfma_f32_16x16x32_bf16 v[112:115], v[172:175], v[48:51], v[112:115]
  v_pk_fma_f32 v[64:65], v[64:65], s[62:63], v[6:7] op_sel_hi:[1,1,0]
  v_pk_fma_f32 v[86:87], v[66:67], s[60:61], v[4:5] op_sel_hi:[1,1,0]
  v_pk_fma_f32 v[66:67], v[66:67], s[62:63], v[6:7] op_sel_hi:[1,1,0]
  v_mfma_f32_16x16x32_bf16 v[112:115], v[176:179], v[52:55], v[112:115]
  v_pk_fma_f32 v[88:89], v[68:69], s[60:61], v[4:5] op_sel_hi:[1,1,0]
  v_pk_fma_f32 v[68:69], v[68:69], s[62:63], v[6:7] op_sel_hi:[1,1,0]
  v_pk_fma_f32 v[90:91], v[70:71], s[60:61], v[4:5] op_sel_hi:[1,1,0]
  v_mfma_f32_16x16x32_bf16 v[116:119], v[180:183], v[44:47], 0
  v_pk_fma_f32 v[70:71], v[70:71], s[62:63], v[6:7] op_sel_hi:[1,1,0]
  v_pk_fma_f32 v[92:93], v[72:73], s[60:61], v[4:5] op_sel_hi:[1,1,0]
  v_pk_fma_f32 v[72:73], v[72:73], s[62:63], v[6:7] op_sel_hi:[1,1,0]
  v_mfma_f32_16x16x32_bf16 v[116:119], v[184:187], v[48:51], v[116:119]
  v_pk_fma_f32 v[94:95], v[74:75], s[60:61], v[4:5] op_sel_hi:[1,1,0]
  v_pk_fma_f32 v[74:75], v[74:75], s[62:63], v[6:7] op_sel_hi:[1,1,0]
  v_pk_fma_f32 v[96:97], v[76:77], s[60:61], v[4:5] op_sel_hi:[1,1,0]
  v_mfma_f32_16x16x32_bf16 v[116:119], v[188:191], v[52:55], v[116:119]
  v_pk_fma_f32 v[76:77], v[76:77], s[62:63], v[6:7] op_sel_hi:[1,1,0]
  v_pk_fma_f32 v[98:99], v[78:79], s[60:61], v[4:5] op_sel_hi:[1,1,0]
  v_pk_fma_f32 v[78:79], v[78:79], s[62:63], v[6:7] op_sel_hi:[1,1,0]
  v_mfma_f32_16x16x32_bf16 v[120:123], v[192:195], v[44:47], 0
  v_pk_fma_f32 v[100:101], v[80:81], s[60:61], v[4:5] op_sel_hi:[1,1,0]
  v_pk_fma_f32 v[80:81], v[80:81], s[62:63], v[6:7] op_sel_hi:[1,1,0]
  v_exp_f32 v84, v84
  v_mfma_f32_16x16x32_bf16 v[120:123], v[196:199], v[48:51], v[120:123]
  v_exp_f32 v64, v64
  v_exp_f32 v85, v85
  v_exp_f32 v65, v65
  v_mfma_f32_16x16x32_bf16 v[120:123], v[200:203], v[52:55], v[120:123]
  v_exp_f32 v86, v86
  v_exp_f32 v66, v66
  v_exp_f32 v87, v87
  v_exp_f32 v67, v67
  v_exp_f32 v88, v88
  v_exp_f32 v68, v68
  v_exp_f32 v89, v89
  v_exp_f32 v69, v69
  v_exp_f32 v90, v90
  v_exp_f32 v70, v70
  v_exp_f32 v91, v91
  v_exp_f32 v71, v71
  v_exp_f32 v92, v92
  v_exp_f32 v72, v72
  v_exp_f32 v93, v93
  v_exp_f32 v73, v73
  v_exp_f32 v94, v94
  v_exp_f32 v74, v74
  v_exp_f32 v95, v95
  v_exp_f32 v75, v75
  v_exp_f32 v96, v96
  v_exp_f32 v76, v76
  v_exp_f32 v97, v97
  v_exp_f32 v77, v77
  v_exp_f32 v98, v98
  v_exp_f32 v78, v78
  v_exp_f32 v99, v99
  v_exp_f32 v79, v79
  v_exp_f32 v100, v100
  v_exp_f32 v80, v80
  v_exp_f32 v101, v101
  v_exp_f32 v81, v81
  v_pk_add_f32 v[8:9], v[84:85], v[86:87]
  v_pk_add_f32 v[10:11], v[64:65], v[66:67]
  v_pk_add_f32 v[8:9], v[8:9], v[88:89]
  v_pk_add_f32 v[10:11], v[10:11], v[68:69]
  v_pk_add_f32 v[8:9], v[8:9], v[90:91]
  v_pk_add_f32 v[10:11], v[10:11], v[70:71]
  v_pk_add_f32 v[8:9], v[8:9], v[92:93]
  v_pk_add_f32 v[10:11], v[10:11], v[72:73]
  v_pk_add_f32 v[8:9], v[8:9], v[94:95]
  v_pk_add_f32 v[10:11], v[10:11], v[74:75]
  v_pk_add_f32 v[8:9], v[8:9], v[96:97]
  v_pk_add_f32 v[10:11], v[10:11], v[76:77]
  v_pk_add_f32 v[8:9], v[8:9], v[98:99]
  v_pk_add_f32 v[10:11], v[10:11], v[78:79]
  v_pk_add_f32 v[8:9], v[8:9], v[100:101]
  v_pk_add_f32 v[10:11], v[10:11], v[80:81]
  v_add_f32 v8, v8, v9
  v_add_f32 v10, v10, v11
  v_rcp_f32 v8, v8
  v_rcp_f32 v10, v10
  v_pk_mul_f32 v[84:85], v[84:85], v[8:9] op_sel_hi:[1,0]
  v_pk_mul_f32 v[64:65], v[64:65], v[10:11] op_sel_hi:[1,0]
  v_pk_mul_f32 v[86:87], v[86:87], v[8:9] op_sel_hi:[1,0]
  v_pk_mul_f32 v[66:67], v[66:67], v[10:11] op_sel_hi:[1,0]
  v_pk_mul_f32 v[88:89], v[88:89], v[8:9] op_sel_hi:[1,0]
  v_pk_mul_f32 v[68:69], v[68:69], v[10:11] op_sel_hi:[1,0]
  v_pk_mul_f32 v[90:91], v[90:91], v[8:9] op_sel_hi:[1,0]
  v_pk_mul_f32 v[70:71], v[70:71], v[10:11] op_sel_hi:[1,0]
  v_pk_mul_f32 v[92:93], v[92:93], v[8:9] op_sel_hi:[1,0]
  v_pk_mul_f32 v[72:73], v[72:73], v[10:11] op_sel_hi:[1,0]
  v_pk_mul_f32 v[94:95], v[94:95], v[8:9] op_sel_hi:[1,0]
  v_pk_mul_f32 v[74:75], v[74:75], v[10:11] op_sel_hi:[1,0]
  v_pk_mul_f32 v[96:97], v[96:97], v[8:9] op_sel_hi:[1,0]
  v_pk_mul_f32 v[76:77], v[76:77], v[10:11] op_sel_hi:[1,0]
  v_pk_mul_f32 v[98:99], v[98:99], v[8:9] op_sel_hi:[1,0]
  v_pk_mul_f32 v[78:79], v[78:79], v[10:11] op_sel_hi:[1,0]
  v_pk_mul_f32 v[100:101], v[100:101], v[8:9] op_sel_hi:[1,0]
  v_pk_mul_f32 v[80:81], v[80:81], v[10:11] op_sel_hi:[1,0]
  v_cvt_pk_bf16_f32 v124, v84, v85
  v_cvt_pk_bf16_f32 v125, v86, v87
  v_cvt_pk_bf16_f32 v126, v88, v89
  v_cvt_pk_bf16_f32 v127, v90, v91
  v_cvt_pk_bf16_f32 v128, v92, v93
  v_cvt_pk_bf16_f32 v129, v94, v95
  v_cvt_pk_bf16_f32 v130, v96, v97
  v_cvt_pk_bf16_f32 v131, v98, v99
  v_cvt_pk_bf16_f32 v132, v100, v101
  v_cvt_pk_bf16_f32 v133, v64, v65
  v_cvt_pk_bf16_f32 v134, v66, v67
  v_cvt_pk_bf16_f32 v135, v68, v69
  v_cvt_pk_bf16_f32 v136, v70, v71
  v_cvt_pk_bf16_f32 v137, v72, v73
  v_cvt_pk_bf16_f32 v138, v74, v75
  v_cvt_pk_bf16_f32 v139, v76, v77
  v_cvt_pk_bf16_f32 v140, v78, v79
  v_cvt_pk_bf16_f32 v141, v80, v81
  v_mov_b32 v142, 0
  v_mov_b32 v143, 0
  v_mov_b32 v4, 163072
  s_mov_b32 s59, 0
  s_nop 0
L_cw4:
  ds_read_b32 v5, v4
  s_waitcnt lgkmcnt(0)
  v_readfirstlane_b32 s50, v5
  s_add_u32 s59, s59, 1
  s_cmp_gt_u32 s59, 2000000
  s_nop 2
  s_cbranch_scc1 L_cw4d
  s_cmp_ge_u32 s50, 8
  s_cbranch_scc1 L_cw4d
  s_setprio 0
  s_sleep 1
  s_branch L_cw4
L_cw4d:
  s_setprio 3
  ds_write_b128 v251, v[124:127] offset:0
  ds_write_b128 v251, v[128:131] offset:16
  ds_write_b128 v251, v[132:135] offset:32
  ds_write_b128 v251, v[136:139] offset:48
  ds_write_b128 v251, v[140:143] offset:64
  v_max3_f32 v4, v104, v105, v106
  v_min3_f32 v6, v104, v105, v106
  v_max3_f32 v8, v107, v108, v109
  v_min3_f32 v9, v107, v108, v109
  v_max3_f32 v4, v4, v110, v111
  v_min3_f32 v6, v6, v110, v111
  v_max3_f32 v8, v8, v112, v113
  v_min3_f32 v9, v9, v112, v113
  v_max3_f32 v4, v4, v114, v115
  v_min3_f32 v6, v6, v114, v115
  v_max3_f32 v8, v8, v116, v117
  v_min3_f32 v9, v9, v116, v117
  v_max3_f32 v4, v4, v118, v119
  v_min3_f32 v6, v6, v118, v119
  v_max3_f32 v8, v8, v120, v121
  v_min3_f32 v9, v9, v120, v121
  v_max_f32 v4, v4, v8
  v_min_f32 v6, v6, v9
  v_mul_f32 v4, s62, v4
  v_mul_f32 v6, s60, v6
  v_pk_fma_f32 v[84:85], v[104:105], s[60:61], v[4:5] op_sel_hi:[1,1,0]
  v_pk_fma_f32 v[104:105], v[104:105], s[62:63], v[6:7] op_sel_hi:[1,1,0]
  v_pk_fma_f32 v[86:87], v[106:107], s[60:61], v[4:5] op_sel_hi:[1,1,0]
  v_pk_fma_f32 v[106:107], v[106:107], s[62:63], v[6:7] op_sel_hi:[1,1,0]
  v_pk_fma_f32 v[88:89], v[108:109], s[60:61], v[4:5] op_sel_hi:[1,1,0]
  v_pk_fma_f32 v[108:109], v[108:109], s[62:63], v[6:7] op_sel_hi:[1,1,0]
  v_pk_fma_f32 v[90:91], v[110:111], s[60:61], v[4:5] op_sel_hi:[1,1,0]
  v_pk_fma_f32 v[110:111], v[110:111], s[62:63], v[6:7] op_sel_hi:[1,1,0]
  v_pk_fma_f32 v[92:93], v[112:113], s[60:61], v[4:5] op_sel_hi:[1,1,0]
  v_pk_fma_f32 v[112:113], v[112:113], s[62:63], v[6:7] op_sel_hi:[1,1,0]
  v_pk_fma_f32 v[94:95], v[114:115], s[60:61], v[4:5] op_sel_hi:[1,1,0]
  v_pk_fma_f32 v[114:115], v[114:115], s[62:63], v[6:7] op_sel_hi:[1,1,0]
  v_pk_fma_f32 v[96:97], v[116:117], s[60:61], v[4:5] op_sel_hi:[1,1,0]
  v_pk_fma_f32 v[116:117], v[116:117], s[62:63], v[6:7] op_sel_hi:[1,1,0]
  v_pk_fma_f32 v[98:99], v[118:119], s[60:61], v[4:5] op_sel_hi:[1,1,0]
  v_pk_fma_f32 v[118:119], v[118:119], s[62:63], v[6:7] op_sel_hi:[1,1,0]
  v_pk_fma_f32 v[100:101], v[120:121], s[60:61], v[4:5] op_sel_hi:[1,1,0]
  v_pk_fma_f32 v[120:121], v[120:121], s[62:63], v[6:7] op_sel_hi:[1,1,0]
  v_exp_f32 v84, v84
  v_exp_f32 v104, v104
  v_exp_f32 v85, v85
  v_exp_f32 v105, v105
  v_exp_f32 v86, v86
  v_exp_f32 v106, v106
  v_exp_f32 v87, v87
  v_exp_f32 v107, v107
  v_exp_f32 v88, v88
  v_exp_f32 v108, v108
  v_exp_f32 v89, v89
  v_exp_f32 v109, v109
  v_exp_f32 v90, v90
  v_exp_f32 v110, v110
  v_exp_f32 v91, v91
  v_exp_f32 v111, v111
  v_exp_f32 v92, v92
  v_exp_f32 v112, v112
  v_exp_f32 v93, v93
  v_exp_f32 v113, v113
  v_exp_f32 v94, v94
  v_exp_f32 v114, v114
  v_exp_f32 v95, v95
  v_exp_f32 v115, v115
  v_exp_f32 v96, v96
  v_exp_f32 v116, v116
  v_exp_f32 v97, v97
  v_exp_f32 v117, v117
  v_exp_f32 v98, v98
  v_exp_f32 v118, v118
  v_exp_f32 v99, v99
  v_exp_f32 v119, v119
  v_exp_f32 v100, v100
  v_exp_f32 v120, v120
  v_exp_f32 v101, v101
  v_exp_f32 v121, v121
  v_pk_add_f32 v[8:9], v[84:85], v[86:87]
  v_pk_add_f32 v[10:11], v[104:105], v[106:107]
  v_pk_add_f32 v[8:9], v[8:9], v[88:89]
  v_pk_add_f32 v[10:11], v[10:11], v[108:109]
  v_pk_add_f32 v[8:9], v[8:9], v[90:91]
  v_pk_add_f32 v[10:11], v[10:11], v[110:111]
  v_pk_add_f32 v[8:9], v[8:9], v[92:93]
  v_pk_add_f32 v[10:11], v[10:11], v[112:113]
  v_pk_add_f32 v[8:9], v[8:9], v[94:95]
  v_pk_add_f32 v[10:11], v[10:11], v[114:115]
  v_pk_add_f32 v[8:9], v[8:9], v[96:97]
  v_pk_add_f32 v[10:11], v[10:11], v[116:117]
  v_pk_add_f32 v[8:9], v[8:9], v[98:99]
  v_pk_add_f32 v[10:11], v[10:11], v[118:119]
  v_pk_add_f32 v[8:9], v[8:9], v[100:101]
  v_pk_add_f32 v[10:11], v[10:11], v[120:121]
  v_add_f32 v8, v8, v9
  v_add_f32 v10, v10, v11
  v_rcp_f32 v8, v8
  v_rcp_f32 v10, v10
  v_pk_mul_f32 v[84:85], v[84:85], v[8:9] op_sel_hi:[1,0]
  v_pk_mul_f32 v[104:105], v[104:105], v[10:11] op_sel_hi:[1,0]
  v_pk_mul_f32 v[86:87], v[86:87], v[8:9] op_sel_hi:[1,0]
  v_pk_mul_f32 v[106:107], v[106:107], v[10:11] op_sel_hi:[1,0]
  v_pk_mul_f32 v[88:89], v[88:89], v[8:9] op_sel_hi:[1,0]
  v_pk_mul_f32 v[108:109], v[108:109], v[10:11] op_sel_hi:[1,0]
  v_pk_mul_f32 v[90:91], v[90:91], v[8:9] op_sel_hi:[1,0]
  v_pk_mul_f32 v[110:111], v[110:111], v[10:11] op_sel_hi:[1,0]
  v_pk_mul_f32 v[92:93], v[92:93], v[8:9] op_sel_hi:[1,0]
  v_pk_mul_f32 v[112:113], v[112:113], v[10:11] op_sel_hi:[1,0]
  v_pk_mul_f32 v[94:95], v[94:95], v[8:9] op_sel_hi:[1,0]
  v_pk_mul_f32 v[114:115], v[114:115], v[10:11] op_sel_hi:[1,0]
  v_pk_mul_f32 v[96:97], v[96:97], v[8:9] op_sel_hi:[1,0]
  v_pk_mul_f32 v[116:117], v[116:117], v[10:11] op_sel_hi:[1,0]
  v_pk_mul_f32 v[98:99], v[98:99], v[8:9] op_sel_hi:[1,0]
  v_pk_mul_f32 v[118:119], v[118:119], v[10:11] op_sel_hi:[1,0]
  v_pk_mul_f32 v[100:101], v[100:101], v[8:9] op_sel_hi:[1,0]
  v_pk_mul_f32 v[120:121], v[120:121], v[10:11] op_sel_hi:[1,0]
  v_cvt_pk_bf16_f32 v204, v84, v85
  v_cvt_pk_bf16_f32 v205, v86, v87
  v_cvt_pk_bf16_f32 v206, v88, v89
  v_cvt_pk_bf16_f32 v207, v90, v91
  v_cvt_pk_bf16_f32 v208, v92, v93
  v_cvt_pk_bf16_f32 v209, v94, v95
  v_cvt_pk_bf16_f32 v210, v96, v97
  v_cvt_pk_bf16_f32 v211, v98, v99
  v_cvt_pk_bf16_f32 v212, v100, v101
  v_cvt_pk_bf16_f32 v213, v104, v105
  v_cvt_pk_bf16_f32 v214, v106, v107
  v_cvt_pk_bf16_f32 v215, v108, v109
  v_cvt_pk_bf16_f32 v216, v110, v111
  v_cvt_pk_bf16_f32 v217, v112, v113
  v_cvt_pk_bf16_f32 v218, v114, v115
  v_cvt_pk_bf16_f32 v219, v116, v117
  v_cvt_pk_bf16_f32 v220, v118, v119
  v_cvt_pk_bf16_f32 v221, v120, v121
  v_mov_b32 v222, 0
  v_mov_b32 v223, 0
  ds_write_b128 v251, v[204:207] offset:5120
  ds_write_b128 v251, v[208:211] offset:5136
  ds_write_b128 v251, v[212:215] offset:5152
  ds_write_b128 v251, v[216:219] offset:5168
  ds_write_b128 v251, v[220:223] offset:5184
  s_waitcnt lgkmcnt(0)
  v_mov_b32 v4, 163076
  v_mov_b32 v5, 1
  s_mov_b64 exec, 1
  ds_add_u32 v4, v5
  s_mov_b64 exec, -1
  ds_read_b128 v[96:99], v228 offset:0
  ds_read_b128 v[100:103], v228 offset:5120
  ds_read_b128 v[104:107], v228 offset:10240
  ds_read_b128 v[108:111], v228 offset:15360
  ds_read_b128 v[112:115], v228 offset:1024
  ds_read_b128 v[116:119], v228 offset:6144
  ds_read_b128 v[120:123], v228 offset:11264
  ds_read_b128 v[124:127], v228 offset:16384
  ds_read_b128 v[128:131], v229 offset:0
  ds_read_b128 v[132:135], v229 offset:5120
  ds_read_b128 v[136:139], v229 offset:10240
  ds_read_b128 v[140:143], v229 offset:15360
  v_mov_b32 v4, 163076
  s_mov_b32 s59, 0
  s_nop 0
L_cw5:
  ds_read_b32 v5, v4
  s_waitcnt lgkmcnt(0)
  v_readfirstlane_b32 s50, v5
  s_add_u32 s59, s59, 1
  s_cmp_gt_u32 s59, 2000000
  s_nop 2
  s_cbranch_scc1 L_cw5d
  s_cmp_ge_u32 s50, 4
  s_cbranch_scc1 L_cw5d
  s_setprio 0
  s_sleep 1
  s_branch L_cw5
L_cw5d:
  s_setprio 3
  ds_read_b64_tr_b16 v[32:33], v227 offset:0
  ds_read_b64_tr_b16 v[34:35], v227 offset:5120
  ds_read_b64_tr_b16 v[36:37], v227 offset:10240
  ds_read_b64_tr_b16 v[38:39], v227 offset:15360
  ds_read_b64_tr_b16 v[40:41], v227 offset:20480
  ds_read_b64_tr_b16 v[42:43], v227 offset:25600
  ds_read_b64_tr_b16 v[44:45], v227 offset:30720
  ds_read_b64_tr_b16 v[46:47], v227 offset:35840
  ds_read_b64_tr_b16 v[48:49], v227 offset:32
  ds_read_b64_tr_b16 v[50:51], v227 offset:5152
  ds_read_b64_tr_b16 v[52:53], v227 offset:10272
  ds_read_b64_tr_b16 v[54:55], v227 offset:15392
  ds_read_b64_tr_b16 v[56:57], v227 offset:20512
  ds_read_b64_tr_b16 v[58:59], v227 offset:25632
  ds_read_b64_tr_b16 v[60:61], v227 offset:30752
  ds_read_b64_tr_b16 v[62:63], v227 offset:35872
  s_waitcnt lgkmcnt(8)
  ds_read_b64_tr_b16 v[64:65], v227 offset:64
  ds_read_b64_tr_b16 v[66:67], v227 offset:5184
  ds_read_b64_tr_b16 v[68:69], v227 offset:10304
  ds_read_b64_tr_b16 v[70:71], v227 offset:15424
  ds_read_b64_tr_b16 v[72:73], v227 offset:20544
  ds_read_b64_tr_b16 v[74:75], v227 offset:25664
  ds_read_b64_tr_b16 v[76:77], v227 offset:30784
  ds_read_b64_tr_b16 v[78:79], v227 offset:35904
  v_mfma_f32_16x16x32_bf16 v[160:163], v[32:35], v[96:99], 0
  v_mfma_f32_16x16x32_bf16 v[160:163], v[36:39], v[100:103], v[160:163]
  v_mfma_f32_16x16x32_bf16 v[160:163], v[40:43], v[104:107], v[160:163]
  v_mfma_f32_16x16x32_bf16 v[160:163], v[44:47], v[108:111], v[160:163]
  v_mfma_f32_16x16x32_bf16 v[164:167], v[32:35], v[112:115], 0
  v_mfma_f32_16x16x32_bf16 v[164:167], v[36:39], v[116:119], v[164:167]
  v_mfma_f32_16x16x32_bf16 v[164:167], v[40:43], v[120:123], v[164:167]
  v_mfma_f32_16x16x32_bf16 v[164:167], v[44:47], v[124:127], v[164:167]
  v_mfma_f32_16x16x32_bf16 v[168:171], v[32:35], v[128:131], 0
  v_mfma_f32_16x16x32_bf16 v[168:171], v[36:39], v[132:135], v[168:171]
  v_mfma_f32_16x16x32_bf16 v[168:171], v[40:43], v[136:139], v[168:171]
  v_mfma_f32_16x16x32_bf16 v[168:171], v[44:47], v[140:143], v[168:171]
  s_waitcnt lgkmcnt(8)
  v_mfma_f32_16x16x32_bf16 v[172:175], v[48:51], v[96:99], 0
  v_mfma_f32_16x16x32_bf16 v[172:175], v[52:55], v[100:103], v[172:175]
  v_mfma_f32_16x16x32_bf16 v[172:175], v[56:59], v[104:107], v[172:175]
  v_mfma_f32_16x16x32_bf16 v[172:175], v[60:63], v[108:111], v[172:175]
  v_mfma_f32_16x16x32_bf16 v[176:179], v[48:51], v[112:115], 0
  v_mfma_f32_16x16x32_bf16 v[176:179], v[52:55], v[116:119], v[176:179]
  v_mfma_f32_16x16x32_bf16 v[176:179], v[56:59], v[120:123], v[176:179]
  v_mfma_f32_16x16x32_bf16 v[176:179], v[60:63], v[124:127], v[176:179]
  v_mfma_f32_16x16x32_bf16 v[180:183], v[48:51], v[128:131], 0
  v_mfma_f32_16x16x32_bf16 v[180:183], v[52:55], v[132:135], v[180:183]
  v_mfma_f32_16x16x32_bf16 v[180:183], v[56:59], v[136:139], v[180:183]
  v_mfma_f32_16x16x32_bf16 v[180:183], v[60:63], v[140:143], v[180:183]
  s_waitcnt lgkmcnt(0)
  v_mov_b32 v4, 163088
  v_mov_b32 v5, 1
  s_mov_b64 exec, 1
  ds_add_u32 v4, v5
  s_mov_b64 exec, -1
  s_cmp_ge_u32 s45, 2
  s_nop 0
  s_cbranch_scc1 L_kvskip
  v_mfma_f32_16x16x32_bf16 v[184:187], v[64:67], v[96:99], 0
  v_mfma_f32_16x16x32_bf16 v[184:187], v[68:71], v[100:103], v[184:187]
  v_mfma_f32_16x16x32_bf16 v[184:187], v[72:75], v[104:107], v[184:187]
  v_mfma_f32_16x16x32_bf16 v[184:187], v[76:79], v[108:111], v[184:187]
  v_mfma_f32_16x16x32_bf16 v[188:191], v[64:67], v[112:115], 0
  v_mfma_f32_16x16x32_bf16 v[188:191], v[68:71], v[116:119], v[188:191]
  v_mfma_f32_16x16x32_bf16 v[188:191], v[72:75], v[120:123], v[188:191]
  v_mfma_f32_16x16x32_bf16 v[188:191], v[76:79], v[124:127], v[188:191]
  v_mfma_f32_16x16x32_bf16 v[192:195], v[64:67], v[128:131], 0
  v_mfma_f32_16x16x32_bf16 v[192:195], v[68:71], v[132:135], v[192:195]
  v_mfma_f32_16x16x32_bf16 v[192:195], v[72:75], v[136:139], v[192:195]
  v_mfma_f32_16x16x32_bf16 v[192:195], v[76:79], v[140:143], v[192:195]
  s_nop 7
L_kvskip:
  v_cvt_pk_bf16_f32 v160, v160, v161
  v_cvt_pk_bf16_f32 v161, v162, v163
  v_cvt_pk_bf16_f32 v164, v164, v165
  v_cvt_pk_bf16_f32 v165, v166, v167
  v_cvt_pk_bf16_f32 v168, v168, v169
  v_cvt_pk_bf16_f32 v169, v170, v171
  v_cvt_pk_bf16_f32 v172, v172, v173
  v_cvt_pk_bf16_f32 v173, v174, v175
  v_cvt_pk_bf16_f32 v176, v176, v177
  v_cvt_pk_bf16_f32 v177, v178, v179
  v_cvt_pk_bf16_f32 v180, v180, v181
  v_cvt_pk_bf16_f32 v181, v182, v183
  v_cvt_pk_bf16_f32 v184, v184, v185
  v_cvt_pk_bf16_f32 v185, v186, v187
  v_cvt_pk_bf16_f32 v188, v188, v189
  v_cvt_pk_bf16_f32 v189, v190, v191
  v_cvt_pk_bf16_f32 v192, v192, v193
  v_cvt_pk_bf16_f32 v193, v194, v195
  v_mov_b32 v4, 163088
  s_mov_b32 s59, 0
  s_nop 0
L_cw6:
  ds_read_b32 v5, v4
  s_waitcnt lgkmcnt(0)
  v_readfirstlane_b32 s50, v5
  s_add_u32 s59, s59, 1
  s_cmp_gt_u32 s59, 2000000
  s_nop 2
  s_cbranch_scc1 L_cw6d
  s_cmp_ge_u32 s50, 4
  s_cbranch_scc1 L_cw6d
  s_setprio 0
  s_sleep 1
  s_branch L_cw6
L_cw6d:
  s_setprio 3
  ds_write_b64 v224, v[160:161]
  ds_write_b64 v225, v[164:165]
  ds_write_b64 v226, v[168:169]
  ds_write_b64 v224, v[172:173] offset:32
  ds_write_b64 v225, v[176:177] offset:32
  ds_write_b64 v226, v[180:181] offset:32
  s_cmp_ge_u32 s45, 2
  s_cbranch_scc1 L_kvskip2
  s_mov_b32 exec_lo, 0xffff
  s_mov_b32 exec_hi, 0xffff
  ds_write_b64 v224, v[184:185] offset:64
  ds_write_b64 v225, v[188:189] offset:64
  ds_write_b64 v226, v[192:193] offset:64
  s_mov_b64 exec, -1
L_kvskip2:
  s_lshl_b32 s91, s41, 13
  s_add_u32 s91, s91, 11534336
  s_lshl_b32 s48, s40, 5
  s_lshl_b32 s51, s45, 3
  s_add_u32 s48, s48, s51
  s_add_u32 s48, s48, s91
  s_lshl_b32 s51, s40, 9
  s_add_u32 s91, s91, s51
  v_lshlrev_b32 v8, 4, v0
  v_add_u32 v8, 0, v8
  s_waitcnt lgkmcnt(0)
  v_mov_b32 v4, 163080
  v_mov_b32 v5, 1
  s_mov_b64 exec, 1
  ds_add_u32 v4, v5
  s_mov_b64 exec, -1
  v_mov_b32 v4, 163080
  s_mov_b32 s59, 0
  s_nop 0
L_cw7:
  ds_read_b32 v5, v4
  s_waitcnt lgkmcnt(0)
  v_readfirstlane_b32 s50, v5
  s_add_u32 s59, s59, 1
  s_cmp_gt_u32 s59, 2000000
  s_nop 2
  s_cbranch_scc1 L_cw7d
  s_cmp_ge_u32 s50, 4
  s_cbranch_scc1 L_cw7d
  s_setprio 0
  s_sleep 1
  s_branch L_cw7
L_cw7d:
  s_setprio 3
  ds_read_b128 v[32:35], v8 offset:0
  ds_read_b128 v[36:39], v8 offset:4096
  s_waitcnt lgkmcnt(1)
  buffer_store_dwordx4 v[32:35], v232, s[12:15], s96 offen sc1
  s_waitcnt lgkmcnt(0)
  buffer_store_dwordx4 v[36:39], v233, s[12:15], s96 offen sc1
  v_mov_b32 v10, s80
  v_mov_b32 v11, s81
  v_lshlrev_b32 v9, 9, v1
  s_waitcnt vmcnt(0)
  s_mov_b64 exec, 65535
  buffer_store_dwordx2 v[10:11], v9, s[12:15], s48 offen sc1
  s_mov_b64 exec, -1
  v_mov_b32 v4, 163084
  v_mov_b32 v5, 1
  s_mov_b64 exec, 1
  ds_add_u32 v4, v5
  s_mov_b64 exec, -1
  s_setprio 0
  v_mov_b32 v4, 163084
  s_mov_b32 s59, 0
  s_nop 0
L_cw8:
  ds_read_b32 v5, v4
  s_waitcnt lgkmcnt(0)
  v_readfirstlane_b32 s50, v5
  s_add_u32 s59, s59, 1
  s_cmp_gt_u32 s59, 2000000
  s_nop 2
  s_cbranch_scc1 L_cw8d
  s_cmp_ge_u32 s50, 4
  s_cbranch_scc1 L_cw8d
  s_setprio 0
  s_sleep 1
  s_branch L_cw8
L_cw8d:
  v_mov_b32 v4, 163092
  s_mov_b32 s59, 0
  s_nop 0
L_cw9:
  ds_read_b32 v5, v4
  s_waitcnt lgkmcnt(0)
  v_readfirstlane_b32 s50, v5
  s_add_u32 s59, s59, 1
  s_cmp_gt_u32 s59, 2000000
  s_nop 2
  s_cbranch_scc1 L_cw9d
  s_cmp_ge_u32 s50, 1
  s_cbranch_scc1 L_cw9d
  s_setprio 0
  s_sleep 1
  s_branch L_cw9
L_cw9d:
  v_cmp_gt_u32 vcc, 2304, v252
  s_nop 0
  s_mov_b64 exec, vcc
  s_add_u32 s51, s66, 161280
  s_add_u32 m0, s54, 154368
  s_nop 0
  buffer_load_dwordx4 v250, s[12:15], s51 offen lds
  s_mov_b64 exec, -1
  v_cmp_gt_u32 vcc, 2304, v252
  s_nop 0
  s_mov_b64 exec, vcc
  s_add_u32 s51, s66, 163584
  s_add_u32 m0, s54, 152064
  s_nop 0
  buffer_load_dwordx4 v250, s[12:15], s51 offen lds
  s_mov_b64 exec, -1
  s_add_u32 s51, s66, 0
  s_add_u32 m0, s54, 6912
  s_nop 0
  buffer_load_dwordx4 v250, s[12:15], s51 offen lds
  s_add_u32 s51, s66, 4096
  s_add_u32 m0, s54, 11008
  s_nop 0
  buffer_load_dwordx4 v250, s[12:15], s51 offen lds
  s_add_u32 s51, s66, 8192
  s_add_u32 m0, s54, 15104
  s_nop 0
  buffer_load_dwordx4 v250, s[12:15], s51 offen lds
  s_add_u32 s51, s66, 12288
  s_add_u32 m0, s54, 19200
  s_nop 0
  buffer_load_dwordx4 v250, s[12:15], s51 offen lds
  s_add_u32 s51, s66, 16384
  s_add_u32 m0, s54, 23296
  s_nop 0
  buffer_load_dwordx4 v250, s[12:15], s51 offen lds
  s_add_u32 s51, s66, 20480
  s_add_u32 m0, s54, 27392
  s_nop 0
  buffer_load_dwordx4 v250, s[12:15], s51 offen lds
  s_add_u32 s51, s66, 24576
  s_add_u32 m0, s54, 31488
  s_nop 0
  buffer_load_dwordx4 v250, s[12:15], s51 offen lds
  s_add_u32 s51, s66, 28672
  s_add_u32 m0, s54, 35584
  s_nop 0
  buffer_load_dwordx4 v250, s[12:15], s51 offen lds
  v_cmp_gt_u32 vcc, 1792, v252
  s_nop 0
  s_mov_b64 exec, vcc
  s_add_u32 s51, s66, 32768
  s_add_u32 m0, s54, 39680
  s_nop 0
  buffer_load_dwordx4 v250, s[12:15], s51 offen lds
  s_mov_b64 exec, -1
  s_add_u32 s51, s66, 34560
  s_add_u32 m0, s54, 133632
  s_nop 0
  buffer_load_dwordx4 v250, s[12:15], s51 offen lds
  s_add_u32 s51, s66, 38656
  s_add_u32 m0, s54, 137728
  s_nop 0
  buffer_load_dwordx4 v250, s[12:15], s51 offen lds
  s_add_u32 s51, s66, 42752
  s_add_u32 m0, s54, 141824
  s_nop 0
  buffer_load_dwordx4 v250, s[12:15], s51 offen lds
  s_add_u32 s51, s66, 46848
  s_add_u32 m0, s54, 145920
  s_nop 0
  buffer_load_dwordx4 v250, s[12:15], s51 offen lds
  v_cmp_gt_u32 vcc, 2048, v252
  s_nop 0
  s_mov_b64 exec, vcc
  s_add_u32 s51, s66, 50944
  s_add_u32 m0, s54, 150016
  s_nop 0
  buffer_load_dwordx4 v250, s[12:15], s51 offen lds
  s_mov_b64 exec, -1
  s_lshl_b32 s92, s41, 18
  s_mov_b32 s64, 0x11111111
  s_mov_b32 s65, 0x11111111
  s_mov_b32 s59, 0
  v_mov_b32 v8, 163112
  s_cmp_lg_u32 s44, 0
  s_nop 0
  s_cbranch_scc1 L_gloop
  buffer_load_dwordx2 v[32:33], v238, s[12:15], s91 offen sc1
L_gp0:
  s_waitcnt vmcnt(0)
  v_cmp_eq_u32 vcc, s80, v32
  v_cmp_eq_u32 s[100:101], s81, v33
  s_nop 0
  s_and_b64 vcc, vcc, s[100:101]
  s_lshr_b64 s[100:101], vcc, 1
  s_and_b64 vcc, vcc, s[100:101]
  s_lshr_b64 s[100:101], vcc, 2
  s_and_b64 vcc, vcc, s[100:101]
  v_mov_b32 v10, vcc_lo
  v_mov_b32 v11, vcc_hi
  ds_write_b64 v8, v[10:11]
  s_andn2_b64 s[100:101], s[64:65], vcc
  s_cbranch_scc0 L_gp1
  buffer_load_dwordx2 v[32:33], v238, s[12:15], s91 offen sc1
  s_add_u32 s59, s59, 1
  s_cmp_lt_u32 s59, 100000
  s_cbranch_scc1 L_gp0
L_gp1:
  ds_write_b64 v8, v[10:11]
L_gloop:
L_gread:
  ds_read_b64 v[10:11], v8
  s_waitcnt lgkmcnt(0)
  v_readfirstlane_b32 s100, v10
  v_readfirstlane_b32 s101, v11
  s_add_u32 s59, s59, 1
  s_cmp_gt_u32 s59, 400000
  s_nop 2
  s_cbranch_scc1 L_gdone
  s_and_b64 s[100:101], s[100:101], s[64:65]
  s_cbranch_scc1 L_gnew
  s_sleep 2
  s_branch L_gloop
L_gnew:
  s_andn2_b64 s[64:65], s[64:65], s[100:101]
  s_bitcmp1_b64 s[100:101], 0
  s_cbranch_scc0 L_gl0
  s_add_u32 s50, s92, 0
  buffer_load_dwordx4 v[32:35], v232, s[12:15], s50 offen
  buffer_load_dwordx4 v[36:39], v233, s[12:15], s50 offen
L_gl0:
  s_bitcmp1_b64 s[100:101], 4
  s_cbranch_scc0 L_gl1
  s_add_u32 s50, s92, 16384
  buffer_load_dwordx4 v[40:43], v232, s[12:15], s50 offen
  buffer_load_dwordx4 v[44:47], v233, s[12:15], s50 offen
L_gl1:
  s_bitcmp1_b64 s[100:101], 8
  s_cbranch_scc0 L_gl2
  s_add_u32 s50, s92, 32768
  buffer_load_dwordx4 v[48:51], v232, s[12:15], s50 offen
  buffer_load_dwordx4 v[52:55], v233, s[12:15], s50 offen
L_gl2:
  s_bitcmp1_b64 s[100:101], 12
  s_cbranch_scc0 L_gl3
  s_add_u32 s50, s92, 49152
  buffer_load_dwordx4 v[56:59], v232, s[12:15], s50 offen
  buffer_load_dwordx4 v[60:63], v233, s[12:15], s50 offen
L_gl3:
  s_bitcmp1_b64 s[100:101], 16
  s_cbranch_scc0 L_gl4
  s_add_u32 s50, s92, 65536
  buffer_load_dwordx4 v[64:67], v232, s[12:15], s50 offen
  buffer_load_dwordx4 v[68:71], v233, s[12:15], s50 offen
L_gl4:
  s_bitcmp1_b64 s[100:101], 20
  s_cbranch_scc0 L_gl5
  s_add_u32 s50, s92, 81920
  buffer_load_dwordx4 v[72:75], v232, s[12:15], s50 offen
  buffer_load_dwordx4 v[76:79], v233, s[12:15], s50 offen
L_gl5:
  s_bitcmp1_b64 s[100:101], 24
  s_cbranch_scc0 L_gl6
  s_add_u32 s50, s92, 98304
  buffer_load_dwordx4 v[80:83], v232, s[12:15], s50 offen
  buffer_load_dwordx4 v[84:87], v233, s[12:15], s50 offen
L_gl6:
  s_bitcmp1_b64 s[100:101], 28
  s_cbranch_scc0 L_gl7
  s_add_u32 s50, s92, 114688
  buffer_load_dwordx4 v[88:91], v232, s[12:15], s50 offen
  buffer_load_dwordx4 v[92:95], v233, s[12:15], s50 offen
L_gl7:
  s_bitcmp1_b64 s[100:101], 32
  s_cbranch_scc0 L_gl8
  s_add_u32 s50, s92, 131072
  buffer_load_dwordx4 v[96:99], v232, s[12:15], s50 offen
  buffer_load_dwordx4 v[100:103], v233, s[12:15], s50 offen
L_gl8:
  s_bitcmp1_b64 s[100:101], 36
  s_cbranch_scc0 L_gl9
  s_add_u32 s50, s92, 147456
  buffer_load_dwordx4 v[104:107], v232, s[12:15], s50 offen
  buffer_load_dwordx4 v[108:111], v233, s[12:15], s50 offen
L_gl9:
  s_bitcmp1_b64 s[100:101], 40
  s_cbranch_scc0 L_gl10
  s_add_u32 s50, s92, 163840
  buffer_load_dwordx4 v[112:115], v232, s[12:15], s50 offen
  buffer_load_dwordx4 v[116:119], v233, s[12:15], s50 offen
L_gl10:
  s_bitcmp1_b64 s[100:101], 44
  s_cbranch_scc0 L_gl11
  s_add_u32 s50, s92, 180224
  buffer_load_dwordx4 v[120:123], v232, s[12:15], s50 offen
  buffer_load_dwordx4 v[124:127], v233, s[12:15], s50 offen
L_gl11:
  s_bitcmp1_b64 s[100:101], 48
  s_cbranch_scc0 L_gl12
  s_add_u32 s50, s92, 196608
  buffer_load_dwordx4 v[128:131], v232, s[12:15], s50 offen
  buffer_load_dwordx4 v[132:135], v233, s[12:15], s50 offen
L_gl12:
  s_bitcmp1_b64 s[100:101], 52
  s_cbranch_scc0 L_gl13
  s_add_u32 s50, s92, 212992
  buffer_load_dwordx4 v[136:139], v232, s[12:15], s50 offen
  buffer_load_dwordx4 v[140:143], v233, s[12:15], s50 offen
L_gl13:
  s_bitcmp1_b64 s[100:101], 56
  s_cbranch_scc0 L_gl14
  s_add_u32 s50, s92, 229376
  buffer_load_dwordx4 v[144:147], v232, s[12:15], s50 offen
  buffer_load_dwordx4 v[148:151], v233, s[12:15], s50 offen
L_gl14:
  s_bitcmp1_b64 s[100:101], 60
  s_cbranch_scc0 L_gl15
  s_add_u32 s50, s92, 245760
  buffer_load_dwordx4 v[152:155], v232, s[12:15], s50 offen
  buffer_load_dwordx4 v[156:159], v233, s[12:15], s50 offen
L_gl15:
  s_cmp_lg_u64 s[64:65], 0
  s_cbranch_scc1 L_gloop
L_gdone:
  s_waitcnt vmcnt(0)
  s_mov_b32 s50, 0x3f80
  s_mov_b32 s51, 0x3f800000
  v_lshlrev_b32 v160, 16, v32
  v_and_b32 v161, 0xffff0000, v32
  v_lshlrev_b32 v162, 16, v33
  v_and_b32 v163, 0xffff0000, v33
  v_lshlrev_b32 v164, 16, v34
  v_and_b32 v165, 0xffff0000, v34
  v_lshlrev_b32 v166, 16, v35
  v_and_b32 v167, 0xffff0000, v35
  v_lshlrev_b32 v168, 16, v36
  v_and_b32 v169, 0xffff0000, v36
  v_lshlrev_b32 v170, 16, v37
  v_and_b32 v171, 0xffff0000, v37
  v_lshlrev_b32 v172, 16, v38
  v_and_b32 v173, 0xffff0000, v38
  v_lshlrev_b32 v174, 16, v39
  v_and_b32 v175, 0xffff0000, v39
  v_dot2_f32_bf16 v160, v40, s50, v160
  v_dot2_f32_bf16 v161, v40, s51, v161
  v_dot2_f32_bf16 v162, v41, s50, v162
  v_dot2_f32_bf16 v163, v41, s51, v163
  v_dot2_f32_bf16 v164, v42, s50, v164
  v_dot2_f32_bf16 v165, v42, s51, v165
  v_dot2_f32_bf16 v166, v43, s50, v166
  v_dot2_f32_bf16 v167, v43, s51, v167
  v_dot2_f32_bf16 v168, v44, s50, v168
  v_dot2_f32_bf16 v169, v44, s51, v169
  v_dot2_f32_bf16 v170, v45, s50, v170
  v_dot2_f32_bf16 v171, v45, s51, v171
  v_dot2_f32_bf16 v172, v46, s50, v172
  v_dot2_f32_bf16 v173, v46, s51, v173
  v_dot2_f32_bf16 v174, v47, s50, v174
  v_dot2_f32_bf16 v175, v47, s51, v175
  v_dot2_f32_bf16 v160, v48, s50, v160
  v_dot2_f32_bf16 v161, v48, s51, v161
  v_dot2_f32_bf16 v162, v49, s50, v162
  v_dot2_f32_bf16 v163, v49, s51, v163
  v_dot2_f32_bf16 v164, v50, s50, v164
  v_dot2_f32_bf16 v165, v50, s51, v165
  v_dot2_f32_bf16 v166, v51, s50, v166
  v_dot2_f32_bf16 v167, v51, s51, v167
  v_dot2_f32_bf16 v168, v52, s50, v168
  v_dot2_f32_bf16 v169, v52, s51, v169
  v_dot2_f32_bf16 v170, v53, s50, v170
  v_dot2_f32_bf16 v171, v53, s51, v171
  v_dot2_f32_bf16 v172, v54, s50, v172
  v_dot2_f32_bf16 v173, v54, s51, v173
  v_dot2_f32_bf16 v174, v55, s50, v174
  v_dot2_f32_bf16 v175, v55, s51, v175
  v_dot2_f32_bf16 v160, v56, s50, v160
  v_dot2_f32_bf16 v161, v56, s51, v161
  v_dot2_f32_bf16 v162, v57, s50, v162
  v_dot2_f32_bf16 v163, v57, s51, v163
  v_dot2_f32_bf16 v164, v58, s50, v164
  v_dot2_f32_bf16 v165, v58, s51, v165
  v_dot2_f32_bf16 v166, v59, s50, v166
  v_dot2_f32_bf16 v167, v59, s51, v167
  v_dot2_f32_bf16 v168, v60, s50, v168
  v_dot2_f32_bf16 v169, v60, s51, v169
  v_dot2_f32_bf16 v170, v61, s50, v170
  v_dot2_f32_bf16 v171, v61, s51, v171
  v_dot2_f32_bf16 v172, v62, s50, v172
  v_dot2_f32_bf16 v173, v62, s51, v173
  v_dot2_f32_bf16 v174, v63, s50, v174
  v_dot2_f32_bf16 v175, v63, s51, v175
  v_dot2_f32_bf16 v160, v64, s50, v160
  v_dot2_f32_bf16 v161, v64, s51, v161
  v_dot2_f32_bf16 v162, v65, s50, v162
  v_dot2_f32_bf16 v163, v65, s51, v163
  v_dot2_f32_bf16 v164, v66, s50, v164
  v_dot2_f32_bf16 v165, v66, s51, v165
  v_dot2_f32_bf16 v166, v67, s50, v166
  v_dot2_f32_bf16 v167, v67, s51, v167
  v_dot2_f32_bf16 v168, v68, s50, v168
  v_dot2_f32_bf16 v169, v68, s51, v169
  v_dot2_f32_bf16 v170, v69, s50, v170
  v_dot2_f32_bf16 v171, v69, s51, v171
  v_dot2_f32_bf16 v172, v70, s50, v172
  v_dot2_f32_bf16 v173, v70, s51, v173
  v_dot2_f32_bf16 v174, v71, s50, v174
  v_dot2_f32_bf16 v175, v71, s51, v175
  v_dot2_f32_bf16 v160, v72, s50, v160
  v_dot2_f32_bf16 v161, v72, s51, v161
  v_dot2_f32_bf16 v162, v73, s50, v162
  v_dot2_f32_bf16 v163, v73, s51, v163
  v_dot2_f32_bf16 v164, v74, s50, v164
  v_dot2_f32_bf16 v165, v74, s51, v165
  v_dot2_f32_bf16 v166, v75, s50, v166
  v_dot2_f32_bf16 v167, v75, s51, v167
  v_dot2_f32_bf16 v168, v76, s50, v168
  v_dot2_f32_bf16 v169, v76, s51, v169
  v_dot2_f32_bf16 v170, v77, s50, v170
  v_dot2_f32_bf16 v171, v77, s51, v171
  v_dot2_f32_bf16 v172, v78, s50, v172
  v_dot2_f32_bf16 v173, v78, s51, v173
  v_dot2_f32_bf16 v174, v79, s50, v174
  v_dot2_f32_bf16 v175, v79, s51, v175
  v_dot2_f32_bf16 v160, v80, s50, v160
  v_dot2_f32_bf16 v161, v80, s51, v161
  v_dot2_f32_bf16 v162, v81, s50, v162
  v_dot2_f32_bf16 v163, v81, s51, v163
  v_dot2_f32_bf16 v164, v82, s50, v164
  v_dot2_f32_bf16 v165, v82, s51, v165
  v_dot2_f32_bf16 v166, v83, s50, v166
  v_dot2_f32_bf16 v167, v83, s51, v167
  v_dot2_f32_bf16 v168, v84, s50, v168
  v_dot2_f32_bf16 v169, v84, s51, v169
  v_dot2_f32_bf16 v170, v85, s50, v170
  v_dot2_f32_bf16 v171, v85, s51, v171
  v_dot2_f32_bf16 v172, v86, s50, v172
  v_dot2_f32_bf16 v173, v86, s51, v173
  v_dot2_f32_bf16 v174, v87, s50, v174
  v_dot2_f32_bf16 v175, v87, s51, v175
  v_dot2_f32_bf16 v160, v88, s50, v160
  v_dot2_f32_bf16 v161, v88, s51, v161
  v_dot2_f32_bf16 v162, v89, s50, v162
  v_dot2_f32_bf16 v163, v89, s51, v163
  v_dot2_f32_bf16 v164, v90, s50, v164
  v_dot2_f32_bf16 v165, v90, s51, v165
  v_dot2_f32_bf16 v166, v91, s50, v166
  v_dot2_f32_bf16 v167, v91, s51, v167
  v_dot2_f32_bf16 v168, v92, s50, v168
  v_dot2_f32_bf16 v169, v92, s51, v169
  v_dot2_f32_bf16 v170, v93, s50, v170
  v_dot2_f32_bf16 v171, v93, s51, v171
  v_dot2_f32_bf16 v172, v94, s50, v172
  v_dot2_f32_bf16 v173, v94, s51, v173
  v_dot2_f32_bf16 v174, v95, s50, v174
  v_dot2_f32_bf16 v175, v95, s51, v175
  v_dot2_f32_bf16 v160, v96, s50, v160
  v_dot2_f32_bf16 v161, v96, s51, v161
  v_dot2_f32_bf16 v162, v97, s50, v162
  v_dot2_f32_bf16 v163, v97, s51, v163
  v_dot2_f32_bf16 v164, v98, s50, v164
  v_dot2_f32_bf16 v165, v98, s51, v165
  v_dot2_f32_bf16 v166, v99, s50, v166
  v_dot2_f32_bf16 v167, v99, s51, v167
  v_dot2_f32_bf16 v168, v100, s50, v168
  v_dot2_f32_bf16 v169, v100, s51, v169
  v_dot2_f32_bf16 v170, v101, s50, v170
  v_dot2_f32_bf16 v171, v101, s51, v171
  v_dot2_f32_bf16 v172, v102, s50, v172
  v_dot2_f32_bf16 v173, v102, s51, v173
  v_dot2_f32_bf16 v174, v103, s50, v174
  v_dot2_f32_bf16 v175, v103, s51, v175
  v_dot2_f32_bf16 v160, v104, s50, v160
  v_dot2_f32_bf16 v161, v104, s51, v161
  v_dot2_f32_bf16 v162, v105, s50, v162
  v_dot2_f32_bf16 v163, v105, s51, v163
  v_dot2_f32_bf16 v164, v106, s50, v164
  v_dot2_f32_bf16 v165, v106, s51, v165
  v_dot2_f32_bf16 v166, v107, s50, v166
  v_dot2_f32_bf16 v167, v107, s51, v167
  v_dot2_f32_bf16 v168, v108, s50, v168
  v_dot2_f32_bf16 v169, v108, s51, v169
  v_dot2_f32_bf16 v170, v109, s50, v170
  v_dot2_f32_bf16 v171, v109, s51, v171
  v_dot2_f32_bf16 v172, v110, s50, v172
  v_dot2_f32_bf16 v173, v110, s51, v173
  v_dot2_f32_bf16 v174, v111, s50, v174
  v_dot2_f32_bf16 v175, v111, s51, v175
  v_dot2_f32_bf16 v160, v112, s50, v160
  v_dot2_f32_bf16 v161, v112, s51, v161
  v_dot2_f32_bf16 v162, v113, s50, v162
  v_dot2_f32_bf16 v163, v113, s51, v163
  v_dot2_f32_bf16 v164, v114, s50, v164
  v_dot2_f32_bf16 v165, v114, s51, v165
  v_dot2_f32_bf16 v166, v115, s50, v166
  v_dot2_f32_bf16 v167, v115, s51, v167
  v_dot2_f32_bf16 v168, v116, s50, v168
  v_dot2_f32_bf16 v169, v116, s51, v169
  v_dot2_f32_bf16 v170, v117, s50, v170
  v_dot2_f32_bf16 v171, v117, s51, v171
  v_dot2_f32_bf16 v172, v118, s50, v172
  v_dot2_f32_bf16 v173, v118, s51, v173
  v_dot2_f32_bf16 v174, v119, s50, v174
  v_dot2_f32_bf16 v175, v119, s51, v175
  v_dot2_f32_bf16 v160, v120, s50, v160
  v_dot2_f32_bf16 v161, v120, s51, v161
  v_dot2_f32_bf16 v162, v121, s50, v162
  v_dot2_f32_bf16 v163, v121, s51, v163
  v_dot2_f32_bf16 v164, v122, s50, v164
  v_dot2_f32_bf16 v165, v122, s51, v165
  v_dot2_f32_bf16 v166, v123, s50, v166
  v_dot2_f32_bf16 v167, v123, s51, v167
  v_dot2_f32_bf16 v168, v124, s50, v168
  v_dot2_f32_bf16 v169, v124, s51, v169
  v_dot2_f32_bf16 v170, v125, s50, v170
  v_dot2_f32_bf16 v171, v125, s51, v171
  v_dot2_f32_bf16 v172, v126, s50, v172
  v_dot2_f32_bf16 v173, v126, s51, v173
  v_dot2_f32_bf16 v174, v127, s50, v174
  v_dot2_f32_bf16 v175, v127, s51, v175
  v_dot2_f32_bf16 v160, v128, s50, v160
  v_dot2_f32_bf16 v161, v128, s51, v161
  v_dot2_f32_bf16 v162, v129, s50, v162
  v_dot2_f32_bf16 v163, v129, s51, v163
  v_dot2_f32_bf16 v164, v130, s50, v164
  v_dot2_f32_bf16 v165, v130, s51, v165
  v_dot2_f32_bf16 v166, v131, s50, v166
  v_dot2_f32_bf16 v167, v131, s51, v167
  v_dot2_f32_bf16 v168, v132, s50, v168
  v_dot2_f32_bf16 v169, v132, s51, v169
  v_dot2_f32_bf16 v170, v133, s50, v170
  v_dot2_f32_bf16 v171, v133, s51, v171
  v_dot2_f32_bf16 v172, v134, s50, v172
  v_dot2_f32_bf16 v173, v134, s51, v173
  v_dot2_f32_bf16 v174, v135, s50, v174
  v_dot2_f32_bf16 v175, v135, s51, v175
  v_dot2_f32_bf16 v160, v136, s50, v160
  v_dot2_f32_bf16 v161, v136, s51, v161
  v_dot2_f32_bf16 v162, v137, s50, v162
  v_dot2_f32_bf16 v163, v137, s51, v163
  v_dot2_f32_bf16 v164, v138, s50, v164
  v_dot2_f32_bf16 v165, v138, s51, v165
  v_dot2_f32_bf16 v166, v139, s50, v166
  v_dot2_f32_bf16 v167, v139, s51, v167
  v_dot2_f32_bf16 v168, v140, s50, v168
  v_dot2_f32_bf16 v169, v140, s51, v169
  v_dot2_f32_bf16 v170, v141, s50, v170
  v_dot2_f32_bf16 v171, v141, s51, v171
  v_dot2_f32_bf16 v172, v142, s50, v172
  v_dot2_f32_bf16 v173, v142, s51, v173
  v_dot2_f32_bf16 v174, v143, s50, v174
  v_dot2_f32_bf16 v175, v143, s51, v175
  v_dot2_f32_bf16 v160, v144, s50, v160
  v_dot2_f32_bf16 v161, v144, s51, v161
  v_dot2_f32_bf16 v162, v145, s50, v162
  v_dot2_f32_bf16 v163, v145, s51, v163
  v_dot2_f32_bf16 v164, v146, s50, v164
  v_dot2_f32_bf16 v165, v146, s51, v165
  v_dot2_f32_bf16 v166, v147, s50, v166
  v_dot2_f32_bf16 v167, v147, s51, v167
  v_dot2_f32_bf16 v168, v148, s50, v168
  v_dot2_f32_bf16 v169, v148, s51, v169
  v_dot2_f32_bf16 v170, v149, s50, v170
  v_dot2_f32_bf16 v171, v149, s51, v171
  v_dot2_f32_bf16 v172, v150, s50, v172
  v_dot2_f32_bf16 v173, v150, s51, v173
  v_dot2_f32_bf16 v174, v151, s50, v174
  v_dot2_f32_bf16 v175, v151, s51, v175
  v_dot2_f32_bf16 v160, v152, s50, v160
  v_dot2_f32_bf16 v161, v152, s51, v161
  v_dot2_f32_bf16 v162, v153, s50, v162
  v_dot2_f32_bf16 v163, v153, s51, v163
  v_dot2_f32_bf16 v164, v154, s50, v164
  v_dot2_f32_bf16 v165, v154, s51, v165
  v_dot2_f32_bf16 v166, v155, s50, v166
  v_dot2_f32_bf16 v167, v155, s51, v167
  v_dot2_f32_bf16 v168, v156, s50, v168
  v_dot2_f32_bf16 v169, v156, s51, v169
  v_dot2_f32_bf16 v170, v157, s50, v170
  v_dot2_f32_bf16 v171, v157, s51, v171
  v_dot2_f32_bf16 v172, v158, s50, v172
  v_dot2_f32_bf16 v173, v158, s51, v173
  v_dot2_f32_bf16 v174, v159, s50, v174
  v_dot2_f32_bf16 v175, v159, s51, v175
  s_nop 3
  v_cvt_pk_bf16_f32 v32, v160, v161
  v_cvt_pk_bf16_f32 v33, v162, v163
  v_cvt_pk_bf16_f32 v34, v164, v165
  v_cvt_pk_bf16_f32 v35, v166, v167
  v_cvt_pk_bf16_f32 v36, v168, v169
  v_cvt_pk_bf16_f32 v37, v170, v171
  v_cvt_pk_bf16_f32 v38, v172, v173
  v_cvt_pk_bf16_f32 v39, v174, v175
  ds_write_b64 v240, v[32:33]
  ds_write_b64 v241, v[34:35]
  v_cmp_gt_u32 vcc, 86, v0
  s_nop 0
  s_and_saveexec_b64 s[94:95], vcc
  ds_write_b64 v242, v[36:37]
  ds_write_b64 v243, v[38:39]
  s_mov_b64 exec, -1
  v_mul_u32_u24 v4, 80, v0
  v_add_u32 v4, 72, v4
  v_mov_b32 v6, 0
  v_mov_b32 v7, 0
  v_cmp_gt_u32 vcc, 76, v0
  s_nop 0
  s_and_saveexec_b64 s[94:95], vcc
  ds_write_b64 v4, v[6:7]
  s_mov_b64 exec, -1
  s_mul_i32 s50, s45, 5120
  s_add_u32 s50, s50, 81920
  v_add_u32 v4, s50, v250
  v_bfe_u32 v7, v1, 2, 2
  v_lshl_add_u32 v5, v3, 2, v7
  v_and_b32 v6, 3, v1
  s_movk_i32 s51, 144
  v_mul_u32_u24 v5, s51, v5
  v_lshl_add_u32 v21, v6, 3, v5
  s_waitcnt lgkmcnt(0)
  s_barrier
  ds_read_b128 v[180:183], v4 offset:0
  ds_read_b128 v[184:187], v4 offset:1024
  ds_read_b128 v[188:191], v4 offset:2048
  ds_read_b128 v[192:195], v4 offset:3072
  ds_read_b128 v[196:199], v4 offset:4096
  v_add_u32 v22, 65536, v21
  v_add_u32 v23, 131072, v21
  ds_read_b64_tr_b16 v[200:201], v23 offset:23296
  ds_read_b64_tr_b16 v[202:203], v23 offset:20992
  ds_read_b64_tr_b16 v[204:205], v23 offset:23328
  ds_read_b64_tr_b16 v[206:207], v23 offset:21024
  ds_read_b64_tr_b16 v[208:209], v23 offset:23360
  ds_read_b64_tr_b16 v[210:211], v23 offset:21056
  ds_read_b64_tr_b16 v[212:213], v23 offset:23392
  ds_read_b64_tr_b16 v[214:215], v23 offset:21088
  ds_read_b64_tr_b16 v[216:217], v23 offset:23424
  ds_read_b64_tr_b16 v[218:219], v23 offset:21120
  s_waitcnt lgkmcnt(0)
  ds_read_b128 v[32:35], v249 offset:0
  ds_read_b128 v[36:39], v249 offset:16
  ds_read_b128 v[40:43], v249 offset:32
  ds_read_b128 v[44:47], v249 offset:48
  ds_read_b128 v[48:51], v249 offset:64
  ds_read_b128 v[52:55], v249 offset:320
  ds_read_b128 v[56:59], v249 offset:336
  ds_read_b128 v[60:63], v249 offset:352
  ds_read_b128 v[64:67], v249 offset:368
  ds_read_b128 v[68:71], v249 offset:384
  ds_read_b128 v[72:75], v249 offset:640
  ds_read_b128 v[76:79], v249 offset:656
  ds_read_b128 v[80:83], v249 offset:672
  s_mul_i32 s50, s44, 2304
  s_add_u32 s50, s50, 81920
  s_movk_i32 s51, 144
  v_mul_u32_u24 v7, s51, v2
  v_add_u32 v7, s50, v7
  v_mul_u32_u24 v8, 36, v3
  v_add_u32 v8, v7, v8
  v_lshl_add_u32 v6, v3, 4, v7
  s_lshr_b32 s50, s93, 2
  s_lshl_b32 s50, s50, 12
  s_and_b32 s51, s93, 3
  s_lshl_b32 s51, s51, 7
  s_add_u32 s50, s50, s51
  s_lshl_b32 s51, s41, 3
  s_add_u32 s50, s50, s51
  s_add_u32 s48, s50, 12582912
  s_waitcnt lgkmcnt(12)
  s_barrier
  v_mfma_f32_16x16x32_bf16 v[136:139], v[32:35], v[180:183], 0
  s_waitcnt lgkmcnt(11)
  v_mfma_f32_16x16x32_bf16 v[136:139], v[36:39], v[184:187], v[136:139]
  s_waitcnt lgkmcnt(10)
  v_mfma_f32_16x16x32_bf16 v[136:139], v[40:43], v[188:191], v[136:139]
  s_waitcnt lgkmcnt(9)
  v_mfma_f32_16x16x32_bf16 v[136:139], v[44:47], v[192:195], v[136:139]
  s_waitcnt lgkmcnt(8)
  v_mfma_f32_16x16x32_bf16 v[136:139], v[48:51], v[196:199], v[136:139]
  s_waitcnt lgkmcnt(7)
  v_mfma_f32_16x16x32_bf16 v[140:143], v[52:55], v[180:183], 0
  s_waitcnt lgkmcnt(6)
  v_mfma_f32_16x16x32_bf16 v[140:143], v[56:59], v[184:187], v[140:143]
  s_waitcnt lgkmcnt(5)
  v_mfma_f32_16x16x32_bf16 v[140:143], v[60:63], v[188:191], v[140:143]
  s_waitcnt lgkmcnt(4)
  v_mfma_f32_16x16x32_bf16 v[140:143], v[64:67], v[192:195], v[140:143]
  s_waitcnt lgkmcnt(3)
  v_mfma_f32_16x16x32_bf16 v[140:143], v[68:71], v[196:199], v[140:143]
  s_waitcnt lgkmcnt(2)
  v_mfma_f32_16x16x32_bf16 v[144:147], v[72:75], v[180:183], 0
  s_waitcnt lgkmcnt(1)
  v_mfma_f32_16x16x32_bf16 v[144:147], v[76:79], v[184:187], v[144:147]
  s_waitcnt lgkmcnt(0)
  v_mfma_f32_16x16x32_bf16 v[144:147], v[80:83], v[188:191], v[144:147]
  ds_read_b128 v[84:87], v249 offset:688
  ds_read_b128 v[88:91], v249 offset:704
  ds_read_b128 v[92:95], v249 offset:960
  ds_read_b128 v[96:99], v249 offset:976
  ds_read_b128 v[100:103], v249 offset:992
  ds_read_b128 v[104:107], v249 offset:1008
  ds_read_b128 v[108:111], v249 offset:1024
  ds_read_b128 v[112:115], v249 offset:1280
  ds_read_b128 v[116:119], v249 offset:1296
  ds_read_b128 v[120:123], v249 offset:1312
  ds_read_b128 v[124:127], v249 offset:1328
  ds_read_b128 v[128:131], v249 offset:1344
  s_waitcnt lgkmcnt(11)
  v_mfma_f32_16x16x32_bf16 v[144:147], v[84:87], v[192:195], v[144:147]
  s_waitcnt lgkmcnt(10)
  v_mfma_f32_16x16x32_bf16 v[144:147], v[88:91], v[196:199], v[144:147]
  s_waitcnt lgkmcnt(9)
  v_mfma_f32_16x16x32_bf16 v[148:151], v[92:95], v[180:183], 0
  s_waitcnt lgkmcnt(8)
  v_mfma_f32_16x16x32_bf16 v[148:151], v[96:99], v[184:187], v[148:151]
  s_waitcnt lgkmcnt(7)
  v_mfma_f32_16x16x32_bf16 v[148:151], v[100:103], v[188:191], v[148:151]
  s_waitcnt lgkmcnt(6)
  v_mfma_f32_16x16x32_bf16 v[148:151], v[104:107], v[192:195], v[148:151]
  s_waitcnt lgkmcnt(5)
  v_mfma_f32_16x16x32_bf16 v[148:151], v[108:111], v[196:199], v[148:151]
  s_waitcnt lgkmcnt(4)
  v_mfma_f32_16x16x32_bf16 v[152:155], v[112:115], v[180:183], 0
  s_waitcnt lgkmcnt(3)
  v_mfma_f32_16x16x32_bf16 v[152:155], v[116:119], v[184:187], v[152:155]
  s_waitcnt lgkmcnt(2)
  v_mfma_f32_16x16x32_bf16 v[152:155], v[120:123], v[188:191], v[152:155]
  s_waitcnt lgkmcnt(1)
  v_mfma_f32_16x16x32_bf16 v[152:155], v[124:127], v[192:195], v[152:155]
  s_waitcnt lgkmcnt(0)
  v_mfma_f32_16x16x32_bf16 v[152:155], v[128:131], v[196:199], v[152:155]
  s_nop 7
  v_add_f32 v4, 0x358637bd, v154
  v_rcp_f32 v4, v4
  s_nop 0
  v_pk_mul_f32 v[136:137], v[136:137], v[4:5] op_sel_hi:[1,0]
  v_pk_mul_f32 v[138:139], v[138:139], v[4:5] op_sel_hi:[1,0]
  v_pk_mul_f32 v[140:141], v[140:141], v[4:5] op_sel_hi:[1,0]
  v_pk_mul_f32 v[142:143], v[142:143], v[4:5] op_sel_hi:[1,0]
  v_pk_mul_f32 v[144:145], v[144:145], v[4:5] op_sel_hi:[1,0]
  v_pk_mul_f32 v[146:147], v[146:147], v[4:5] op_sel_hi:[1,0]
  v_pk_mul_f32 v[148:149], v[148:149], v[4:5] op_sel_hi:[1,0]
  v_pk_mul_f32 v[150:151], v[150:151], v[4:5] op_sel_hi:[1,0]
  v_pk_mul_f32 v[152:153], v[152:153], v[4:5] op_sel_hi:[1,0]
  v_cvt_pk_bf16_f32 v156, v136, v137
  v_cvt_pk_bf16_f32 v157, v138, v139
  v_cvt_pk_bf16_f32 v158, v140, v141
  v_cvt_pk_bf16_f32 v159, v142, v143
  v_cvt_pk_bf16_f32 v160, v144, v145
  v_cvt_pk_bf16_f32 v161, v146, v147
  v_cvt_pk_bf16_f32 v162, v148, v149
  v_cvt_pk_bf16_f32 v163, v150, v151
  v_cvt_pk_bf16_f32 v164, v152, v153
  ds_write2_b32 v8, v156, v157 offset0:0 offset1:1
  ds_write2_b32 v8, v158, v159 offset0:2 offset1:3
  ds_write2_b32 v8, v160, v161 offset0:4 offset1:5
  ds_write2_b32 v8, v162, v163 offset0:6 offset1:7
  ds_write_b32 v8, v164 offset:32
  s_waitcnt lgkmcnt(0)
  ds_read_b128 v[136:139], v6 offset:0
  ds_read_b128 v[140:143], v6 offset:64
  ds_read_b128 v[144:147], v6 offset:128
  s_waitcnt lgkmcnt(2)
  buffer_store_dwordx4 v[136:139], v28, s[12:15], 0 offen sc1
  s_waitcnt lgkmcnt(1)
  buffer_store_dwordx4 v[140:143], v29, s[12:15], 0 offen sc1
  s_waitcnt lgkmcnt(0)
  buffer_store_dwordx4 v[144:147], v30, s[12:15], 0 offen sc1
  s_barrier
  v_mov_b32 v10, s80
  v_mov_b32 v11, s81
  v_lshlrev_b32 v9, 9, v1
  s_waitcnt vmcnt(0)
  s_mov_b64 exec, 255
  buffer_store_dwordx2 v[10:11], v9, s[12:15], s48 offen sc1
  s_mov_b64 exec, -1
  v_mov_b32 v196, v200
  v_mov_b32 v197, v201
  v_mov_b32 v198, v202
  v_mov_b32 v199, v203
  v_mov_b32 v200, v204
  v_mov_b32 v201, v205
  v_mov_b32 v202, v206
  v_mov_b32 v203, v207
  v_mov_b32 v204, v208
  v_mov_b32 v205, v209
  v_mov_b32 v206, v210
  v_mov_b32 v207, v211
  v_mov_b32 v208, v212
  v_mov_b32 v209, v213
  v_mov_b32 v210, v214
  v_mov_b32 v211, v215
  v_mov_b32 v212, v216
  v_mov_b32 v213, v217
  v_mov_b32 v214, v218
  v_mov_b32 v215, v219
  s_lshr_b32 s48, s45, 1
  s_and_b32 s49, s45, 1
  s_lshl_b32 s50, s57, 2
  s_lshl_b32 s51, s49, 1
  s_add_u32 s50, s50, s51
  s_lshl_b32 s51, s48, 7
  s_add_u32 s51, s51, s50
  s_mul_i32 s92, s51, 18432
  s_add_u32 s92, s92, 4194304
  s_add_u32 s91, s92, 18432
  v_lshlrev_b32 v4, 4, v1
  v_add_u32 v5, 4096, v4
  v_add_u32 v6, 8192, v4
  v_add_u32 v7, 12288, v4
  v_add_u32 v8, 16384, v4
  s_lshl_b32 s50, s50, 6
  s_add_u32 s96, s50, 10485760
  v_lshlrev_b32 v9, 2, v2
  v_lshlrev_b32 v13, 3, v1
  s_lshl_b32 s51, s57, 12
  s_lshl_b32 s90, s58, 9
  s_add_u32 s51, s51, s90
  s_add_u32 s90, s51, 12582912
  s_barrier
  s_cmp_lg_u32 s44, 0
  s_cbranch_scc1 L_opoll_w
  s_mov_b32 s59, 0
  buffer_load_dwordx2 v[32:33], v13, s[12:15], s90 offen sc1
L_opoll:
  s_waitcnt vmcnt(0)
  v_cmp_ne_u32 vcc, s80, v32
  v_cmp_ne_u32 s[100:101], s81, v33
  s_nop 0
  s_or_b64 vcc, vcc, s[100:101]
  s_nop 2
  s_cbranch_scc0 L_opoll_d
  buffer_load_dwordx2 v[32:33], v13, s[12:15], s90 offen sc1
  s_add_u32 s59, s59, 1
  s_cmp_lt_u32 s59, 100000
  s_cbranch_scc1 L_opoll
L_opoll_d:
  v_mov_b32 v10, 163104
  v_mov_b32 v11, 1
  s_mov_b64 exec, 1
  ds_add_u32 v10, v11
  s_mov_b64 exec, -1
L_opoll_w:
  v_mov_b32 v10, 163104
  s_mov_b32 s59, 0
  s_nop 0
L_cw10:
  ds_read_b32 v11, v10
  s_waitcnt lgkmcnt(0)
  v_readfirstlane_b32 s50, v11
  s_add_u32 s59, s59, 1
  s_cmp_gt_u32 s59, 2000000
  s_nop 2
  s_cbranch_scc1 L_cw10d
  s_cmp_ge_u32 s50, 1
  s_cbranch_scc1 L_cw10d
  s_setprio 0
  s_sleep 1
  s_branch L_cw10
L_cw10d:
  buffer_load_dword v10, v9, s[12:15], s96 offen
  buffer_load_dword v11, v9, s[12:15], s96 offen offset:64
  buffer_load_dwordx4 v[32:35], v4, s[12:15], s92 offen offset:0
  buffer_load_dwordx4 v[36:39], v4, s[12:15], s91 offen offset:0
  buffer_load_dwordx4 v[40:43], v4, s[12:15], s92 offen offset:1024
  buffer_load_dwordx4 v[44:47], v4, s[12:15], s91 offen offset:1024
  buffer_load_dwordx4 v[48:51], v4, s[12:15], s92 offen offset:2048
  buffer_load_dwordx4 v[52:55], v4, s[12:15], s91 offen offset:2048
  buffer_load_dwordx4 v[56:59], v4, s[12:15], s92 offen offset:3072
  buffer_load_dwordx4 v[60:63], v4, s[12:15], s91 offen offset:3072
  buffer_load_dwordx4 v[64:67], v5, s[12:15], s92 offen offset:0
  buffer_load_dwordx4 v[68:71], v5, s[12:15], s91 offen offset:0
  buffer_load_dwordx4 v[72:75], v5, s[12:15], s92 offen offset:1024
  buffer_load_dwordx4 v[76:79], v5, s[12:15], s91 offen offset:1024
  buffer_load_dwordx4 v[80:83], v5, s[12:15], s92 offen offset:2048
  buffer_load_dwordx4 v[84:87], v5, s[12:15], s91 offen offset:2048
  buffer_load_dwordx4 v[88:91], v5, s[12:15], s92 offen offset:3072
  buffer_load_dwordx4 v[92:95], v5, s[12:15], s91 offen offset:3072
  buffer_load_dwordx4 v[96:99], v6, s[12:15], s92 offen offset:0
  buffer_load_dwordx4 v[100:103], v6, s[12:15], s91 offen offset:0
  buffer_load_dwordx4 v[104:107], v6, s[12:15], s92 offen offset:1024
  buffer_load_dwordx4 v[108:111], v6, s[12:15], s91 offen offset:1024
  buffer_load_dwordx4 v[112:115], v6, s[12:15], s92 offen offset:2048
  buffer_load_dwordx4 v[116:119], v6, s[12:15], s91 offen offset:2048
  buffer_load_dwordx4 v[120:123], v6, s[12:15], s92 offen offset:3072
  buffer_load_dwordx4 v[124:127], v6, s[12:15], s91 offen offset:3072
  buffer_load_dwordx4 v[128:131], v7, s[12:15], s92 offen offset:0
  buffer_load_dwordx4 v[132:135], v7, s[12:15], s91 offen offset:0
  buffer_load_dwordx4 v[136:139], v7, s[12:15], s92 offen offset:1024
  buffer_load_dwordx4 v[140:143], v7, s[12:15], s91 offen offset:1024
  buffer_load_dwordx4 v[144:147], v7, s[12:15], s92 offen offset:2048
  buffer_load_dwordx4 v[148:151], v7, s[12:15], s91 offen offset:2048
  buffer_load_dwordx4 v[152:155], v7, s[12:15], s92 offen offset:3072
  buffer_load_dwordx4 v[156:159], v7, s[12:15], s91 offen offset:3072
  buffer_load_dwordx4 v[160:163], v8, s[12:15], s92 offen offset:0
  buffer_load_dwordx4 v[164:167], v8, s[12:15], s91 offen offset:0
  buffer_load_dwordx4 v[168:171], v8, s[12:15], s92 offen offset:1024
  buffer_load_dwordx4 v[172:175], v8, s[12:15], s91 offen offset:1024
  s_cmp_eq_u32 s48, 1
  s_cbranch_scc1 L_pc_b1
  ds_read_b64_tr_b16 v[176:177], v21 offset:6912
  ds_read_b64_tr_b16 v[178:179], v21 offset:9216
  ds_read_b64_tr_b16 v[180:181], v21 offset:6944
  ds_read_b64_tr_b16 v[182:183], v21 offset:9248
  ds_read_b64_tr_b16 v[184:185], v21 offset:6976
  ds_read_b64_tr_b16 v[186:187], v21 offset:9280
  ds_read_b64_tr_b16 v[188:189], v21 offset:7008
  ds_read_b64_tr_b16 v[190:191], v21 offset:9312
  s_waitcnt vmcnt(34) lgkmcnt(6)
  v_mfma_f32_16x16x32_bf16 v[216:219], v[176:179], v[32:35], 0
  ds_read_b64_tr_b16 v[192:193], v21 offset:7040
  v_mfma_f32_16x16x32_bf16 v[236:239], v[176:179], v[36:39], 0
  ds_read_b64_tr_b16 v[194:195], v21 offset:9344
  s_waitcnt lgkmcnt(6)
  v_mfma_f32_16x16x32_bf16 v[220:223], v[180:183], v[32:35], 0
  ds_read_b64_tr_b16 v[176:177], v21 offset:16128
  v_mfma_f32_16x16x32_bf16 v[240:243], v[180:183], v[36:39], 0
  ds_read_b64_tr_b16 v[178:179], v21 offset:18432
  s_waitcnt lgkmcnt(6)
  v_mfma_f32_16x16x32_bf16 v[224:227], v[184:187], v[32:35], 0
  ds_read_b64_tr_b16 v[180:181], v21 offset:16160
  v_mfma_f32_16x16x32_bf16 v[244:247], v[184:187], v[36:39], 0
  ds_read_b64_tr_b16 v[182:183], v21 offset:18464
  s_waitcnt lgkmcnt(6)
  v_mfma_f32_16x16x32_bf16 v[228:231], v[188:191], v[32:35], 0
  ds_read_b64_tr_b16 v[184:185], v21 offset:16192
  v_mfma_f32_16x16x32_bf16 v[248:251], v[188:191], v[36:39], 0
  ds_read_b64_tr_b16 v[186:187], v21 offset:18496
  s_waitcnt lgkmcnt(6)
  v_mfma_f32_16x16x32_bf16 v[232:235], v[192:195], v[32:35], 0
  ds_read_b64_tr_b16 v[188:189], v21 offset:16224
  v_mfma_f32_16x16x32_bf16 v[252:255], v[192:195], v[36:39], 0
  ds_read_b64_tr_b16 v[190:191], v21 offset:18528
  s_waitcnt vmcnt(32) lgkmcnt(6)
  v_mfma_f32_16x16x32_bf16 v[216:219], v[176:179], v[40:43], v[216:219]
  ds_read_b64_tr_b16 v[192:193], v21 offset:16256
  v_mfma_f32_16x16x32_bf16 v[236:239], v[176:179], v[44:47], v[236:239]
  ds_read_b64_tr_b16 v[194:195], v21 offset:18560
  s_waitcnt lgkmcnt(6)
  v_mfma_f32_16x16x32_bf16 v[220:223], v[180:183], v[40:43], v[220:223]
  ds_read_b64_tr_b16 v[176:177], v21 offset:25344
  v_mfma_f32_16x16x32_bf16 v[240:243], v[180:183], v[44:47], v[240:243]
  ds_read_b64_tr_b16 v[178:179], v21 offset:27648
  s_waitcnt lgkmcnt(6)
  v_mfma_f32_16x16x32_bf16 v[224:227], v[184:187], v[40:43], v[224:227]
  ds_read_b64_tr_b16 v[180:181], v21 offset:25376
  v_mfma_f32_16x16x32_bf16 v[244:247], v[184:187], v[44:47], v[244:247]
  ds_read_b64_tr_b16 v[182:183], v21 offset:27680
  s_waitcnt lgkmcnt(6)
  v_mfma_f32_16x16x32_bf16 v[228:231], v[188:191], v[40:43], v[228:231]
  ds_read_b64_tr_b16 v[184:185], v21 offset:25408
  v_mfma_f32_16x16x32_bf16 v[248:251], v[188:191], v[44:47], v[248:251]
  ds_read_b64_tr_b16 v[186:187], v21 offset:27712
  s_waitcnt lgkmcnt(6)
  v_mfma_f32_16x16x32_bf16 v[232:235], v[192:195], v[40:43], v[232:235]
  ds_read_b64_tr_b16 v[188:189], v21 offset:25440
  v_mfma_f32_16x16x32_bf16 v[252:255], v[192:195], v[44:47], v[252:255]
  ds_read_b64_tr_b16 v[190:191], v21 offset:27744
  s_waitcnt vmcnt(30) lgkmcnt(6)
  v_mfma_f32_16x16x32_bf16 v[216:219], v[176:179], v[48:51], v[216:219]
  ds_read_b64_tr_b16 v[192:193], v21 offset:25472
  v_mfma_f32_16x16x32_bf16 v[236:239], v[176:179], v[52:55], v[236:239]
  ds_read_b64_tr_b16 v[194:195], v21 offset:27776
  s_waitcnt lgkmcnt(6)
  v_mfma_f32_16x16x32_bf16 v[220:223], v[180:183], v[48:51], v[220:223]
  ds_read_b64_tr_b16 v[176:177], v21 offset:34560
  v_mfma_f32_16x16x32_bf16 v[240:243], v[180:183], v[52:55], v[240:243]
  ds_read_b64_tr_b16 v[178:179], v21 offset:36864
  s_waitcnt lgkmcnt(6)
  v_mfma_f32_16x16x32_bf16 v[224:227], v[184:187], v[48:51], v[224:227]
  ds_read_b64_tr_b16 v[180:181], v21 offset:34592
  v_mfma_f32_16x16x32_bf16 v[244:247], v[184:187], v[52:55], v[244:247]
  ds_read_b64_tr_b16 v[182:183], v21 offset:36896
  s_waitcnt lgkmcnt(6)
  v_mfma_f32_16x16x32_bf16 v[228:231], v[188:191], v[48:51], v[228:231]
  ds_read_b64_tr_b16 v[184:185], v21 offset:34624
  v_mfma_f32_16x16x32_bf16 v[248:251], v[188:191], v[52:55], v[248:251]
  ds_read_b64_tr_b16 v[186:187], v21 offset:36928
  s_waitcnt lgkmcnt(6)
  v_mfma_f32_16x16x32_bf16 v[232:235], v[192:195], v[48:51], v[232:235]
  ds_read_b64_tr_b16 v[188:189], v21 offset:34656
  v_mfma_f32_16x16x32_bf16 v[252:255], v[192:195], v[52:55], v[252:255]
  ds_read_b64_tr_b16 v[190:191], v21 offset:36960
  s_waitcnt vmcnt(28) lgkmcnt(6)
  v_mfma_f32_16x16x32_bf16 v[216:219], v[176:179], v[56:59], v[216:219]
  ds_read_b64_tr_b16 v[192:193], v21 offset:34688
  v_mfma_f32_16x16x32_bf16 v[236:239], v[176:179], v[60:63], v[236:239]
  ds_read_b64_tr_b16 v[194:195], v21 offset:36992
  s_waitcnt lgkmcnt(6)
  v_mfma_f32_16x16x32_bf16 v[220:223], v[180:183], v[56:59], v[220:223]
  ds_read_b64_tr_b16 v[176:177], v23 offset:4864
  v_mfma_f32_16x16x32_bf16 v[240:243], v[180:183], v[60:63], v[240:243]
  ds_read_b64_tr_b16 v[178:179], v23 offset:7168
  s_waitcnt lgkmcnt(6)
  v_mfma_f32_16x16x32_bf16 v[224:227], v[184:187], v[56:59], v[224:227]
  ds_read_b64_tr_b16 v[180:181], v23 offset:4896
  v_mfma_f32_16x16x32_bf16 v[244:247], v[184:187], v[60:63], v[244:247]
  ds_read_b64_tr_b16 v[182:183], v23 offset:7200
  s_waitcnt lgkmcnt(6)
  v_mfma_f32_16x16x32_bf16 v[228:231], v[188:191], v[56:59], v[228:231]
  ds_read_b64_tr_b16 v[184:185], v23 offset:4928
  v_mfma_f32_16x16x32_bf16 v[248:251], v[188:191], v[60:63], v[248:251]
  ds_read_b64_tr_b16 v[186:187], v23 offset:7232
  s_waitcnt lgkmcnt(6)
  v_mfma_f32_16x16x32_bf16 v[232:235], v[192:195], v[56:59], v[232:235]
  ds_read_b64_tr_b16 v[188:189], v23 offset:4960
  v_mfma_f32_16x16x32_bf16 v[252:255], v[192:195], v[60:63], v[252:255]
  ds_read_b64_tr_b16 v[190:191], v23 offset:7264
  s_waitcnt vmcnt(26) lgkmcnt(6)
  v_mfma_f32_16x16x32_bf16 v[216:219], v[176:179], v[64:67], v[216:219]
  ds_read_b64_tr_b16 v[192:193], v23 offset:4992
  v_mfma_f32_16x16x32_bf16 v[236:239], v[176:179], v[68:71], v[236:239]
  ds_read_b64_tr_b16 v[194:195], v23 offset:7296
  s_waitcnt lgkmcnt(6)
  v_mfma_f32_16x16x32_bf16 v[220:223], v[180:183], v[64:67], v[220:223]
  ds_read_b64_tr_b16 v[176:177], v23 offset:14080
  v_mfma_f32_16x16x32_bf16 v[240:243], v[180:183], v[68:71], v[240:243]
  ds_read_b64_tr_b16 v[178:179], v23 offset:16384
  s_waitcnt lgkmcnt(6)
  v_mfma_f32_16x16x32_bf16 v[224:227], v[184:187], v[64:67], v[224:227]
  ds_read_b64_tr_b16 v[180:181], v23 offset:14112
  v_mfma_f32_16x16x32_bf16 v[244:247], v[184:187], v[68:71], v[244:247]
  ds_read_b64_tr_b16 v[182:183], v23 offset:16416
  s_waitcnt lgkmcnt(6)
  v_mfma_f32_16x16x32_bf16 v[228:231], v[188:191], v[64:67], v[228:231]
  ds_read_b64_tr_b16 v[184:185], v23 offset:14144
  v_mfma_f32_16x16x32_bf16 v[248:251], v[188:191], v[68:71], v[248:251]
  ds_read_b64_tr_b16 v[186:187], v23 offset:16448
  s_waitcnt lgkmcnt(6)
  v_mfma_f32_16x16x32_bf16 v[232:235], v[192:195], v[64:67], v[232:235]
  ds_read_b64_tr_b16 v[188:189], v23 offset:14176
  v_mfma_f32_16x16x32_bf16 v[252:255], v[192:195], v[68:71], v[252:255]
  ds_read_b64_tr_b16 v[190:191], v23 offset:16480
  s_waitcnt vmcnt(24) lgkmcnt(6)
  v_mfma_f32_16x16x32_bf16 v[216:219], v[176:179], v[72:75], v[216:219]
  ds_read_b64_tr_b16 v[192:193], v23 offset:14208
  v_mfma_f32_16x16x32_bf16 v[236:239], v[176:179], v[76:79], v[236:239]
  ds_read_b64_tr_b16 v[194:195], v23 offset:16512
  s_waitcnt lgkmcnt(6)
  v_mfma_f32_16x16x32_bf16 v[220:223], v[180:183], v[72:75], v[220:223]
  ds_read_b64_tr_b16 v[176:177], v21 offset:43776
  v_mfma_f32_16x16x32_bf16 v[240:243], v[180:183], v[76:79], v[240:243]
  ds_read_b64_tr_b16 v[178:179], v21 offset:46080
  s_waitcnt lgkmcnt(6)
  v_mfma_f32_16x16x32_bf16 v[224:227], v[184:187], v[72:75], v[224:227]
  ds_read_b64_tr_b16 v[180:181], v21 offset:43808
  v_mfma_f32_16x16x32_bf16 v[244:247], v[184:187], v[76:79], v[244:247]
  ds_read_b64_tr_b16 v[182:183], v21 offset:46112
  s_waitcnt lgkmcnt(6)
  v_mfma_f32_16x16x32_bf16 v[228:231], v[188:191], v[72:75], v[228:231]
  ds_read_b64_tr_b16 v[184:185], v21 offset:43840
  v_mfma_f32_16x16x32_bf16 v[248:251], v[188:191], v[76:79], v[248:251]
  ds_read_b64_tr_b16 v[186:187], v21 offset:46144
  s_waitcnt lgkmcnt(6)
  v_mfma_f32_16x16x32_bf16 v[232:235], v[192:195], v[72:75], v[232:235]
  ds_read_b64_tr_b16 v[188:189], v21 offset:43872
  v_mfma_f32_16x16x32_bf16 v[252:255], v[192:195], v[76:79], v[252:255]
  ds_read_b64_tr_b16 v[190:191], v21 offset:46176
  s_waitcnt vmcnt(22) lgkmcnt(6)
  v_mfma_f32_16x16x32_bf16 v[216:219], v[176:179], v[80:83], v[216:219]
  ds_read_b64_tr_b16 v[192:193], v21 offset:43904
  v_mfma_f32_16x16x32_bf16 v[236:239], v[176:179], v[84:87], v[236:239]
  ds_read_b64_tr_b16 v[194:195], v21 offset:46208
  s_waitcnt lgkmcnt(6)
  v_mfma_f32_16x16x32_bf16 v[220:223], v[180:183], v[80:83], v[220:223]
  ds_read_b64_tr_b16 v[176:177], v21 offset:52992
  v_mfma_f32_16x16x32_bf16 v[240:243], v[180:183], v[84:87], v[240:243]
  ds_read_b64_tr_b16 v[178:179], v21 offset:55296
  s_waitcnt lgkmcnt(6)
  v_mfma_f32_16x16x32_bf16 v[224:227], v[184:187], v[80:83], v[224:227]
  ds_read_b64_tr_b16 v[180:181], v21 offset:53024
  v_mfma_f32_16x16x32_bf16 v[244:247], v[184:187], v[84:87], v[244:247]
  ds_read_b64_tr_b16 v[182:183], v21 offset:55328
  s_waitcnt lgkmcnt(6)
  v_mfma_f32_16x16x32_bf16 v[228:231], v[188:191], v[80:83], v[228:231]
  ds_read_b64_tr_b16 v[184:185], v21 offset:53056
  v_mfma_f32_16x16x32_bf16 v[248:251], v[188:191], v[84:87], v[248:251]
  ds_read_b64_tr_b16 v[186:187], v21 offset:55360
  s_waitcnt lgkmcnt(6)
  v_mfma_f32_16x16x32_bf16 v[232:235], v[192:195], v[80:83], v[232:235]
  ds_read_b64_tr_b16 v[188:189], v21 offset:53088
  v_mfma_f32_16x16x32_bf16 v[252:255], v[192:195], v[84:87], v[252:255]
  ds_read_b64_tr_b16 v[190:191], v21 offset:55392
  s_waitcnt vmcnt(20) lgkmcnt(6)
  v_mfma_f32_16x16x32_bf16 v[216:219], v[176:179], v[88:91], v[216:219]
  ds_read_b64_tr_b16 v[192:193], v21 offset:53120
  v_mfma_f32_16x16x32_bf16 v[236:239], v[176:179], v[92:95], v[236:239]
  ds_read_b64_tr_b16 v[194:195], v21 offset:55424
  s_waitcnt lgkmcnt(6)
  v_mfma_f32_16x16x32_bf16 v[220:223], v[180:183], v[88:91], v[220:223]
  ds_read_b64_tr_b16 v[176:177], v21 offset:62208
  v_mfma_f32_16x16x32_bf16 v[240:243], v[180:183], v[92:95], v[240:243]
  ds_read_b64_tr_b16 v[178:179], v21 offset:64512
  s_waitcnt lgkmcnt(6)
  v_mfma_f32_16x16x32_bf16 v[224:227], v[184:187], v[88:91], v[224:227]
  ds_read_b64_tr_b16 v[180:181], v21 offset:62240
  v_mfma_f32_16x16x32_bf16 v[244:247], v[184:187], v[92:95], v[244:247]
  ds_read_b64_tr_b16 v[182:183], v21 offset:64544
  s_waitcnt lgkmcnt(6)
  v_mfma_f32_16x16x32_bf16 v[228:231], v[188:191], v[88:91], v[228:231]
  ds_read_b64_tr_b16 v[184:185], v21 offset:62272
  v_mfma_f32_16x16x32_bf16 v[248:251], v[188:191], v[92:95], v[248:251]
  ds_read_b64_tr_b16 v[186:187], v21 offset:64576
  s_waitcnt lgkmcnt(6)
  v_mfma_f32_16x16x32_bf16 v[232:235], v[192:195], v[88:91], v[232:235]
  ds_read_b64_tr_b16 v[188:189], v21 offset:62304
  v_mfma_f32_16x16x32_bf16 v[252:255], v[192:195], v[92:95], v[252:255]
  ds_read_b64_tr_b16 v[190:191], v21 offset:64608
  s_waitcnt vmcnt(18) lgkmcnt(6)
  v_mfma_f32_16x16x32_bf16 v[216:219], v[176:179], v[96:99], v[216:219]
  ds_read_b64_tr_b16 v[192:193], v21 offset:62336
  v_mfma_f32_16x16x32_bf16 v[236:239], v[176:179], v[100:103], v[236:239]
  ds_read_b64_tr_b16 v[194:195], v21 offset:64640
  s_waitcnt lgkmcnt(6)
  v_mfma_f32_16x16x32_bf16 v[220:223], v[180:183], v[96:99], v[220:223]
  ds_read_b64_tr_b16 v[176:177], v22 offset:5888
  v_mfma_f32_16x16x32_bf16 v[240:243], v[180:183], v[100:103], v[240:243]
  ds_read_b64_tr_b16 v[178:179], v22 offset:8192
  s_waitcnt lgkmcnt(6)
  v_mfma_f32_16x16x32_bf16 v[224:227], v[184:187], v[96:99], v[224:227]
  ds_read_b64_tr_b16 v[180:181], v22 offset:5920
  v_mfma_f32_16x16x32_bf16 v[244:247], v[184:187], v[100:103], v[244:247]
  ds_read_b64_tr_b16 v[182:183], v22 offset:8224
  s_waitcnt lgkmcnt(6)
  v_mfma_f32_16x16x32_bf16 v[228:231], v[188:191], v[96:99], v[228:231]
  ds_read_b64_tr_b16 v[184:185], v22 offset:5952
  v_mfma_f32_16x16x32_bf16 v[248:251], v[188:191], v[100:103], v[248:251]
  ds_read_b64_tr_b16 v[186:187], v22 offset:8256
  s_waitcnt lgkmcnt(6)
  v_mfma_f32_16x16x32_bf16 v[232:235], v[192:195], v[96:99], v[232:235]
  ds_read_b64_tr_b16 v[188:189], v22 offset:5984
  v_mfma_f32_16x16x32_bf16 v[252:255], v[192:195], v[100:103], v[252:255]
  ds_read_b64_tr_b16 v[190:191], v22 offset:8288
  s_waitcnt vmcnt(16) lgkmcnt(6)
  v_mfma_f32_16x16x32_bf16 v[216:219], v[176:179], v[104:107], v[216:219]
  ds_read_b64_tr_b16 v[192:193], v22 offset:6016
  v_mfma_f32_16x16x32_bf16 v[236:239], v[176:179], v[108:111], v[236:239]
  ds_read_b64_tr_b16 v[194:195], v22 offset:8320
  s_waitcnt lgkmcnt(6)
  v_mfma_f32_16x16x32_bf16 v[220:223], v[180:183], v[104:107], v[220:223]
  ds_read_b64_tr_b16 v[176:177], v22 offset:38144
  v_mfma_f32_16x16x32_bf16 v[240:243], v[180:183], v[108:111], v[240:243]
  ds_read_b64_tr_b16 v[178:179], v22 offset:40448
  s_waitcnt lgkmcnt(6)
  v_mfma_f32_16x16x32_bf16 v[224:227], v[184:187], v[104:107], v[224:227]
  ds_read_b64_tr_b16 v[180:181], v22 offset:38176
  v_mfma_f32_16x16x32_bf16 v[244:247], v[184:187], v[108:111], v[244:247]
  ds_read_b64_tr_b16 v[182:183], v22 offset:40480
  s_waitcnt lgkmcnt(6)
  v_mfma_f32_16x16x32_bf16 v[228:231], v[188:191], v[104:107], v[228:231]
  ds_read_b64_tr_b16 v[184:185], v22 offset:38208
  v_mfma_f32_16x16x32_bf16 v[248:251], v[188:191], v[108:111], v[248:251]
  ds_read_b64_tr_b16 v[186:187], v22 offset:40512
  s_waitcnt lgkmcnt(6)
  v_mfma_f32_16x16x32_bf16 v[232:235], v[192:195], v[104:107], v[232:235]
  ds_read_b64_tr_b16 v[188:189], v22 offset:38240
  v_mfma_f32_16x16x32_bf16 v[252:255], v[192:195], v[108:111], v[252:255]
  ds_read_b64_tr_b16 v[190:191], v22 offset:40544
  s_waitcnt vmcnt(14) lgkmcnt(6)
  v_mfma_f32_16x16x32_bf16 v[216:219], v[176:179], v[112:115], v[216:219]
  ds_read_b64_tr_b16 v[192:193], v22 offset:38272
  v_mfma_f32_16x16x32_bf16 v[236:239], v[176:179], v[116:119], v[236:239]
  ds_read_b64_tr_b16 v[194:195], v22 offset:40576
  s_waitcnt lgkmcnt(6)
  v_mfma_f32_16x16x32_bf16 v[220:223], v[180:183], v[112:115], v[220:223]
  ds_read_b64_tr_b16 v[176:177], v22 offset:47360
  v_mfma_f32_16x16x32_bf16 v[240:243], v[180:183], v[116:119], v[240:243]
  ds_read_b64_tr_b16 v[178:179], v22 offset:49664
  s_waitcnt lgkmcnt(6)
  v_mfma_f32_16x16x32_bf16 v[224:227], v[184:187], v[112:115], v[224:227]
  ds_read_b64_tr_b16 v[180:181], v22 offset:47392
  v_mfma_f32_16x16x32_bf16 v[244:247], v[184:187], v[116:119], v[244:247]
  ds_read_b64_tr_b16 v[182:183], v22 offset:49696
  s_waitcnt lgkmcnt(6)
  v_mfma_f32_16x16x32_bf16 v[228:231], v[188:191], v[112:115], v[228:231]
  ds_read_b64_tr_b16 v[184:185], v22 offset:47424
  v_mfma_f32_16x16x32_bf16 v[248:251], v[188:191], v[116:119], v[248:251]
  ds_read_b64_tr_b16 v[186:187], v22 offset:49728
  s_waitcnt lgkmcnt(6)
  v_mfma_f32_16x16x32_bf16 v[232:235], v[192:195], v[112:115], v[232:235]
  ds_read_b64_tr_b16 v[188:189], v22 offset:47456
  v_mfma_f32_16x16x32_bf16 v[252:255], v[192:195], v[116:119], v[252:255]
  ds_read_b64_tr_b16 v[190:191], v22 offset:49760
  s_waitcnt vmcnt(12) lgkmcnt(6)
  v_mfma_f32_16x16x32_bf16 v[216:219], v[176:179], v[120:123], v[216:219]
  ds_read_b64_tr_b16 v[192:193], v22 offset:47488
  v_mfma_f32_16x16x32_bf16 v[236:239], v[176:179], v[124:127], v[236:239]
  ds_read_b64_tr_b16 v[194:195], v22 offset:49792
  s_waitcnt lgkmcnt(6)
  v_mfma_f32_16x16x32_bf16 v[220:223], v[180:183], v[120:123], v[220:223]
  ds_read_b64_tr_b16 v[176:177], v22 offset:56576
  v_mfma_f32_16x16x32_bf16 v[240:243], v[180:183], v[124:127], v[240:243]
  ds_read_b64_tr_b16 v[178:179], v22 offset:58880
  s_waitcnt lgkmcnt(6)
  v_mfma_f32_16x16x32_bf16 v[224:227], v[184:187], v[120:123], v[224:227]
  ds_read_b64_tr_b16 v[180:181], v22 offset:56608
  v_mfma_f32_16x16x32_bf16 v[244:247], v[184:187], v[124:127], v[244:247]
  ds_read_b64_tr_b16 v[182:183], v22 offset:58912
  s_waitcnt lgkmcnt(6)
  v_mfma_f32_16x16x32_bf16 v[228:231], v[188:191], v[120:123], v[228:231]
  ds_read_b64_tr_b16 v[184:185], v22 offset:56640
  v_mfma_f32_16x16x32_bf16 v[248:251], v[188:191], v[124:127], v[248:251]
  ds_read_b64_tr_b16 v[186:187], v22 offset:58944
  s_waitcnt lgkmcnt(6)
  v_mfma_f32_16x16x32_bf16 v[232:235], v[192:195], v[120:123], v[232:235]
  ds_read_b64_tr_b16 v[188:189], v22 offset:56672
  v_mfma_f32_16x16x32_bf16 v[252:255], v[192:195], v[124:127], v[252:255]
  ds_read_b64_tr_b16 v[190:191], v22 offset:58976
  s_waitcnt vmcnt(10) lgkmcnt(6)
  v_mfma_f32_16x16x32_bf16 v[216:219], v[176:179], v[128:131], v[216:219]
  ds_read_b64_tr_b16 v[192:193], v22 offset:56704
  v_mfma_f32_16x16x32_bf16 v[236:239], v[176:179], v[132:135], v[236:239]
  ds_read_b64_tr_b16 v[194:195], v22 offset:59008
  s_waitcnt lgkmcnt(6)
  v_mfma_f32_16x16x32_bf16 v[220:223], v[180:183], v[128:131], v[220:223]
  ds_read_b64_tr_b16 v[176:177], v23 offset:256
  v_mfma_f32_16x16x32_bf16 v[240:243], v[180:183], v[132:135], v[240:243]
  ds_read_b64_tr_b16 v[178:179], v21 offset:0
  s_waitcnt lgkmcnt(6)
  v_mfma_f32_16x16x32_bf16 v[224:227], v[184:187], v[128:131], v[224:227]
  ds_read_b64_tr_b16 v[180:181], v23 offset:288
  v_mfma_f32_16x16x32_bf16 v[244:247], v[184:187], v[132:135], v[244:247]
  ds_read_b64_tr_b16 v[182:183], v21 offset:32
  s_waitcnt lgkmcnt(6)
  v_mfma_f32_16x16x32_bf16 v[228:231], v[188:191], v[128:131], v[228:231]
  ds_read_b64_tr_b16 v[184:185], v23 offset:320
  v_mfma_f32_16x16x32_bf16 v[248:251], v[188:191], v[132:135], v[248:251]
  ds_read_b64_tr_b16 v[186:187], v21 offset:64
  s_waitcnt lgkmcnt(6)
  v_mfma_f32_16x16x32_bf16 v[232:235], v[192:195], v[128:131], v[232:235]
  ds_read_b64_tr_b16 v[188:189], v23 offset:352
  v_mfma_f32_16x16x32_bf16 v[252:255], v[192:195], v[132:135], v[252:255]
  ds_read_b64_tr_b16 v[190:191], v21 offset:96
  s_waitcnt vmcnt(8) lgkmcnt(6)
  v_mfma_f32_16x16x32_bf16 v[216:219], v[176:179], v[136:139], v[216:219]
  ds_read_b64_tr_b16 v[192:193], v23 offset:384
  v_mfma_f32_16x16x32_bf16 v[236:239], v[176:179], v[140:143], v[236:239]
  ds_read_b64_tr_b16 v[194:195], v21 offset:128
  s_waitcnt lgkmcnt(6)
  v_mfma_f32_16x16x32_bf16 v[220:223], v[180:183], v[136:139], v[220:223]
  ds_read_b64_tr_b16 v[176:177], v22 offset:15104
  v_mfma_f32_16x16x32_bf16 v[240:243], v[180:183], v[140:143], v[240:243]
  ds_read_b64_tr_b16 v[178:179], v22 offset:17408
  s_waitcnt lgkmcnt(6)
  v_mfma_f32_16x16x32_bf16 v[224:227], v[184:187], v[136:139], v[224:227]
  ds_read_b64_tr_b16 v[180:181], v22 offset:15136
  v_mfma_f32_16x16x32_bf16 v[244:247], v[184:187], v[140:143], v[244:247]
  ds_read_b64_tr_b16 v[182:183], v22 offset:17440
  s_waitcnt lgkmcnt(6)
  v_mfma_f32_16x16x32_bf16 v[228:231], v[188:191], v[136:139], v[228:231]
  ds_read_b64_tr_b16 v[184:185], v22 offset:15168
  v_mfma_f32_16x16x32_bf16 v[248:251], v[188:191], v[140:143], v[248:251]
  ds_read_b64_tr_b16 v[186:187], v22 offset:17472
  s_waitcnt lgkmcnt(6)
  v_mfma_f32_16x16x32_bf16 v[232:235], v[192:195], v[136:139], v[232:235]
  ds_read_b64_tr_b16 v[188:189], v22 offset:15200
  v_mfma_f32_16x16x32_bf16 v[252:255], v[192:195], v[140:143], v[252:255]
  ds_read_b64_tr_b16 v[190:191], v22 offset:17504
  s_waitcnt vmcnt(6) lgkmcnt(6)
  v_mfma_f32_16x16x32_bf16 v[216:219], v[176:179], v[144:147], v[216:219]
  ds_read_b64_tr_b16 v[192:193], v22 offset:15232
  v_mfma_f32_16x16x32_bf16 v[236:239], v[176:179], v[148:151], v[236:239]
  ds_read_b64_tr_b16 v[194:195], v22 offset:17536
  s_waitcnt lgkmcnt(6)
  v_mfma_f32_16x16x32_bf16 v[220:223], v[180:183], v[144:147], v[220:223]
  ds_read_b64_tr_b16 v[176:177], v22 offset:24320
  v_mfma_f32_16x16x32_bf16 v[240:243], v[180:183], v[148:151], v[240:243]
  ds_read_b64_tr_b16 v[178:179], v22 offset:26624
  s_waitcnt lgkmcnt(6)
  v_mfma_f32_16x16x32_bf16 v[224:227], v[184:187], v[144:147], v[224:227]
  ds_read_b64_tr_b16 v[180:181], v22 offset:24352
  v_mfma_f32_16x16x32_bf16 v[244:247], v[184:187], v[148:151], v[244:247]
  ds_read_b64_tr_b16 v[182:183], v22 offset:26656
  s_waitcnt lgkmcnt(6)
  v_mfma_f32_16x16x32_bf16 v[228:231], v[188:191], v[144:147], v[228:231]
  ds_read_b64_tr_b16 v[184:185], v22 offset:24384
  v_mfma_f32_16x16x32_bf16 v[248:251], v[188:191], v[148:151], v[248:251]
  ds_read_b64_tr_b16 v[186:187], v22 offset:26688
  s_waitcnt lgkmcnt(6)
  v_mfma_f32_16x16x32_bf16 v[232:235], v[192:195], v[144:147], v[232:235]
  ds_read_b64_tr_b16 v[188:189], v22 offset:24416
  v_mfma_f32_16x16x32_bf16 v[252:255], v[192:195], v[148:151], v[252:255]
  ds_read_b64_tr_b16 v[190:191], v22 offset:26720
  s_waitcnt vmcnt(4) lgkmcnt(6)
  v_mfma_f32_16x16x32_bf16 v[216:219], v[176:179], v[152:155], v[216:219]
  ds_read_b64_tr_b16 v[192:193], v22 offset:24448
  v_mfma_f32_16x16x32_bf16 v[236:239], v[176:179], v[156:159], v[236:239]
  ds_read_b64_tr_b16 v[194:195], v22 offset:26752
  s_waitcnt lgkmcnt(6)
  v_mfma_f32_16x16x32_bf16 v[220:223], v[180:183], v[152:155], v[220:223]
  ds_read_b64_tr_b16 v[176:177], v22 offset:33536
  v_mfma_f32_16x16x32_bf16 v[240:243], v[180:183], v[156:159], v[240:243]
  ds_read_b64_tr_b16 v[178:179], v22 offset:35840
  s_waitcnt lgkmcnt(6)
  v_mfma_f32_16x16x32_bf16 v[224:227], v[184:187], v[152:155], v[224:227]
  ds_read_b64_tr_b16 v[180:181], v22 offset:33568
  v_mfma_f32_16x16x32_bf16 v[244:247], v[184:187], v[156:159], v[244:247]
  ds_read_b64_tr_b16 v[182:183], v22 offset:35872
  s_waitcnt lgkmcnt(6)
  v_mfma_f32_16x16x32_bf16 v[228:231], v[188:191], v[152:155], v[228:231]
  ds_read_b64_tr_b16 v[184:185], v22 offset:33600
  v_mfma_f32_16x16x32_bf16 v[248:251], v[188:191], v[156:159], v[248:251]
  ds_read_b64_tr_b16 v[186:187], v22 offset:35904
  s_waitcnt lgkmcnt(6)
  v_mfma_f32_16x16x32_bf16 v[232:235], v[192:195], v[152:155], v[232:235]
  ds_read_b64_tr_b16 v[188:189], v22 offset:33632
  v_mfma_f32_16x16x32_bf16 v[252:255], v[192:195], v[156:159], v[252:255]
  ds_read_b64_tr_b16 v[190:191], v22 offset:35936
  s_waitcnt vmcnt(2) lgkmcnt(6)
  v_mfma_f32_16x16x32_bf16 v[216:219], v[176:179], v[160:163], v[216:219]
  ds_read_b64_tr_b16 v[192:193], v22 offset:33664
  v_mfma_f32_16x16x32_bf16 v[236:239], v[176:179], v[164:167], v[236:239]
  ds_read_b64_tr_b16 v[194:195], v22 offset:35968
  s_waitcnt lgkmcnt(6)
  v_mfma_f32_16x16x32_bf16 v[220:223], v[180:183], v[160:163], v[220:223]
  ds_read_b64_tr_b16 v[176:177], v23 offset:23296
  v_mfma_f32_16x16x32_bf16 v[240:243], v[180:183], v[164:167], v[240:243]
  ds_read_b64_tr_b16 v[178:179], v23 offset:20992
  s_waitcnt lgkmcnt(6)
  v_mfma_f32_16x16x32_bf16 v[224:227], v[184:187], v[160:163], v[224:227]
  ds_read_b64_tr_b16 v[180:181], v23 offset:23328
  v_mfma_f32_16x16x32_bf16 v[244:247], v[184:187], v[164:167], v[244:247]
  ds_read_b64_tr_b16 v[182:183], v23 offset:21024
  s_waitcnt lgkmcnt(6)
  v_mfma_f32_16x16x32_bf16 v[228:231], v[188:191], v[160:163], v[228:231]
  ds_read_b64_tr_b16 v[184:185], v23 offset:23360
  v_mfma_f32_16x16x32_bf16 v[248:251], v[188:191], v[164:167], v[248:251]
  ds_read_b64_tr_b16 v[186:187], v23 offset:21056
  s_waitcnt lgkmcnt(6)
  v_mfma_f32_16x16x32_bf16 v[232:235], v[192:195], v[160:163], v[232:235]
  ds_read_b64_tr_b16 v[188:189], v23 offset:23392
  v_mfma_f32_16x16x32_bf16 v[252:255], v[192:195], v[164:167], v[252:255]
  ds_read_b64_tr_b16 v[190:191], v23 offset:21088
  s_waitcnt vmcnt(0) lgkmcnt(6)
  v_mfma_f32_16x16x32_bf16 v[216:219], v[176:179], v[168:171], v[216:219]
  ds_read_b64_tr_b16 v[192:193], v23 offset:23424
  v_mfma_f32_16x16x32_bf16 v[236:239], v[176:179], v[172:175], v[236:239]
  ds_read_b64_tr_b16 v[194:195], v23 offset:21120
  s_waitcnt lgkmcnt(6)
  v_mfma_f32_16x16x32_bf16 v[220:223], v[180:183], v[168:171], v[220:223]
  v_mfma_f32_16x16x32_bf16 v[240:243], v[180:183], v[172:175], v[240:243]
  s_waitcnt lgkmcnt(4)
  v_mfma_f32_16x16x32_bf16 v[224:227], v[184:187], v[168:171], v[224:227]
  v_mfma_f32_16x16x32_bf16 v[244:247], v[184:187], v[172:175], v[244:247]
  s_waitcnt lgkmcnt(2)
  v_mfma_f32_16x16x32_bf16 v[228:231], v[188:191], v[168:171], v[228:231]
  v_mfma_f32_16x16x32_bf16 v[248:251], v[188:191], v[172:175], v[248:251]
  s_waitcnt lgkmcnt(0)
  v_mfma_f32_16x16x32_bf16 v[232:235], v[192:195], v[168:171], v[232:235]
  v_mfma_f32_16x16x32_bf16 v[252:255], v[192:195], v[172:175], v[252:255]
  s_nop 7
  s_branch L_pc_done
L_pc_b1:
  ds_read_b64_tr_b16 v[176:177], v21 offset:11520
  ds_read_b64_tr_b16 v[178:179], v21 offset:13824
  ds_read_b64_tr_b16 v[180:181], v21 offset:11552
  ds_read_b64_tr_b16 v[182:183], v21 offset:13856
  ds_read_b64_tr_b16 v[184:185], v21 offset:11584
  ds_read_b64_tr_b16 v[186:187], v21 offset:13888
  ds_read_b64_tr_b16 v[188:189], v21 offset:11616
  ds_read_b64_tr_b16 v[190:191], v21 offset:13920
  s_waitcnt vmcnt(34) lgkmcnt(6)
  v_mfma_f32_16x16x32_bf16 v[216:219], v[176:179], v[32:35], 0
  ds_read_b64_tr_b16 v[192:193], v21 offset:11648
  v_mfma_f32_16x16x32_bf16 v[236:239], v[176:179], v[36:39], 0
  ds_read_b64_tr_b16 v[194:195], v21 offset:13952
  s_waitcnt lgkmcnt(6)
  v_mfma_f32_16x16x32_bf16 v[220:223], v[180:183], v[32:35], 0
  ds_read_b64_tr_b16 v[176:177], v21 offset:20736
  v_mfma_f32_16x16x32_bf16 v[240:243], v[180:183], v[36:39], 0
  ds_read_b64_tr_b16 v[178:179], v21 offset:23040
  s_waitcnt lgkmcnt(6)
  v_mfma_f32_16x16x32_bf16 v[224:227], v[184:187], v[32:35], 0
  ds_read_b64_tr_b16 v[180:181], v21 offset:20768
  v_mfma_f32_16x16x32_bf16 v[244:247], v[184:187], v[36:39], 0
  ds_read_b64_tr_b16 v[182:183], v21 offset:23072
  s_waitcnt lgkmcnt(6)
  v_mfma_f32_16x16x32_bf16 v[228:231], v[188:191], v[32:35], 0
  ds_read_b64_tr_b16 v[184:185], v21 offset:20800
  v_mfma_f32_16x16x32_bf16 v[248:251], v[188:191], v[36:39], 0
  ds_read_b64_tr_b16 v[186:187], v21 offset:23104
  s_waitcnt lgkmcnt(6)
  v_mfma_f32_16x16x32_bf16 v[232:235], v[192:195], v[32:35], 0
  ds_read_b64_tr_b16 v[188:189], v21 offset:20832
  v_mfma_f32_16x16x32_bf16 v[252:255], v[192:195], v[36:39], 0
  ds_read_b64_tr_b16 v[190:191], v21 offset:23136
  s_waitcnt vmcnt(32) lgkmcnt(6)
  v_mfma_f32_16x16x32_bf16 v[216:219], v[176:179], v[40:43], v[216:219]
  ds_read_b64_tr_b16 v[192:193], v21 offset:20864
  v_mfma_f32_16x16x32_bf16 v[236:239], v[176:179], v[44:47], v[236:239]
  ds_read_b64_tr_b16 v[194:195], v21 offset:23168
  s_waitcnt lgkmcnt(6)
  v_mfma_f32_16x16x32_bf16 v[220:223], v[180:183], v[40:43], v[220:223]
  ds_read_b64_tr_b16 v[176:177], v21 offset:29952
  v_mfma_f32_16x16x32_bf16 v[240:243], v[180:183], v[44:47], v[240:243]
  ds_read_b64_tr_b16 v[178:179], v21 offset:32256
  s_waitcnt lgkmcnt(6)
  v_mfma_f32_16x16x32_bf16 v[224:227], v[184:187], v[40:43], v[224:227]
  ds_read_b64_tr_b16 v[180:181], v21 offset:29984
  v_mfma_f32_16x16x32_bf16 v[244:247], v[184:187], v[44:47], v[244:247]
  ds_read_b64_tr_b16 v[182:183], v21 offset:32288
  s_waitcnt lgkmcnt(6)
  v_mfma_f32_16x16x32_bf16 v[228:231], v[188:191], v[40:43], v[228:231]
  ds_read_b64_tr_b16 v[184:185], v21 offset:30016
  v_mfma_f32_16x16x32_bf16 v[248:251], v[188:191], v[44:47], v[248:251]
  ds_read_b64_tr_b16 v[186:187], v21 offset:32320
  s_waitcnt lgkmcnt(6)
  v_mfma_f32_16x16x32_bf16 v[232:235], v[192:195], v[40:43], v[232:235]
  ds_read_b64_tr_b16 v[188:189], v21 offset:30048
  v_mfma_f32_16x16x32_bf16 v[252:255], v[192:195], v[44:47], v[252:255]
  ds_read_b64_tr_b16 v[190:191], v21 offset:32352
  s_waitcnt vmcnt(30) lgkmcnt(6)
  v_mfma_f32_16x16x32_bf16 v[216:219], v[176:179], v[48:51], v[216:219]
  ds_read_b64_tr_b16 v[192:193], v21 offset:30080
  v_mfma_f32_16x16x32_bf16 v[236:239], v[176:179], v[52:55], v[236:239]
  ds_read_b64_tr_b16 v[194:195], v21 offset:32384
  s_waitcnt lgkmcnt(6)
  v_mfma_f32_16x16x32_bf16 v[220:223], v[180:183], v[48:51], v[220:223]
  ds_read_b64_tr_b16 v[176:177], v21 offset:39168
  v_mfma_f32_16x16x32_bf16 v[240:243], v[180:183], v[52:55], v[240:243]
  ds_read_b64_tr_b16 v[178:179], v23 offset:2560
  s_waitcnt lgkmcnt(6)
  v_mfma_f32_16x16x32_bf16 v[224:227], v[184:187], v[48:51], v[224:227]
  ds_read_b64_tr_b16 v[180:181], v21 offset:39200
  v_mfma_f32_16x16x32_bf16 v[244:247], v[184:187], v[52:55], v[244:247]
  ds_read_b64_tr_b16 v[182:183], v23 offset:2592
  s_waitcnt lgkmcnt(6)
  v_mfma_f32_16x16x32_bf16 v[228:231], v[188:191], v[48:51], v[228:231]
  ds_read_b64_tr_b16 v[184:185], v21 offset:39232
  v_mfma_f32_16x16x32_bf16 v[248:251], v[188:191], v[52:55], v[248:251]
  ds_read_b64_tr_b16 v[186:187], v23 offset:2624
  s_waitcnt lgkmcnt(6)
  v_mfma_f32_16x16x32_bf16 v[232:235], v[192:195], v[48:51], v[232:235]
  ds_read_b64_tr_b16 v[188:189], v21 offset:39264
  v_mfma_f32_16x16x32_bf16 v[252:255], v[192:195], v[52:55], v[252:255]
  ds_read_b64_tr_b16 v[190:191], v23 offset:2656
  s_waitcnt vmcnt(28) lgkmcnt(6)
  v_mfma_f32_16x16x32_bf16 v[216:219], v[176:179], v[56:59], v[216:219]
  ds_read_b64_tr_b16 v[192:193], v21 offset:39296
  v_mfma_f32_16x16x32_bf16 v[236:239], v[176:179], v[60:63], v[236:239]
  ds_read_b64_tr_b16 v[194:195], v23 offset:2688
  s_waitcnt lgkmcnt(6)
  v_mfma_f32_16x16x32_bf16 v[220:223], v[180:183], v[56:59], v[220:223]
  ds_read_b64_tr_b16 v[176:177], v23 offset:9472
  v_mfma_f32_16x16x32_bf16 v[240:243], v[180:183], v[60:63], v[240:243]
  ds_read_b64_tr_b16 v[178:179], v23 offset:11776
  s_waitcnt lgkmcnt(6)
  v_mfma_f32_16x16x32_bf16 v[224:227], v[184:187], v[56:59], v[224:227]
  ds_read_b64_tr_b16 v[180:181], v23 offset:9504
  v_mfma_f32_16x16x32_bf16 v[244:247], v[184:187], v[60:63], v[244:247]
  ds_read_b64_tr_b16 v[182:183], v23 offset:11808
  s_waitcnt lgkmcnt(6)
  v_mfma_f32_16x16x32_bf16 v[228:231], v[188:191], v[56:59], v[228:231]
  ds_read_b64_tr_b16 v[184:185], v23 offset:9536
  v_mfma_f32_16x16x32_bf16 v[248:251], v[188:191], v[60:63], v[248:251]
  ds_read_b64_tr_b16 v[186:187], v23 offset:11840
  s_waitcnt lgkmcnt(6)
  v_mfma_f32_16x16x32_bf16 v[232:235], v[192:195], v[56:59], v[232:235]
  ds_read_b64_tr_b16 v[188:189], v23 offset:9568
  v_mfma_f32_16x16x32_bf16 v[252:255], v[192:195], v[60:63], v[252:255]
  ds_read_b64_tr_b16 v[190:191], v23 offset:11872
  s_waitcnt vmcnt(26) lgkmcnt(6)
  v_mfma_f32_16x16x32_bf16 v[216:219], v[176:179], v[64:67], v[216:219]
  ds_read_b64_tr_b16 v[192:193], v23 offset:9600
  v_mfma_f32_16x16x32_bf16 v[236:239], v[176:179], v[68:71], v[236:239]
  ds_read_b64_tr_b16 v[194:195], v23 offset:11904
  s_waitcnt lgkmcnt(6)
  v_mfma_f32_16x16x32_bf16 v[220:223], v[180:183], v[64:67], v[220:223]
  ds_read_b64_tr_b16 v[176:177], v23 offset:18688
  v_mfma_f32_16x16x32_bf16 v[240:243], v[180:183], v[68:71], v[240:243]
  ds_read_b64_tr_b16 v[178:179], v21 offset:41472
  s_waitcnt lgkmcnt(6)
  v_mfma_f32_16x16x32_bf16 v[224:227], v[184:187], v[64:67], v[224:227]
  ds_read_b64_tr_b16 v[180:181], v23 offset:18720
  v_mfma_f32_16x16x32_bf16 v[244:247], v[184:187], v[68:71], v[244:247]
  ds_read_b64_tr_b16 v[182:183], v21 offset:41504
  s_waitcnt lgkmcnt(6)
  v_mfma_f32_16x16x32_bf16 v[228:231], v[188:191], v[64:67], v[228:231]
  ds_read_b64_tr_b16 v[184:185], v23 offset:18752
  v_mfma_f32_16x16x32_bf16 v[248:251], v[188:191], v[68:71], v[248:251]
  ds_read_b64_tr_b16 v[186:187], v21 offset:41536
  s_waitcnt lgkmcnt(6)
  v_mfma_f32_16x16x32_bf16 v[232:235], v[192:195], v[64:67], v[232:235]
  ds_read_b64_tr_b16 v[188:189], v23 offset:18784
  v_mfma_f32_16x16x32_bf16 v[252:255], v[192:195], v[68:71], v[252:255]
  ds_read_b64_tr_b16 v[190:191], v21 offset:41568
  s_waitcnt vmcnt(24) lgkmcnt(6)
  v_mfma_f32_16x16x32_bf16 v[216:219], v[176:179], v[72:75], v[216:219]
  ds_read_b64_tr_b16 v[192:193], v23 offset:18816
  v_mfma_f32_16x16x32_bf16 v[236:239], v[176:179], v[76:79], v[236:239]
  ds_read_b64_tr_b16 v[194:195], v21 offset:41600
  s_waitcnt lgkmcnt(6)
  v_mfma_f32_16x16x32_bf16 v[220:223], v[180:183], v[72:75], v[220:223]
  ds_read_b64_tr_b16 v[176:177], v21 offset:48384
  v_mfma_f32_16x16x32_bf16 v[240:243], v[180:183], v[76:79], v[240:243]
  ds_read_b64_tr_b16 v[178:179], v21 offset:50688
  s_waitcnt lgkmcnt(6)
  v_mfma_f32_16x16x32_bf16 v[224:227], v[184:187], v[72:75], v[224:227]
  ds_read_b64_tr_b16 v[180:181], v21 offset:48416
  v_mfma_f32_16x16x32_bf16 v[244:247], v[184:187], v[76:79], v[244:247]
  ds_read_b64_tr_b16 v[182:183], v21 offset:50720
  s_waitcnt lgkmcnt(6)
  v_mfma_f32_16x16x32_bf16 v[228:231], v[188:191], v[72:75], v[228:231]
  ds_read_b64_tr_b16 v[184:185], v21 offset:48448
  v_mfma_f32_16x16x32_bf16 v[248:251], v[188:191], v[76:79], v[248:251]
  ds_read_b64_tr_b16 v[186:187], v21 offset:50752
  s_waitcnt lgkmcnt(6)
  v_mfma_f32_16x16x32_bf16 v[232:235], v[192:195], v[72:75], v[232:235]
  ds_read_b64_tr_b16 v[188:189], v21 offset:48480
  v_mfma_f32_16x16x32_bf16 v[252:255], v[192:195], v[76:79], v[252:255]
  ds_read_b64_tr_b16 v[190:191], v21 offset:50784
  s_waitcnt vmcnt(22) lgkmcnt(6)
  v_mfma_f32_16x16x32_bf16 v[216:219], v[176:179], v[80:83], v[216:219]
  ds_read_b64_tr_b16 v[192:193], v21 offset:48512
  v_mfma_f32_16x16x32_bf16 v[236:239], v[176:179], v[84:87], v[236:239]
  ds_read_b64_tr_b16 v[194:195], v21 offset:50816
  s_waitcnt lgkmcnt(6)
  v_mfma_f32_16x16x32_bf16 v[220:223], v[180:183], v[80:83], v[220:223]
  ds_read_b64_tr_b16 v[176:177], v21 offset:57600
  v_mfma_f32_16x16x32_bf16 v[240:243], v[180:183], v[84:87], v[240:243]
  ds_read_b64_tr_b16 v[178:179], v21 offset:59904
  s_waitcnt lgkmcnt(6)
  v_mfma_f32_16x16x32_bf16 v[224:227], v[184:187], v[80:83], v[224:227]
  ds_read_b64_tr_b16 v[180:181], v21 offset:57632
  v_mfma_f32_16x16x32_bf16 v[244:247], v[184:187], v[84:87], v[244:247]
  ds_read_b64_tr_b16 v[182:183], v21 offset:59936
  s_waitcnt lgkmcnt(6)
  v_mfma_f32_16x16x32_bf16 v[228:231], v[188:191], v[80:83], v[228:231]
  ds_read_b64_tr_b16 v[184:185], v21 offset:57664
  v_mfma_f32_16x16x32_bf16 v[248:251], v[188:191], v[84:87], v[248:251]
  ds_read_b64_tr_b16 v[186:187], v21 offset:59968
  s_waitcnt lgkmcnt(6)
  v_mfma_f32_16x16x32_bf16 v[232:235], v[192:195], v[80:83], v[232:235]
  ds_read_b64_tr_b16 v[188:189], v21 offset:57696
  v_mfma_f32_16x16x32_bf16 v[252:255], v[192:195], v[84:87], v[252:255]
  ds_read_b64_tr_b16 v[190:191], v21 offset:60000
  s_waitcnt vmcnt(20) lgkmcnt(6)
  v_mfma_f32_16x16x32_bf16 v[216:219], v[176:179], v[88:91], v[216:219]
  ds_read_b64_tr_b16 v[192:193], v21 offset:57728
  v_mfma_f32_16x16x32_bf16 v[236:239], v[176:179], v[92:95], v[236:239]
  ds_read_b64_tr_b16 v[194:195], v21 offset:60032
  s_waitcnt lgkmcnt(6)
  v_mfma_f32_16x16x32_bf16 v[220:223], v[180:183], v[88:91], v[220:223]
  ds_read_b64_tr_b16 v[176:177], v22 offset:1280
  v_mfma_f32_16x16x32_bf16 v[240:243], v[180:183], v[92:95], v[240:243]
  ds_read_b64_tr_b16 v[178:179], v22 offset:3584
  s_waitcnt lgkmcnt(6)
  v_mfma_f32_16x16x32_bf16 v[224:227], v[184:187], v[88:91], v[224:227]
  ds_read_b64_tr_b16 v[180:181], v22 offset:1312
  v_mfma_f32_16x16x32_bf16 v[244:247], v[184:187], v[92:95], v[244:247]
  ds_read_b64_tr_b16 v[182:183], v22 offset:3616
  s_waitcnt lgkmcnt(6)
  v_mfma_f32_16x16x32_bf16 v[228:231], v[188:191], v[88:91], v[228:231]
  ds_read_b64_tr_b16 v[184:185], v22 offset:1344
  v_mfma_f32_16x16x32_bf16 v[248:251], v[188:191], v[92:95], v[248:251]
  ds_read_b64_tr_b16 v[186:187], v22 offset:3648
  s_waitcnt lgkmcnt(6)
  v_mfma_f32_16x16x32_bf16 v[232:235], v[192:195], v[88:91], v[232:235]
  ds_read_b64_tr_b16 v[188:189], v22 offset:1376
  v_mfma_f32_16x16x32_bf16 v[252:255], v[192:195], v[92:95], v[252:255]
  ds_read_b64_tr_b16 v[190:191], v22 offset:3680
  s_waitcnt vmcnt(18) lgkmcnt(6)
  v_mfma_f32_16x16x32_bf16 v[216:219], v[176:179], v[96:99], v[216:219]
  ds_read_b64_tr_b16 v[192:193], v22 offset:1408
  v_mfma_f32_16x16x32_bf16 v[236:239], v[176:179], v[100:103], v[236:239]
  ds_read_b64_tr_b16 v[194:195], v22 offset:3712
  s_waitcnt lgkmcnt(6)
  v_mfma_f32_16x16x32_bf16 v[220:223], v[180:183], v[96:99], v[220:223]
  ds_read_b64_tr_b16 v[176:177], v22 offset:10496
  v_mfma_f32_16x16x32_bf16 v[240:243], v[180:183], v[100:103], v[240:243]
  ds_read_b64_tr_b16 v[178:179], v22 offset:12800
  s_waitcnt lgkmcnt(6)
  v_mfma_f32_16x16x32_bf16 v[224:227], v[184:187], v[96:99], v[224:227]
  ds_read_b64_tr_b16 v[180:181], v22 offset:10528
  v_mfma_f32_16x16x32_bf16 v[244:247], v[184:187], v[100:103], v[244:247]
  ds_read_b64_tr_b16 v[182:183], v22 offset:12832
  s_waitcnt lgkmcnt(6)
  v_mfma_f32_16x16x32_bf16 v[228:231], v[188:191], v[96:99], v[228:231]
  ds_read_b64_tr_b16 v[184:185], v22 offset:10560
  v_mfma_f32_16x16x32_bf16 v[248:251], v[188:191], v[100:103], v[248:251]
  ds_read_b64_tr_b16 v[186:187], v22 offset:12864
  s_waitcnt lgkmcnt(6)
  v_mfma_f32_16x16x32_bf16 v[232:235], v[192:195], v[96:99], v[232:235]
  ds_read_b64_tr_b16 v[188:189], v22 offset:10592
  v_mfma_f32_16x16x32_bf16 v[252:255], v[192:195], v[100:103], v[252:255]
  ds_read_b64_tr_b16 v[190:191], v22 offset:12896
  s_waitcnt vmcnt(16) lgkmcnt(6)
  v_mfma_f32_16x16x32_bf16 v[216:219], v[176:179], v[104:107], v[216:219]
  ds_read_b64_tr_b16 v[192:193], v22 offset:10624
  v_mfma_f32_16x16x32_bf16 v[236:239], v[176:179], v[108:111], v[236:239]
  ds_read_b64_tr_b16 v[194:195], v22 offset:12928
  s_waitcnt lgkmcnt(6)
  v_mfma_f32_16x16x32_bf16 v[220:223], v[180:183], v[104:107], v[220:223]
  ds_read_b64_tr_b16 v[176:177], v22 offset:42752
  v_mfma_f32_16x16x32_bf16 v[240:243], v[180:183], v[108:111], v[240:243]
  ds_read_b64_tr_b16 v[178:179], v22 offset:45056
  s_waitcnt lgkmcnt(6)
  v_mfma_f32_16x16x32_bf16 v[224:227], v[184:187], v[104:107], v[224:227]
  ds_read_b64_tr_b16 v[180:181], v22 offset:42784
  v_mfma_f32_16x16x32_bf16 v[244:247], v[184:187], v[108:111], v[244:247]
  ds_read_b64_tr_b16 v[182:183], v22 offset:45088
  s_waitcnt lgkmcnt(6)
  v_mfma_f32_16x16x32_bf16 v[228:231], v[188:191], v[104:107], v[228:231]
  ds_read_b64_tr_b16 v[184:185], v22 offset:42816
  v_mfma_f32_16x16x32_bf16 v[248:251], v[188:191], v[108:111], v[248:251]
  ds_read_b64_tr_b16 v[186:187], v22 offset:45120
  s_waitcnt lgkmcnt(6)
  v_mfma_f32_16x16x32_bf16 v[232:235], v[192:195], v[104:107], v[232:235]
  ds_read_b64_tr_b16 v[188:189], v22 offset:42848
  v_mfma_f32_16x16x32_bf16 v[252:255], v[192:195], v[108:111], v[252:255]
  ds_read_b64_tr_b16 v[190:191], v22 offset:45152
  s_waitcnt vmcnt(14) lgkmcnt(6)
  v_mfma_f32_16x16x32_bf16 v[216:219], v[176:179], v[112:115], v[216:219]
  ds_read_b64_tr_b16 v[192:193], v22 offset:42880
  v_mfma_f32_16x16x32_bf16 v[236:239], v[176:179], v[116:119], v[236:239]
  ds_read_b64_tr_b16 v[194:195], v22 offset:45184
  s_waitcnt lgkmcnt(6)
  v_mfma_f32_16x16x32_bf16 v[220:223], v[180:183], v[112:115], v[220:223]
  ds_read_b64_tr_b16 v[176:177], v22 offset:51968
  v_mfma_f32_16x16x32_bf16 v[240:243], v[180:183], v[116:119], v[240:243]
  ds_read_b64_tr_b16 v[178:179], v22 offset:54272
  s_waitcnt lgkmcnt(6)
  v_mfma_f32_16x16x32_bf16 v[224:227], v[184:187], v[112:115], v[224:227]
  ds_read_b64_tr_b16 v[180:181], v22 offset:52000
  v_mfma_f32_16x16x32_bf16 v[244:247], v[184:187], v[116:119], v[244:247]
  ds_read_b64_tr_b16 v[182:183], v22 offset:54304
  s_waitcnt lgkmcnt(6)
  v_mfma_f32_16x16x32_bf16 v[228:231], v[188:191], v[112:115], v[228:231]
  ds_read_b64_tr_b16 v[184:185], v22 offset:52032
  v_mfma_f32_16x16x32_bf16 v[248:251], v[188:191], v[116:119], v[248:251]
  ds_read_b64_tr_b16 v[186:187], v22 offset:54336
  s_waitcnt lgkmcnt(6)
  v_mfma_f32_16x16x32_bf16 v[232:235], v[192:195], v[112:115], v[232:235]
  ds_read_b64_tr_b16 v[188:189], v22 offset:52064
  v_mfma_f32_16x16x32_bf16 v[252:255], v[192:195], v[116:119], v[252:255]
  ds_read_b64_tr_b16 v[190:191], v22 offset:54368
  s_waitcnt vmcnt(12) lgkmcnt(6)
  v_mfma_f32_16x16x32_bf16 v[216:219], v[176:179], v[120:123], v[216:219]
  ds_read_b64_tr_b16 v[192:193], v22 offset:52096
  v_mfma_f32_16x16x32_bf16 v[236:239], v[176:179], v[124:127], v[236:239]
  ds_read_b64_tr_b16 v[194:195], v22 offset:54400
  s_waitcnt lgkmcnt(6)
  v_mfma_f32_16x16x32_bf16 v[220:223], v[180:183], v[120:123], v[220:223]
  ds_read_b64_tr_b16 v[176:177], v22 offset:61184
  v_mfma_f32_16x16x32_bf16 v[240:243], v[180:183], v[124:127], v[240:243]
  ds_read_b64_tr_b16 v[178:179], v22 offset:63488
  s_waitcnt lgkmcnt(6)
  v_mfma_f32_16x16x32_bf16 v[224:227], v[184:187], v[120:123], v[224:227]
  ds_read_b64_tr_b16 v[180:181], v22 offset:61216
  v_mfma_f32_16x16x32_bf16 v[244:247], v[184:187], v[124:127], v[244:247]
  ds_read_b64_tr_b16 v[182:183], v22 offset:63520
  s_waitcnt lgkmcnt(6)
  v_mfma_f32_16x16x32_bf16 v[228:231], v[188:191], v[120:123], v[228:231]
  ds_read_b64_tr_b16 v[184:185], v22 offset:61248
  v_mfma_f32_16x16x32_bf16 v[248:251], v[188:191], v[124:127], v[248:251]
  ds_read_b64_tr_b16 v[186:187], v22 offset:63552
  s_waitcnt lgkmcnt(6)
  v_mfma_f32_16x16x32_bf16 v[232:235], v[192:195], v[120:123], v[232:235]
  ds_read_b64_tr_b16 v[188:189], v22 offset:61280
  v_mfma_f32_16x16x32_bf16 v[252:255], v[192:195], v[124:127], v[252:255]
  ds_read_b64_tr_b16 v[190:191], v22 offset:63584
  s_waitcnt vmcnt(10) lgkmcnt(6)
  v_mfma_f32_16x16x32_bf16 v[216:219], v[176:179], v[128:131], v[216:219]
  ds_read_b64_tr_b16 v[192:193], v22 offset:61312
  v_mfma_f32_16x16x32_bf16 v[236:239], v[176:179], v[132:135], v[236:239]
  ds_read_b64_tr_b16 v[194:195], v22 offset:63616
  s_waitcnt lgkmcnt(6)
  v_mfma_f32_16x16x32_bf16 v[220:223], v[180:183], v[128:131], v[220:223]
  ds_read_b64_tr_b16 v[176:177], v21 offset:2304
  v_mfma_f32_16x16x32_bf16 v[240:243], v[180:183], v[132:135], v[240:243]
  ds_read_b64_tr_b16 v[178:179], v21 offset:4608
  s_waitcnt lgkmcnt(6)
  v_mfma_f32_16x16x32_bf16 v[224:227], v[184:187], v[128:131], v[224:227]
  ds_read_b64_tr_b16 v[180:181], v21 offset:2336
  v_mfma_f32_16x16x32_bf16 v[244:247], v[184:187], v[132:135], v[244:247]
  ds_read_b64_tr_b16 v[182:183], v21 offset:4640
  s_waitcnt lgkmcnt(6)
  v_mfma_f32_16x16x32_bf16 v[228:231], v[188:191], v[128:131], v[228:231]
  ds_read_b64_tr_b16 v[184:185], v21 offset:2368
  v_mfma_f32_16x16x32_bf16 v[248:251], v[188:191], v[132:135], v[248:251]
  ds_read_b64_tr_b16 v[186:187], v21 offset:4672
  s_waitcnt lgkmcnt(6)
  v_mfma_f32_16x16x32_bf16 v[232:235], v[192:195], v[128:131], v[232:235]
  ds_read_b64_tr_b16 v[188:189], v21 offset:2400
  v_mfma_f32_16x16x32_bf16 v[252:255], v[192:195], v[132:135], v[252:255]
  ds_read_b64_tr_b16 v[190:191], v21 offset:4704
  s_waitcnt vmcnt(8) lgkmcnt(6)
  v_mfma_f32_16x16x32_bf16 v[216:219], v[176:179], v[136:139], v[216:219]
  ds_read_b64_tr_b16 v[192:193], v21 offset:2432
  v_mfma_f32_16x16x32_bf16 v[236:239], v[176:179], v[140:143], v[236:239]
  ds_read_b64_tr_b16 v[194:195], v21 offset:4736
  s_waitcnt lgkmcnt(6)
  v_mfma_f32_16x16x32_bf16 v[220:223], v[180:183], v[136:139], v[220:223]
  ds_read_b64_tr_b16 v[176:177], v22 offset:19712
  v_mfma_f32_16x16x32_bf16 v[240:243], v[180:183], v[140:143], v[240:243]
  ds_read_b64_tr_b16 v[178:179], v22 offset:22016
  s_waitcnt lgkmcnt(6)
  v_mfma_f32_16x16x32_bf16 v[224:227], v[184:187], v[136:139], v[224:227]
  ds_read_b64_tr_b16 v[180:181], v22 offset:19744
  v_mfma_f32_16x16x32_bf16 v[244:247], v[184:187], v[140:143], v[244:247]
  ds_read_b64_tr_b16 v[182:183], v22 offset:22048
  s_waitcnt lgkmcnt(6)
  v_mfma_f32_16x16x32_bf16 v[228:231], v[188:191], v[136:139], v[228:231]
  ds_read_b64_tr_b16 v[184:185], v22 offset:19776
  v_mfma_f32_16x16x32_bf16 v[248:251], v[188:191], v[140:143], v[248:251]
  ds_read_b64_tr_b16 v[186:187], v22 offset:22080
  s_waitcnt lgkmcnt(6)
  v_mfma_f32_16x16x32_bf16 v[232:235], v[192:195], v[136:139], v[232:235]
  ds_read_b64_tr_b16 v[188:189], v22 offset:19808
  v_mfma_f32_16x16x32_bf16 v[252:255], v[192:195], v[140:143], v[252:255]
  ds_read_b64_tr_b16 v[190:191], v22 offset:22112
  s_waitcnt vmcnt(6) lgkmcnt(6)
  v_mfma_f32_16x16x32_bf16 v[216:219], v[176:179], v[144:147], v[216:219]
  ds_read_b64_tr_b16 v[192:193], v22 offset:19840
  v_mfma_f32_16x16x32_bf16 v[236:239], v[176:179], v[148:151], v[236:239]
  ds_read_b64_tr_b16 v[194:195], v22 offset:22144
  s_waitcnt lgkmcnt(6)
  v_mfma_f32_16x16x32_bf16 v[220:223], v[180:183], v[144:147], v[220:223]
  ds_read_b64_tr_b16 v[176:177], v22 offset:28928
  v_mfma_f32_16x16x32_bf16 v[240:243], v[180:183], v[148:151], v[240:243]
  ds_read_b64_tr_b16 v[178:179], v22 offset:31232
  s_waitcnt lgkmcnt(6)
  v_mfma_f32_16x16x32_bf16 v[224:227], v[184:187], v[144:147], v[224:227]
  ds_read_b64_tr_b16 v[180:181], v22 offset:28960
  v_mfma_f32_16x16x32_bf16 v[244:247], v[184:187], v[148:151], v[244:247]
  ds_read_b64_tr_b16 v[182:183], v22 offset:31264
  s_waitcnt lgkmcnt(6)
  v_mfma_f32_16x16x32_bf16 v[228:231], v[188:191], v[144:147], v[228:231]
  ds_read_b64_tr_b16 v[184:185], v22 offset:28992
  v_mfma_f32_16x16x32_bf16 v[248:251], v[188:191], v[148:151], v[248:251]
  ds_read_b64_tr_b16 v[186:187], v22 offset:31296
  s_waitcnt lgkmcnt(6)
  v_mfma_f32_16x16x32_bf16 v[232:235], v[192:195], v[144:147], v[232:235]
  ds_read_b64_tr_b16 v[188:189], v22 offset:29024
  v_mfma_f32_16x16x32_bf16 v[252:255], v[192:195], v[148:151], v[252:255]
  ds_read_b64_tr_b16 v[190:191], v22 offset:31328
  s_waitcnt vmcnt(4) lgkmcnt(6)
  v_mfma_f32_16x16x32_bf16 v[216:219], v[176:179], v[152:155], v[216:219]
  ds_read_b64_tr_b16 v[192:193], v22 offset:29056
  v_mfma_f32_16x16x32_bf16 v[236:239], v[176:179], v[156:159], v[236:239]
  ds_read_b64_tr_b16 v[194:195], v22 offset:31360
  s_waitcnt lgkmcnt(6)
  v_mfma_f32_16x16x32_bf16 v[220:223], v[180:183], v[152:155], v[220:223]
  ds_read_b64_tr_b16 v[176:177], v23 offset:25600
  v_mfma_f32_16x16x32_bf16 v[240:243], v[180:183], v[156:159], v[240:243]
  ds_read_b64_tr_b16 v[178:179], v23 offset:27904
  s_waitcnt lgkmcnt(6)
  v_mfma_f32_16x16x32_bf16 v[224:227], v[184:187], v[152:155], v[224:227]
  ds_read_b64_tr_b16 v[180:181], v23 offset:25632
  v_mfma_f32_16x16x32_bf16 v[244:247], v[184:187], v[156:159], v[244:247]
  ds_read_b64_tr_b16 v[182:183], v23 offset:27936
  s_waitcnt lgkmcnt(6)
  v_mfma_f32_16x16x32_bf16 v[228:231], v[188:191], v[152:155], v[228:231]
  ds_read_b64_tr_b16 v[184:185], v23 offset:25664
  v_mfma_f32_16x16x32_bf16 v[248:251], v[188:191], v[156:159], v[248:251]
  ds_read_b64_tr_b16 v[186:187], v23 offset:27968
  s_waitcnt lgkmcnt(6)
  v_mfma_f32_16x16x32_bf16 v[232:235], v[192:195], v[152:155], v[232:235]
  ds_read_b64_tr_b16 v[188:189], v23 offset:25696
  v_mfma_f32_16x16x32_bf16 v[252:255], v[192:195], v[156:159], v[252:255]
  ds_read_b64_tr_b16 v[190:191], v23 offset:28000
  s_waitcnt vmcnt(2) lgkmcnt(6)
  v_mfma_f32_16x16x32_bf16 v[216:219], v[176:179], v[160:163], v[216:219]
  ds_read_b64_tr_b16 v[192:193], v23 offset:25728
  v_mfma_f32_16x16x32_bf16 v[236:239], v[176:179], v[164:167], v[236:239]
  ds_read_b64_tr_b16 v[194:195], v23 offset:28032
  s_waitcnt lgkmcnt(6)
  v_mfma_f32_16x16x32_bf16 v[220:223], v[180:183], v[160:163], v[220:223]
  v_mfma_f32_16x16x32_bf16 v[240:243], v[180:183], v[164:167], v[240:243]
  s_waitcnt lgkmcnt(4)
  v_mfma_f32_16x16x32_bf16 v[224:227], v[184:187], v[160:163], v[224:227]
  v_mfma_f32_16x16x32_bf16 v[244:247], v[184:187], v[164:167], v[244:247]
  s_waitcnt lgkmcnt(2)
  v_mfma_f32_16x16x32_bf16 v[228:231], v[188:191], v[160:163], v[228:231]
  v_mfma_f32_16x16x32_bf16 v[248:251], v[188:191], v[164:167], v[248:251]
  s_waitcnt lgkmcnt(0)
  v_mfma_f32_16x16x32_bf16 v[232:235], v[192:195], v[160:163], v[232:235]
  v_mfma_f32_16x16x32_bf16 v[252:255], v[192:195], v[164:167], v[252:255]
  s_waitcnt vmcnt(0)
  v_mfma_f32_16x16x32_bf16 v[216:219], v[196:199], v[168:171], v[216:219]
  v_mfma_f32_16x16x32_bf16 v[236:239], v[196:199], v[172:175], v[236:239]
  v_mfma_f32_16x16x32_bf16 v[220:223], v[200:203], v[168:171], v[220:223]
  v_mfma_f32_16x16x32_bf16 v[240:243], v[200:203], v[172:175], v[240:243]
  v_mfma_f32_16x16x32_bf16 v[224:227], v[204:207], v[168:171], v[224:227]
  v_mfma_f32_16x16x32_bf16 v[244:247], v[204:207], v[172:175], v[244:247]
  v_mfma_f32_16x16x32_bf16 v[228:231], v[208:211], v[168:171], v[228:231]
  v_mfma_f32_16x16x32_bf16 v[248:251], v[208:211], v[172:175], v[248:251]
  v_mfma_f32_16x16x32_bf16 v[232:235], v[212:215], v[168:171], v[232:235]
  v_mfma_f32_16x16x32_bf16 v[252:255], v[212:215], v[172:175], v[252:255]
  s_nop 7
L_pc_done:
  v_mov_b32 v14, 163088
  v_mov_b32 v15, 1
  s_mov_b64 exec, 1
  ds_add_u32 v14, v15
  s_mov_b64 exec, -1
  v_cvt_pk_bf16_f32 v32, v216, v217
  v_cvt_pk_bf16_f32 v33, v218, v219
  v_cvt_pk_bf16_f32 v34, v220, v221
  v_cvt_pk_bf16_f32 v35, v222, v223
  v_cvt_pk_bf16_f32 v36, v224, v225
  v_cvt_pk_bf16_f32 v37, v226, v227
  v_cvt_pk_bf16_f32 v38, v228, v229
  v_cvt_pk_bf16_f32 v39, v230, v231
  v_cvt_pk_bf16_f32 v40, v232, v233
  v_cvt_pk_bf16_f32 v41, v234, v235
  v_cvt_pk_bf16_f32 v42, v236, v237
  v_cvt_pk_bf16_f32 v43, v238, v239
  v_cvt_pk_bf16_f32 v44, v240, v241
  v_cvt_pk_bf16_f32 v45, v242, v243
  v_cvt_pk_bf16_f32 v46, v244, v245
  v_cvt_pk_bf16_f32 v47, v246, v247
  v_cvt_pk_bf16_f32 v48, v248, v249
  v_cvt_pk_bf16_f32 v49, v250, v251
  v_cvt_pk_bf16_f32 v50, v252, v253
  v_cvt_pk_bf16_f32 v51, v254, v255
  s_cmp_eq_u32 s48, 1
  s_cselect_b64 vcc, -1, 0
  v_cndmask_b32 v10, v10, v11, vcc
  v_cvt_pk_bf16_f32 v10, v10, v10
  v_lshlrev_b32 v10, 16, v10
  v_mul_f32 v10, s62, v10
  v_exp_f32 v10, v10
  s_nop 0
  v_add_f32 v10, 1.0, v10
  v_rcp_f32 v10, v10
  s_nop 0
  v_cvt_pk_bf16_f32 v10, v10, v10
  v_lshlrev_b32 v10, 16, v10
  v_sub_f32 v11, 1.0, v10
  v_cvt_pk_bf16_f32 v11, v11, v11
  v_lshlrev_b32 v11, 16, v11
  v_cndmask_b32 v12, v10, v11, vcc
  v_cndmask_b32 v14, v11, v10, vcc
  v_cndmask_b32 v52, v42, v32, vcc
  v_cndmask_b32 v64, v32, v42, vcc
  v_cndmask_b32 v53, v43, v33, vcc
  v_cndmask_b32 v65, v33, v43, vcc
  v_cndmask_b32 v54, v44, v34, vcc
  v_cndmask_b32 v66, v34, v44, vcc
  v_cndmask_b32 v55, v45, v35, vcc
  v_cndmask_b32 v67, v35, v45, vcc
  v_cndmask_b32 v56, v46, v36, vcc
  v_cndmask_b32 v68, v36, v46, vcc
  v_cndmask_b32 v57, v47, v37, vcc
  v_cndmask_b32 v69, v37, v47, vcc
  v_cndmask_b32 v58, v48, v38, vcc
  v_cndmask_b32 v70, v38, v48, vcc
  v_cndmask_b32 v59, v49, v39, vcc
  v_cndmask_b32 v71, v39, v49, vcc
  v_cndmask_b32 v60, v50, v40, vcc
  v_cndmask_b32 v72, v40, v50, vcc
  v_cndmask_b32 v61, v51, v41, vcc
  v_cndmask_b32 v73, v41, v51, vcc
  s_mul_i32 s50, s44, 3072
  v_add_u32 v5, s50, v4
  s_xor_b32 s51, s44, 2
  s_mul_i32 s51, s51, 3072
  v_add_u32 v6, s51, v4
  v_mov_b32 v9, 163088
  s_mov_b32 s59, 0
  s_nop 0
L_cw11:
  ds_read_b32 v13, v9
  s_waitcnt lgkmcnt(0)
  v_readfirstlane_b32 s50, v13
  s_add_u32 s59, s59, 1
  s_cmp_gt_u32 s59, 2000000
  s_nop 2
  s_cbranch_scc1 L_cw11d
  s_cmp_ge_u32 s50, 8
  s_cbranch_scc1 L_cw11d
  s_setprio 0
  s_sleep 1
  s_branch L_cw11
L_cw11d:
  ds_write_b128 v5, v[52:55]
  ds_write_b128 v5, v[56:59] offset:1024
  ds_write_b64 v5, v[60:61] offset:2048
  v_mov_b32 v9, 163108
  v_mov_b32 v13, 1
  s_waitcnt lgkmcnt(0)
  s_mov_b64 exec, 1
  ds_add_u32 v9, v13
  s_mov_b64 exec, -1
  s_lshl_b32 s50, s57, 6
  s_lshl_b32 s51, s49, 5
  s_add_u32 s50, s50, s51
  s_lshl_b32 s51, s48, 4
  s_add_u32 s50, s50, s51
  v_add_u32 v7, s50, v2
  s_movk_i32 s51, 1152
  v_mul_lo_u32 v7, v7, s51
  v_lshl_add_u32 v7, v3, 3, v7
  s_mul_i32 s51, s58, 144
  v_add_u32 v7, s51, v7
  v_cmp_lt_u32 vcc, 1, v3
  v_mov_b32 v8, 2147418112
  s_nop 0
  v_cndmask_b32 v8, v7, v8, vcc
  v_lshlrev_b32 v80, 16, v64
  v_and_b32 v81, 0xffff0000, v64
  v_pk_mul_f32 v[80:81], v[80:81], v[12:13] op_sel_hi:[1,0]
  v_cvt_pk_bf16_f32 v64, v80, v81
  v_lshlrev_b32 v80, 16, v64
  v_and_b32 v81, 0xffff0000, v64
  v_lshlrev_b32 v82, 16, v65
  v_and_b32 v83, 0xffff0000, v65
  v_pk_mul_f32 v[82:83], v[82:83], v[12:13] op_sel_hi:[1,0]
  v_cvt_pk_bf16_f32 v65, v82, v83
  v_lshlrev_b32 v82, 16, v65
  v_and_b32 v83, 0xffff0000, v65
  v_lshlrev_b32 v84, 16, v66
  v_and_b32 v85, 0xffff0000, v66
  v_pk_mul_f32 v[84:85], v[84:85], v[12:13] op_sel_hi:[1,0]
  v_cvt_pk_bf16_f32 v66, v84, v85
  v_lshlrev_b32 v84, 16, v66
  v_and_b32 v85, 0xffff0000, v66
  v_lshlrev_b32 v86, 16, v67
  v_and_b32 v87, 0xffff0000, v67
  v_pk_mul_f32 v[86:87], v[86:87], v[12:13] op_sel_hi:[1,0]
  v_cvt_pk_bf16_f32 v67, v86, v87
  v_lshlrev_b32 v86, 16, v67
  v_and_b32 v87, 0xffff0000, v67
  v_lshlrev_b32 v88, 16, v68
  v_and_b32 v89, 0xffff0000, v68
  v_pk_mul_f32 v[88:89], v[88:89], v[12:13] op_sel_hi:[1,0]
  v_cvt_pk_bf16_f32 v68, v88, v89
  v_lshlrev_b32 v88, 16, v68
  v_and_b32 v89, 0xffff0000, v68
  v_lshlrev_b32 v90, 16, v69
  v_and_b32 v91, 0xffff0000, v69
  v_pk_mul_f32 v[90:91], v[90:91], v[12:13] op_sel_hi:[1,0]
  v_cvt_pk_bf16_f32 v69, v90, v91
  v_lshlrev_b32 v90, 16, v69
  v_and_b32 v91, 0xffff0000, v69
  v_lshlrev_b32 v92, 16, v70
  v_and_b32 v93, 0xffff0000, v70
  v_pk_mul_f32 v[92:93], v[92:93], v[12:13] op_sel_hi:[1,0]
  v_cvt_pk_bf16_f32 v70, v92, v93
  v_lshlrev_b32 v92, 16, v70
  v_and_b32 v93, 0xffff0000, v70
  v_lshlrev_b32 v94, 16, v71
  v_and_b32 v95, 0xffff0000, v71
  v_pk_mul_f32 v[94:95], v[94:95], v[12:13] op_sel_hi:[1,0]
  v_cvt_pk_bf16_f32 v71, v94, v95
  v_lshlrev_b32 v94, 16, v71
  v_and_b32 v95, 0xffff0000, v71
  v_lshlrev_b32 v96, 16, v72
  v_and_b32 v97, 0xffff0000, v72
  v_pk_mul_f32 v[96:97], v[96:97], v[12:13] op_sel_hi:[1,0]
  v_cvt_pk_bf16_f32 v72, v96, v97
  v_lshlrev_b32 v96, 16, v72
  v_and_b32 v97, 0xffff0000, v72
  v_lshlrev_b32 v98, 16, v73
  v_and_b32 v99, 0xffff0000, v73
  v_pk_mul_f32 v[98:99], v[98:99], v[12:13] op_sel_hi:[1,0]
  v_cvt_pk_bf16_f32 v73, v98, v99
  v_lshlrev_b32 v98, 16, v73
  v_and_b32 v99, 0xffff0000, v73
  v_mov_b32 v9, 163108
  s_mov_b32 s59, 0
  s_nop 0
L_cw12:
  ds_read_b32 v13, v9
  s_waitcnt lgkmcnt(0)
  v_readfirstlane_b32 s50, v13
  s_add_u32 s59, s59, 1
  s_cmp_gt_u32 s59, 2000000
  s_nop 2
  s_cbranch_scc1 L_cw12d
  s_cmp_ge_u32 s50, 4
  s_cbranch_scc1 L_cw12d
  s_setprio 0
  s_sleep 1
  s_branch L_cw12
L_cw12d:
  ds_read_b128 v[52:55], v6
  ds_read_b128 v[56:59], v6 offset:1024
  ds_read_b64 v[60:61], v6 offset:2048
  s_waitcnt lgkmcnt(0)
  v_lshlrev_b32 v100, 16, v52
  v_and_b32 v101, 0xffff0000, v52
  v_pk_mul_f32 v[100:101], v[100:101], v[14:15] op_sel_hi:[1,0]
  v_cvt_pk_bf16_f32 v52, v100, v101
  v_lshlrev_b32 v100, 16, v52
  v_and_b32 v101, 0xffff0000, v52
  v_pk_add_f32 v[100:101], v[100:101], v[80:81]
  v_cvt_pk_bf16_f32 v32, v100, v101
  v_lshlrev_b32 v102, 16, v53
  v_and_b32 v103, 0xffff0000, v53
  v_pk_mul_f32 v[102:103], v[102:103], v[14:15] op_sel_hi:[1,0]
  v_cvt_pk_bf16_f32 v53, v102, v103
  v_lshlrev_b32 v102, 16, v53
  v_and_b32 v103, 0xffff0000, v53
  v_pk_add_f32 v[102:103], v[102:103], v[82:83]
  v_cvt_pk_bf16_f32 v33, v102, v103
  buffer_store_dwordx2 v[32:33], v7, s[24:27], 0 offen offset:0
  v_lshlrev_b32 v100, 16, v54
  v_and_b32 v101, 0xffff0000, v54
  v_pk_mul_f32 v[100:101], v[100:101], v[14:15] op_sel_hi:[1,0]
  v_cvt_pk_bf16_f32 v54, v100, v101
  v_lshlrev_b32 v100, 16, v54
  v_and_b32 v101, 0xffff0000, v54
  v_pk_add_f32 v[100:101], v[100:101], v[84:85]
  v_cvt_pk_bf16_f32 v34, v100, v101
  v_lshlrev_b32 v102, 16, v55
  v_and_b32 v103, 0xffff0000, v55
  v_pk_mul_f32 v[102:103], v[102:103], v[14:15] op_sel_hi:[1,0]
  v_cvt_pk_bf16_f32 v55, v102, v103
  v_lshlrev_b32 v102, 16, v55
  v_and_b32 v103, 0xffff0000, v55
  v_pk_add_f32 v[102:103], v[102:103], v[86:87]
  v_cvt_pk_bf16_f32 v35, v102, v103
  buffer_store_dwordx2 v[34:35], v7, s[24:27], 0 offen offset:32
  v_lshlrev_b32 v100, 16, v56
  v_and_b32 v101, 0xffff0000, v56
  v_pk_mul_f32 v[100:101], v[100:101], v[14:15] op_sel_hi:[1,0]
  v_cvt_pk_bf16_f32 v56, v100, v101
  v_lshlrev_b32 v100, 16, v56
  v_and_b32 v101, 0xffff0000, v56
  v_pk_add_f32 v[100:101], v[100:101], v[88:89]
  v_cvt_pk_bf16_f32 v36, v100, v101
  v_lshlrev_b32 v102, 16, v57
  v_and_b32 v103, 0xffff0000, v57
  v_pk_mul_f32 v[102:103], v[102:103], v[14:15] op_sel_hi:[1,0]
  v_cvt_pk_bf16_f32 v57, v102, v103
  v_lshlrev_b32 v102, 16, v57
  v_and_b32 v103, 0xffff0000, v57
  v_pk_add_f32 v[102:103], v[102:103], v[90:91]
  v_cvt_pk_bf16_f32 v37, v102, v103
  buffer_store_dwordx2 v[36:37], v7, s[24:27], 0 offen offset:64
  v_lshlrev_b32 v100, 16, v58
  v_and_b32 v101, 0xffff0000, v58
  v_pk_mul_f32 v[100:101], v[100:101], v[14:15] op_sel_hi:[1,0]
  v_cvt_pk_bf16_f32 v58, v100, v101
  v_lshlrev_b32 v100, 16, v58
  v_and_b32 v101, 0xffff0000, v58
  v_pk_add_f32 v[100:101], v[100:101], v[92:93]
  v_cvt_pk_bf16_f32 v38, v100, v101
  v_lshlrev_b32 v102, 16, v59
  v_and_b32 v103, 0xffff0000, v59
  v_pk_mul_f32 v[102:103], v[102:103], v[14:15] op_sel_hi:[1,0]
  v_cvt_pk_bf16_f32 v59, v102, v103
  v_lshlrev_b32 v102, 16, v59
  v_and_b32 v103, 0xffff0000, v59
  v_pk_add_f32 v[102:103], v[102:103], v[94:95]
  v_cvt_pk_bf16_f32 v39, v102, v103
  buffer_store_dwordx2 v[38:39], v7, s[24:27], 0 offen offset:96
  v_lshlrev_b32 v100, 16, v60
  v_and_b32 v101, 0xffff0000, v60
  v_pk_mul_f32 v[100:101], v[100:101], v[14:15] op_sel_hi:[1,0]
  v_cvt_pk_bf16_f32 v60, v100, v101
  v_lshlrev_b32 v100, 16, v60
  v_and_b32 v101, 0xffff0000, v60
  v_pk_add_f32 v[100:101], v[100:101], v[96:97]
  v_cvt_pk_bf16_f32 v40, v100, v101
  v_lshlrev_b32 v102, 16, v61
  v_and_b32 v103, 0xffff0000, v61
  v_pk_mul_f32 v[102:103], v[102:103], v[14:15] op_sel_hi:[1,0]
  v_cvt_pk_bf16_f32 v61, v102, v103
  v_lshlrev_b32 v102, 16, v61
  v_and_b32 v103, 0xffff0000, v61
  v_pk_add_f32 v[102:103], v[102:103], v[98:99]
  v_cvt_pk_bf16_f32 v41, v102, v103
  buffer_store_dwordx2 v[40:41], v8, s[24:27], 0 offen offset:128
  s_nop 0
  s_branch L_fin
L_loader:
  v_lshrrev_b32 v4, 1, v2
  v_xor_b32 v4, v4, v3
  v_lshlrev_b32 v4, 4, v4
  v_lshl_add_u32 v4, v2, 7, v4
  s_lshl_b32 s50, s45, 12
  v_add_u32 v26, s50, v4
  v_xor_b32 v27, 64, v26
  s_waitcnt vmcnt(4)
  s_barrier
  ds_read_b128 v[32:35], v26 offset:0
  ds_read_b128 v[36:39], v26 offset:2048
  s_lshl_b32 s50, s47, 6
  s_add_u32 s51, s50, 18432
  s_add_u32 m0, s52, 16384
  s_nop 0
  buffer_load_dwordx4 v16, s[4:7], s50 offen lds
  s_add_u32 m0, s52, 17408
  s_nop 0
  buffer_load_dwordx4 v15, s[4:7], s50 offen lds
  s_add_u32 m0, s52, 18432
  s_nop 0
  buffer_load_dwordx4 v16, s[4:7], s51 offen lds
  s_add_u32 m0, s52, 19456
  s_nop 0
  buffer_load_dwordx4 v15, s[4:7], s51 offen lds
  s_add_u32 s47, s47, 2
  s_cmp_eq_u32 s47, 18
  s_cselect_b32 s47, 0, s47
  s_mul_i32 s51, s3, 110592
  s_add_u32 m0, s53, 49152
  s_nop 0
  buffer_load_dwordx4 v21, s[8:11], s51 offen lds
  s_add_u32 s50, s51, 55296
  s_add_u32 m0, s53, 53248
  s_nop 0
  buffer_load_dwordx4 v21, s[8:11], s50 offen lds
  s_add_u32 s50, s51, 13824
  s_add_u32 m0, s53, 57344
  s_nop 0
  buffer_load_dwordx4 v21, s[8:11], s50 offen lds
  s_add_u32 s50, s51, 69120
  s_add_u32 m0, s53, 61440
  s_nop 0
  buffer_load_dwordx4 v21, s[8:11], s50 offen lds
  s_add_u32 s3, s3, 1
  s_cmp_eq_u32 s3, 18
  s_cselect_b32 s3, 0, s3
  s_lshl_b32 s50, s47, 6
  s_add_u32 s51, s50, 18432
  s_add_u32 m0, s52, 32768
  s_nop 0
  buffer_load_dwordx4 v16, s[4:7], s50 offen lds
  s_add_u32 m0, s52, 33792
  s_nop 0
  buffer_load_dwordx4 v15, s[4:7], s50 offen lds
  s_add_u32 m0, s52, 34816
  s_nop 0
  buffer_load_dwordx4 v16, s[4:7], s51 offen lds
  s_add_u32 m0, s52, 35840
  s_nop 0
  buffer_load_dwordx4 v15, s[4:7], s51 offen lds
  s_add_u32 s47, s47, 2
  s_cmp_eq_u32 s47, 18
  s_cselect_b32 s47, 0, s47
  s_mul_i32 s51, s3, 110592
  s_add_u32 m0, s53, 65536
  s_nop 0
  buffer_load_dwordx4 v21, s[8:11], s51 offen lds
  s_add_u32 s50, s51, 55296
  s_add_u32 m0, s53, 69632
  s_nop 0
  buffer_load_dwordx4 v21, s[8:11], s50 offen lds
  s_add_u32 s50, s51, 13824
  s_add_u32 m0, s53, 73728
  s_nop 0
  buffer_load_dwordx4 v21, s[8:11], s50 offen lds
  s_add_u32 s50, s51, 69120
  s_add_u32 m0, s53, 77824
  s_nop 0
  buffer_load_dwordx4 v21, s[8:11], s50 offen lds
  s_add_u32 s3, s3, 1
  s_cmp_eq_u32 s3, 18
  s_cselect_b32 s3, 0, s3
  s_waitcnt vmcnt(16) lgkmcnt(0)
  s_barrier
  ds_read_b128 v[40:43], v27 offset:0
  ds_read_b128 v[44:47], v27 offset:2048
  s_mul_i32 s51, s3, 110592
  s_add_u32 m0, s53, 81920
  s_nop 0
  buffer_load_dwordx4 v21, s[8:11], s51 offen lds
  s_add_u32 s50, s51, 55296
  s_add_u32 m0, s53, 86016
  s_nop 0
  buffer_load_dwordx4 v21, s[8:11], s50 offen lds
  s_add_u32 s50, s51, 13824
  s_add_u32 m0, s53, 90112
  s_nop 0
  buffer_load_dwordx4 v21, s[8:11], s50 offen lds
  s_add_u32 s50, s51, 69120
  s_add_u32 m0, s53, 94208
  s_nop 0
  buffer_load_dwordx4 v21, s[8:11], s50 offen lds
  s_add_u32 s3, s3, 1
  s_cmp_eq_u32 s3, 18
  s_cselect_b32 s3, 0, s3
  s_mul_i32 s51, s3, 110592
  s_add_u32 m0, s53, 0
  s_nop 0
  buffer_load_dwordx4 v21, s[8:11], s51 offen lds
  s_add_u32 s50, s51, 55296
  s_add_u32 m0, s53, 4096
  s_nop 0
  buffer_load_dwordx4 v21, s[8:11], s50 offen lds
  s_add_u32 s50, s51, 13824
  s_add_u32 m0, s53, 8192
  s_nop 0
  buffer_load_dwordx4 v21, s[8:11], s50 offen lds
  s_add_u32 s50, s51, 69120
  s_add_u32 m0, s53, 12288
  s_nop 0
  buffer_load_dwordx4 v21, s[8:11], s50 offen lds
  s_add_u32 s3, s3, 1
  s_cmp_eq_u32 s3, 18
  s_cselect_b32 s3, 0, s3
  s_waitcnt vmcnt(16) lgkmcnt(0)
  s_barrier
  ds_read_b128 v[48:51], v26 offset:16384
  ds_read_b128 v[52:55], v26 offset:18432
  s_lshl_b32 s50, s47, 6
  s_add_u32 s51, s50, 18432
  s_add_u32 m0, s52, 0
  s_nop 0
  buffer_load_dwordx4 v16, s[4:7], s50 offen lds
  s_add_u32 m0, s52, 1024
  s_nop 0
  buffer_load_dwordx4 v15, s[4:7], s50 offen lds
  s_add_u32 m0, s52, 2048
  s_nop 0
  buffer_load_dwordx4 v16, s[4:7], s51 offen lds
  s_add_u32 m0, s52, 3072
  s_nop 0
  buffer_load_dwordx4 v15, s[4:7], s51 offen lds
  s_add_u32 s47, s47, 2
  s_cmp_eq_u32 s47, 18
  s_cselect_b32 s47, 0, s47
  s_mul_i32 s51, s3, 110592
  s_add_u32 m0, s53, 16384
  s_nop 0
  buffer_load_dwordx4 v21, s[8:11], s51 offen lds
  s_add_u32 s50, s51, 55296
  s_add_u32 m0, s53, 20480
  s_nop 0
  buffer_load_dwordx4 v21, s[8:11], s50 offen lds
  s_add_u32 s50, s51, 13824
  s_add_u32 m0, s53, 24576
  s_nop 0
  buffer_load_dwordx4 v21, s[8:11], s50 offen lds
  s_add_u32 s50, s51, 69120
  s_add_u32 m0, s53, 28672
  s_nop 0
  buffer_load_dwordx4 v21, s[8:11], s50 offen lds
  s_add_u32 s3, s3, 1
  s_cmp_eq_u32 s3, 18
  s_cselect_b32 s3, 0, s3
  s_waitcnt vmcnt(16) lgkmcnt(0)
  s_barrier
  ds_read_b128 v[56:59], v27 offset:16384
  ds_read_b128 v[60:63], v27 offset:18432
  s_mul_i32 s51, s3, 110592
  s_add_u32 m0, s53, 32768
  s_nop 0
  buffer_load_dwordx4 v21, s[8:11], s51 offen lds
  s_add_u32 s50, s51, 55296
  s_add_u32 m0, s53, 36864
  s_nop 0
  buffer_load_dwordx4 v21, s[8:11], s50 offen lds
  s_add_u32 s50, s51, 13824
  s_add_u32 m0, s53, 40960
  s_nop 0
  buffer_load_dwordx4 v21, s[8:11], s50 offen lds
  s_add_u32 s50, s51, 69120
  s_add_u32 m0, s53, 45056
  s_nop 0
  buffer_load_dwordx4 v21, s[8:11], s50 offen lds
  s_add_u32 s3, s3, 1
  s_cmp_eq_u32 s3, 18
  s_cselect_b32 s3, 0, s3
  s_waitcnt vmcnt(16) lgkmcnt(0)
  s_barrier
  ds_read_b128 v[64:67], v26 offset:32768
  ds_read_b128 v[68:71], v26 offset:34816
  s_lshl_b32 s50, s47, 6
  s_add_u32 s51, s50, 18432
  s_add_u32 m0, s52, 16384
  s_nop 0
  buffer_load_dwordx4 v16, s[4:7], s50 offen lds
  s_add_u32 m0, s52, 17408
  s_nop 0
  buffer_load_dwordx4 v15, s[4:7], s50 offen lds
  s_add_u32 m0, s52, 18432
  s_nop 0
  buffer_load_dwordx4 v16, s[4:7], s51 offen lds
  s_add_u32 m0, s52, 19456
  s_nop 0
  buffer_load_dwordx4 v15, s[4:7], s51 offen lds
  s_add_u32 s47, s47, 2
  s_cmp_eq_u32 s47, 18
  s_cselect_b32 s47, 0, s47
  s_mul_i32 s51, s3, 110592
  s_add_u32 m0, s53, 49152
  s_nop 0
  buffer_load_dwordx4 v21, s[8:11], s51 offen lds
  s_add_u32 s50, s51, 55296
  s_add_u32 m0, s53, 53248
  s_nop 0
  buffer_load_dwordx4 v21, s[8:11], s50 offen lds
  s_add_u32 s50, s51, 13824
  s_add_u32 m0, s53, 57344
  s_nop 0
  buffer_load_dwordx4 v21, s[8:11], s50 offen lds
  s_add_u32 s50, s51, 69120
  s_add_u32 m0, s53, 61440
  s_nop 0
  buffer_load_dwordx4 v21, s[8:11], s50 offen lds
  s_add_u32 s3, s3, 1
  s_cmp_eq_u32 s3, 18
  s_cselect_b32 s3, 0, s3
  s_waitcnt vmcnt(20) lgkmcnt(0)
  s_barrier
  ds_read_b128 v[72:75], v27 offset:32768
  ds_read_b128 v[76:79], v27 offset:34816
  s_mul_i32 s51, s3, 110592
  s_add_u32 m0, s53, 65536
  s_nop 0
  buffer_load_dwordx4 v21, s[8:11], s51 offen lds
  s_add_u32 s50, s51, 55296
  s_add_u32 m0, s53, 69632
  s_nop 0
  buffer_load_dwordx4 v21, s[8:11], s50 offen lds
  s_add_u32 s50, s51, 13824
  s_add_u32 m0, s53, 73728
  s_nop 0
  buffer_load_dwordx4 v21, s[8:11], s50 offen lds
  s_add_u32 s50, s51, 69120
  s_add_u32 m0, s53, 77824
  s_nop 0
  buffer_load_dwordx4 v21, s[8:11], s50 offen lds
  s_add_u32 s3, s3, 1
  s_cmp_eq_u32 s3, 18
  s_cselect_b32 s3, 0, s3
  s_waitcnt vmcnt(16) lgkmcnt(0)
  s_barrier
  ds_read_b128 v[80:83], v26 offset:0
  ds_read_b128 v[84:87], v26 offset:2048
  s_lshl_b32 s50, s47, 6
  s_add_u32 s51, s50, 18432
  s_add_u32 m0, s52, 32768
  s_nop 0
  buffer_load_dwordx4 v16, s[4:7], s50 offen lds
  s_add_u32 m0, s52, 33792
  s_nop 0
  buffer_load_dwordx4 v15, s[4:7], s50 offen lds
  s_add_u32 m0, s52, 34816
  s_nop 0
  buffer_load_dwordx4 v16, s[4:7], s51 offen lds
  s_add_u32 m0, s52, 35840
  s_nop 0
  buffer_load_dwordx4 v15, s[4:7], s51 offen lds
  s_add_u32 s47, s47, 2
  s_cmp_eq_u32 s47, 18
  s_cselect_b32 s47, 0, s47
  s_mul_i32 s51, s3, 110592
  s_add_u32 m0, s53, 81920
  s_nop 0
  buffer_load_dwordx4 v21, s[8:11], s51 offen lds
  s_add_u32 s50, s51, 55296
  s_add_u32 m0, s53, 86016
  s_nop 0
  buffer_load_dwordx4 v21, s[8:11], s50 offen lds
  s_add_u32 s50, s51, 13824
  s_add_u32 m0, s53, 90112
  s_nop 0
  buffer_load_dwordx4 v21, s[8:11], s50 offen lds
  s_add_u32 s50, s51, 69120
  s_add_u32 m0, s53, 94208
  s_nop 0
  buffer_load_dwordx4 v21, s[8:11], s50 offen lds
  s_add_u32 s3, s3, 1
  s_cmp_eq_u32 s3, 18
  s_cselect_b32 s3, 0, s3
  s_waitcnt vmcnt(20) lgkmcnt(0)
  s_barrier
  ds_read_b128 v[88:91], v27 offset:0
  ds_read_b128 v[92:95], v27 offset:2048
  s_mul_i32 s51, s3, 110592
  s_add_u32 m0, s53, 0
  s_nop 0
  buffer_load_dwordx4 v21, s[8:11], s51 offen lds
  s_add_u32 s50, s51, 55296
  s_add_u32 m0, s53, 4096
  s_nop 0
  buffer_load_dwordx4 v21, s[8:11], s50 offen lds
  s_add_u32 s50, s51, 13824
  s_add_u32 m0, s53, 8192
  s_nop 0
  buffer_load_dwordx4 v21, s[8:11], s50 offen lds
  s_add_u32 s50, s51, 69120
  s_add_u32 m0, s53, 12288
  s_nop 0
  buffer_load_dwordx4 v21, s[8:11], s50 offen lds
  s_add_u32 s3, s3, 1
  s_cmp_eq_u32 s3, 18
  s_cselect_b32 s3, 0, s3
  s_and_b32 s50, s40, 7
  s_mul_i32 s50, s50, 72
  s_mul_i32 s51, s45, 18
  s_add_u32 s50, s50, s51
  s_mul_i32 s50, s50, 3456
  s_add_u32 s50, s50, s97
  v_min_u32 v4, 35, v1
  v_lshrrev_b32 v5, 1, v4
  s_movk_i32 s51, 3456
  v_mul_u32_u24 v5, s51, v5
  v_and_b32 v4, 1, v4
  v_mul_u32_u24 v4, 140, v4
  v_add_u32 v4, v4, v5
  buffer_load_dword v17, v4, s[8:11], s50 offen
  s_waitcnt vmcnt(17) lgkmcnt(0)
  s_barrier
  ds_read_b128 v[96:99], v26 offset:16384
  ds_read_b128 v[100:103], v26 offset:18432
  s_lshl_b32 s50, s47, 6
  s_add_u32 s51, s50, 18432
  s_add_u32 m0, s52, 0
  s_nop 0
  buffer_load_dwordx4 v16, s[4:7], s50 offen lds
  s_add_u32 m0, s52, 1024
  s_nop 0
  buffer_load_dwordx4 v15, s[4:7], s50 offen lds
  s_add_u32 m0, s52, 2048
  s_nop 0
  buffer_load_dwordx4 v16, s[4:7], s51 offen lds
  s_add_u32 m0, s52, 3072
  s_nop 0
  buffer_load_dwordx4 v15, s[4:7], s51 offen lds
  s_add_u32 s47, s47, 2
  s_cmp_eq_u32 s47, 18
  s_cselect_b32 s47, 0, s47
  s_mul_i32 s51, s3, 110592
  s_add_u32 m0, s53, 16384
  s_nop 0
  buffer_load_dwordx4 v21, s[8:11], s51 offen lds
  s_add_u32 s50, s51, 55296
  s_add_u32 m0, s53, 20480
  s_nop 0
  buffer_load_dwordx4 v21, s[8:11], s50 offen lds
  s_add_u32 s50, s51, 13824
  s_add_u32 m0, s53, 24576
  s_nop 0
  buffer_load_dwordx4 v21, s[8:11], s50 offen lds
  s_add_u32 s50, s51, 69120
  s_add_u32 m0, s53, 28672
  s_nop 0
  buffer_load_dwordx4 v21, s[8:11], s50 offen lds
  s_add_u32 s3, s3, 1
  s_cmp_eq_u32 s3, 18
  s_cselect_b32 s3, 0, s3
  s_waitcnt vmcnt(21) lgkmcnt(0)
  s_barrier
  ds_read_b128 v[104:107], v27 offset:16384
  ds_read_b128 v[108:111], v27 offset:18432
  s_mul_i32 s51, s3, 110592
  s_add_u32 m0, s53, 32768
  s_nop 0
  buffer_load_dwordx4 v21, s[8:11], s51 offen lds
  s_add_u32 s50, s51, 55296
  s_add_u32 m0, s53, 36864
  s_nop 0
  buffer_load_dwordx4 v21, s[8:11], s50 offen lds
  s_add_u32 s50, s51, 13824
  s_add_u32 m0, s53, 40960
  s_nop 0
  buffer_load_dwordx4 v21, s[8:11], s50 offen lds
  s_add_u32 s50, s51, 69120
  s_add_u32 m0, s53, 45056
  s_nop 0
  buffer_load_dwordx4 v21, s[8:11], s50 offen lds
  s_add_u32 s3, s3, 1
  s_cmp_eq_u32 s3, 18
  s_cselect_b32 s3, 0, s3
  v_mov_b32 v9, 0
  buffer_load_dwordx2 v[12:13], v9, s[28:31], 0 offen sc1
  s_waitcnt vmcnt(18) lgkmcnt(0)
  s_barrier
  ds_read_b128 v[112:115], v26 offset:32768
  ds_read_b128 v[116:119], v26 offset:34816
  s_lshl_b32 s50, s47, 6
  s_add_u32 s51, s50, 18432
  s_add_u32 m0, s52, 16384
  s_nop 0
  buffer_load_dwordx4 v16, s[4:7], s50 offen lds
  s_add_u32 m0, s52, 17408
  s_nop 0
  buffer_load_dwordx4 v15, s[4:7], s50 offen lds
  s_add_u32 m0, s52, 18432
  s_nop 0
  buffer_load_dwordx4 v16, s[4:7], s51 offen lds
  s_add_u32 m0, s52, 19456
  s_nop 0
  buffer_load_dwordx4 v15, s[4:7], s51 offen lds
  s_add_u32 s47, s47, 2
  s_cmp_eq_u32 s47, 18
  s_cselect_b32 s47, 0, s47
  s_mul_i32 s51, s3, 110592
  s_add_u32 m0, s53, 49152
  s_nop 0
  buffer_load_dwordx4 v21, s[8:11], s51 offen lds
  s_add_u32 s50, s51, 55296
  s_add_u32 m0, s53, 53248
  s_nop 0
  buffer_load_dwordx4 v21, s[8:11], s50 offen lds
  s_add_u32 s50, s51, 13824
  s_add_u32 m0, s53, 57344
  s_nop 0
  buffer_load_dwordx4 v21, s[8:11], s50 offen lds
  s_add_u32 s50, s51, 69120
  s_add_u32 m0, s53, 61440
  s_nop 0
  buffer_load_dwordx4 v21, s[8:11], s50 offen lds
  s_add_u32 s3, s3, 1
  s_cmp_eq_u32 s3, 18
  s_cselect_b32 s3, 0, s3
  s_waitcnt vmcnt(22) lgkmcnt(0)
  s_barrier
  ds_read_b128 v[120:123], v27 offset:32768
  ds_read_b128 v[124:127], v27 offset:34816
  s_mul_i32 s51, s3, 110592
  s_add_u32 m0, s53, 65536
  s_nop 0
  buffer_load_dwordx4 v21, s[8:11], s51 offen lds
  s_add_u32 s50, s51, 55296
  s_add_u32 m0, s53, 69632
  s_nop 0
  buffer_load_dwordx4 v21, s[8:11], s50 offen lds
  s_add_u32 s50, s51, 13824
  s_add_u32 m0, s53, 73728
  s_nop 0
  buffer_load_dwordx4 v21, s[8:11], s50 offen lds
  s_add_u32 s50, s51, 69120
  s_add_u32 m0, s53, 77824
  s_nop 0
  buffer_load_dwordx4 v21, s[8:11], s50 offen lds
  s_add_u32 s3, s3, 1
  s_cmp_eq_u32 s3, 18
  s_cselect_b32 s3, 0, s3
  s_waitcnt vmcnt(17) lgkmcnt(0)
  s_barrier
  ds_read_b128 v[128:131], v26 offset:0
  ds_read_b128 v[132:135], v26 offset:2048
  s_lshl_b32 s50, s47, 6
  s_add_u32 s51, s50, 18432
  s_add_u32 m0, s52, 32768
  s_nop 0
  buffer_load_dwordx4 v16, s[4:7], s50 offen lds
  s_add_u32 m0, s52, 33792
  s_nop 0
  buffer_load_dwordx4 v15, s[4:7], s50 offen lds
  s_add_u32 m0, s52, 34816
  s_nop 0
  buffer_load_dwordx4 v16, s[4:7], s51 offen lds
  s_add_u32 m0, s52, 35840
  s_nop 0
  buffer_load_dwordx4 v15, s[4:7], s51 offen lds
  s_add_u32 s47, s47, 2
  s_cmp_eq_u32 s47, 18
  s_cselect_b32 s47, 0, s47
  s_mul_i32 s51, s3, 110592
  s_add_u32 m0, s53, 81920
  s_nop 0
  buffer_load_dwordx4 v21, s[8:11], s51 offen lds
  s_add_u32 s50, s51, 55296
  s_add_u32 m0, s53, 86016
  s_nop 0
  buffer_load_dwordx4 v21, s[8:11], s50 offen lds
  s_add_u32 s50, s51, 13824
  s_add_u32 m0, s53, 90112
  s_nop 0
  buffer_load_dwordx4 v21, s[8:11], s50 offen lds
  s_add_u32 s50, s51, 69120
  s_add_u32 m0, s53, 94208
  s_nop 0
  buffer_load_dwordx4 v21, s[8:11], s50 offen lds
  s_add_u32 s3, s3, 1
  s_cmp_eq_u32 s3, 18
  s_cselect_b32 s3, 0, s3
  s_waitcnt vmcnt(21) lgkmcnt(0)
  s_barrier
  ds_read_b128 v[136:139], v27 offset:0
  ds_read_b128 v[140:143], v27 offset:2048
  s_mul_i32 s51, s3, 110592
  s_add_u32 m0, s53, 0
  s_nop 0
  buffer_load_dwordx4 v21, s[8:11], s51 offen lds
  s_add_u32 s50, s51, 55296
  s_add_u32 m0, s53, 4096
  s_nop 0
  buffer_load_dwordx4 v21, s[8:11], s50 offen lds
  s_add_u32 s50, s51, 13824
  s_add_u32 m0, s53, 8192
  s_nop 0
  buffer_load_dwordx4 v21, s[8:11], s50 offen lds
  s_add_u32 s50, s51, 69120
  s_add_u32 m0, s53, 12288
  s_nop 0
  buffer_load_dwordx4 v21, s[8:11], s50 offen lds
  s_add_u32 s3, s3, 1
  s_cmp_eq_u32 s3, 18
  s_cselect_b32 s3, 0, s3
  s_waitcnt vmcnt(16) lgkmcnt(0)
  s_barrier
  ds_read_b128 v[144:147], v26 offset:16384
  ds_read_b128 v[148:151], v26 offset:18432
  s_waitcnt vmcnt(12) lgkmcnt(0)
  s_barrier
  ds_read_b128 v[152:155], v27 offset:16384
  ds_read_b128 v[156:159], v27 offset:18432
  s_waitcnt vmcnt(4) lgkmcnt(0)
  s_barrier
  ds_read_b128 v[160:163], v26 offset:32768
  ds_read_b128 v[164:167], v26 offset:34816
  s_waitcnt vmcnt(0) lgkmcnt(0)
  s_barrier
  ds_read_b128 v[168:171], v27 offset:32768
  ds_read_b128 v[172:175], v27 offset:34816
  s_waitcnt vmcnt(63) lgkmcnt(0)
  s_barrier
  v_mov_b32 v4, 163072
  v_mov_b32 v5, 1
  s_mov_b64 exec, 1
  ds_add_u32 v4, v5
  s_mov_b64 exec, -1
  s_mul_i32 s51, s3, 110592
  s_add_u32 s50, s51, 13824
  s_add_u32 m0, s55, 65536
  s_mov_b32 exec_hi, 0xf
  buffer_load_dwordx4 v19, s[8:11], s51 offen lds
  s_add_u32 m0, s55, 67840
  s_nop 0
  buffer_load_dwordx4 v19, s[8:11], s50 offen lds
  s_mov_b32 exec_hi, -1
  s_add_u32 s3, s3, 1
  s_cmp_eq_u32 s3, 18
  s_cselect_b32 s3, 0, s3
  s_mul_i32 s51, s3, 110592
  s_add_u32 s50, s51, 13824
  s_add_u32 m0, s55, 70144
  s_mov_b32 exec_hi, 0xf
  buffer_load_dwordx4 v19, s[8:11], s51 offen lds
  s_add_u32 m0, s55, 72448
  s_nop 0
  buffer_load_dwordx4 v19, s[8:11], s50 offen lds
  s_mov_b32 exec_hi, -1
  s_add_u32 s3, s3, 1
  s_cmp_eq_u32 s3, 18
  s_cselect_b32 s3, 0, s3
  s_mul_i32 s51, s3, 110592
  s_add_u32 s50, s51, 13824
  s_add_u32 m0, s55, 74752
  s_mov_b32 exec_hi, 0xf
  buffer_load_dwordx4 v19, s[8:11], s51 offen lds
  s_add_u32 m0, s55, 77056
  s_nop 0
  buffer_load_dwordx4 v19, s[8:11], s50 offen lds
  s_mov_b32 exec_hi, -1
  s_add_u32 s3, s3, 1
  s_cmp_eq_u32 s3, 18
  s_cselect_b32 s3, 0, s3
  s_mul_i32 s51, s3, 110592
  s_add_u32 s50, s51, 13824
  s_add_u32 m0, s55, 79360
  s_mov_b32 exec_hi, 0xf
  buffer_load_dwordx4 v19, s[8:11], s51 offen lds
  s_add_u32 m0, s55, 81664
  s_nop 0
  buffer_load_dwordx4 v19, s[8:11], s50 offen lds
  s_mov_b32 exec_hi, -1
  s_add_u32 s3, s3, 1
  s_cmp_eq_u32 s3, 18
  s_cselect_b32 s3, 0, s3
  s_mul_i32 s51, s3, 110592
  s_add_u32 s50, s51, 13824
  s_add_u32 m0, s55, 83968
  s_mov_b32 exec_hi, 0xf
  buffer_load_dwordx4 v19, s[8:11], s51 offen lds
  s_add_u32 m0, s55, 86272
  s_nop 0
  buffer_load_dwordx4 v19, s[8:11], s50 offen lds
  s_mov_b32 exec_hi, -1
  s_add_u32 s3, s3, 1
  s_cmp_eq_u32 s3, 18
  s_cselect_b32 s3, 0, s3
  s_mul_i32 s51, s3, 110592
  s_add_u32 s50, s51, 13824
  s_add_u32 m0, s55, 88576
  s_mov_b32 exec_hi, 0xf
  buffer_load_dwordx4 v19, s[8:11], s51 offen lds
  s_add_u32 m0, s55, 90880
  s_nop 0
  buffer_load_dwordx4 v19, s[8:11], s50 offen lds
  s_mov_b32 exec_hi, -1
  s_add_u32 s3, s3, 1
  s_cmp_eq_u32 s3, 18
  s_cselect_b32 s3, 0, s3
  s_mul_i32 s51, s3, 110592
  s_add_u32 s50, s51, 13824
  s_add_u32 m0, s55, 93184
  s_mov_b32 exec_hi, 0xf
  buffer_load_dwordx4 v19, s[8:11], s51 offen lds
  s_add_u32 m0, s55, 95488
  s_nop 0
  buffer_load_dwordx4 v19, s[8:11], s50 offen lds
  s_mov_b32 exec_hi, -1
  s_add_u32 s3, s3, 1
  s_cmp_eq_u32 s3, 18
  s_cselect_b32 s3, 0, s3
  s_mul_i32 s51, s3, 110592
  s_add_u32 s50, s51, 13824
  s_add_u32 m0, s55, 97792
  s_mov_b32 exec_hi, 0xf
  buffer_load_dwordx4 v19, s[8:11], s51 offen lds
  s_add_u32 m0, s55, 100096
  s_nop 0
  buffer_load_dwordx4 v19, s[8:11], s50 offen lds
  s_mov_b32 exec_hi, -1
  s_add_u32 s3, s3, 1
  s_cmp_eq_u32 s3, 18
  s_cselect_b32 s3, 0, s3
  s_mul_i32 s51, s3, 110592
  s_add_u32 s50, s51, 13824
  s_add_u32 m0, s55, 102400
  s_mov_b32 exec_hi, 0xf
  buffer_load_dwordx4 v19, s[8:11], s51 offen lds
  s_add_u32 m0, s55, 104704
  s_nop 0
  buffer_load_dwordx4 v19, s[8:11], s50 offen lds
  s_mov_b32 exec_hi, -1
  s_add_u32 s3, s3, 1
  s_cmp_eq_u32 s3, 18
  s_cselect_b32 s3, 0, s3
  s_mul_i32 s51, s3, 110592
  s_add_u32 s50, s51, 13824
  s_add_u32 m0, s55, 107008
  s_mov_b32 exec_hi, 0xf
  buffer_load_dwordx4 v19, s[8:11], s51 offen lds
  s_add_u32 m0, s55, 109312
  s_nop 0
  buffer_load_dwordx4 v19, s[8:11], s50 offen lds
  s_mov_b32 exec_hi, -1
  s_add_u32 s3, s3, 1
  s_cmp_eq_u32 s3, 18
  s_cselect_b32 s3, 0, s3
  s_mul_i32 s51, s3, 110592
  s_add_u32 s50, s51, 13824
  s_add_u32 m0, s55, 111616
  s_mov_b32 exec_hi, 0xf
  buffer_load_dwordx4 v19, s[8:11], s51 offen lds
  s_add_u32 m0, s55, 113920
  s_nop 0
  buffer_load_dwordx4 v19, s[8:11], s50 offen lds
  s_mov_b32 exec_hi, -1
  s_add_u32 s3, s3, 1
  s_cmp_eq_u32 s3, 18
  s_cselect_b32 s3, 0, s3
  s_mul_i32 s51, s3, 110592
  s_add_u32 s50, s51, 13824
  s_add_u32 m0, s55, 116224
  s_mov_b32 exec_hi, 0xf
  buffer_load_dwordx4 v19, s[8:11], s51 offen lds
  s_add_u32 m0, s55, 118528
  s_nop 0
  buffer_load_dwordx4 v19, s[8:11], s50 offen lds
  s_mov_b32 exec_hi, -1
  s_add_u32 s3, s3, 1
  s_cmp_eq_u32 s3, 18
  s_cselect_b32 s3, 0, s3
  s_mul_i32 s51, s3, 110592
  s_add_u32 s50, s51, 13824
  s_add_u32 m0, s55, 120832
  s_mov_b32 exec_hi, 0xf
  buffer_load_dwordx4 v19, s[8:11], s51 offen lds
  s_add_u32 m0, s55, 123136
  s_nop 0
  buffer_load_dwordx4 v19, s[8:11], s50 offen lds
  s_mov_b32 exec_hi, -1
  s_add_u32 s3, s3, 1
  s_cmp_eq_u32 s3, 18
  s_cselect_b32 s3, 0, s3
  s_mul_i32 s51, s3, 110592
  s_add_u32 s50, s51, 13824
  s_add_u32 m0, s55, 125440
  s_mov_b32 exec_hi, 0xf
  buffer_load_dwordx4 v19, s[8:11], s51 offen lds
  s_add_u32 m0, s55, 127744
  s_nop 0
  buffer_load_dwordx4 v19, s[8:11], s50 offen lds
  s_mov_b32 exec_hi, -1
  s_add_u32 s3, s3, 1
  s_cmp_eq_u32 s3, 18
  s_cselect_b32 s3, 0, s3
  v_readfirstlane_b32 s80, v12
  v_readfirstlane_b32 s81, v13
  s_mov_b32 s59, 0
  s_cmp_lg_u32 s80, 0
  s_nop 2
  s_cbranch_scc1 L_non13d
L_non13:
  v_mov_b32 v9, 0
  buffer_load_dwordx2 v[12:13], v9, s[28:31], 0 offen sc1
  s_waitcnt vmcnt(0)
  v_readfirstlane_b32 s80, v12
  v_readfirstlane_b32 s81, v13
  s_add_u32 s59, s59, 1
  s_cmp_gt_u32 s59, 100000
  s_nop 2
  s_cbranch_scc1 L_non13d
  s_cmp_eq_u32 s80, 0
  s_cbranch_scc1 L_non13
L_non13d:
  v_bfe_u32 v4, v1, 2, 2
  v_lshl_add_u32 v5, v3, 2, v4
  v_and_b32 v6, 3, v1
  s_movk_i32 s51, 144
  v_mul_u32_u24 v8, s51, v5
  s_mov_b32 s51, 218694656
  v_lshlrev_b32 v9, 3, v6
  v_lshrrev_b32 v9, v9, s51
  v_and_b32 v9, 0xff, v9
  v_lshl_add_u32 v23, v9, 3, v8
  v_add_u32 v24, 65536, v23
  v_lshlrev_b32 v25, 4, v3
  v_add_u32 v25, 160512, v25
  s_mov_b32 s92, s56
  v_mov_b32 v12, 163072
  s_mov_b32 s59, 0
  s_nop 0
L_cw14:
  ds_read_b32 v13, v12
  s_waitcnt lgkmcnt(0)
  v_readfirstlane_b32 s50, v13
  s_add_u32 s59, s59, 1
  s_cmp_gt_u32 s59, 2000000
  s_nop 2
  s_cbranch_scc1 L_cw14d
  s_cmp_ge_u32 s50, 8
  s_cbranch_scc1 L_cw14d
  s_setprio 0
  s_sleep 1
  s_branch L_cw14
L_cw14d:
  s_mul_i32 s51, s3, 110592
  s_add_u32 s50, s51, 13824
  s_add_u32 m0, s55, 49152
  s_mov_b32 exec_hi, 0xf
  buffer_load_dwordx4 v19, s[8:11], s51 offen lds
  s_add_u32 m0, s55, 51456
  s_nop 0
  buffer_load_dwordx4 v19, s[8:11], s50 offen lds
  s_mov_b32 exec_hi, -1
  s_add_u32 s3, s3, 1
  s_cmp_eq_u32 s3, 18
  s_cselect_b32 s3, 0, s3
  s_mul_i32 s51, s3, 110592
  s_add_u32 s50, s51, 13824
  s_add_u32 m0, s55, 53760
  s_mov_b32 exec_hi, 0xf
  buffer_load_dwordx4 v19, s[8:11], s51 offen lds
  s_add_u32 m0, s55, 56064
  s_nop 0
  buffer_load_dwordx4 v19, s[8:11], s50 offen lds
  s_mov_b32 exec_hi, -1
  s_add_u32 s3, s3, 1
  s_cmp_eq_u32 s3, 18
  s_cselect_b32 s3, 0, s3
  s_mul_i32 s51, s3, 110592
  s_add_u32 s50, s51, 13824
  s_add_u32 m0, s55, 58368
  s_mov_b32 exec_hi, 0xf
  buffer_load_dwordx4 v19, s[8:11], s51 offen lds
  s_add_u32 m0, s55, 60672
  s_nop 0
  buffer_load_dwordx4 v19, s[8:11], s50 offen lds
  s_mov_b32 exec_hi, -1
  s_add_u32 s3, s3, 1
  s_cmp_eq_u32 s3, 18
  s_cselect_b32 s3, 0, s3
  s_mul_i32 s51, s3, 110592
  s_add_u32 s50, s51, 13824
  s_add_u32 m0, s55, 41472
  s_mov_b32 exec_hi, 0xf
  buffer_load_dwordx4 v19, s[8:11], s51 offen lds
  s_add_u32 m0, s55, 43776
  s_nop 0
  buffer_load_dwordx4 v19, s[8:11], s50 offen lds
  s_mov_b32 exec_hi, -1
  s_add_u32 s3, s3, 1
  s_cmp_eq_u32 s3, 18
  s_cselect_b32 s3, 0, s3
  s_lshl_b32 s51, s58, 10
  s_add_u32 s51, s51, 13631488
  s_mov_b32 s59, 0
L_wordy:
  buffer_load_dwordx4 v[12:15], v250, s[12:15], s51 offen sc1
  s_waitcnt vmcnt(0)
  v_cmp_ne_u32 vcc, s80, v12
  v_cmp_ne_u32 s[100:101], s81, v13
  s_nop 0
  s_or_b64 vcc, vcc, s[100:101]
  v_cmp_ne_u32 s[100:101], s80, v14
  s_nop 0
  s_or_b64 vcc, vcc, s[100:101]
  v_cmp_ne_u32 s[100:101], s81, v15
  s_nop 0
  s_or_b64 vcc, vcc, s[100:101]
  s_nop 2
  s_cbranch_scc0 L_wordyd
  s_add_u32 s59, s59, 1
  s_cmp_lt_u32 s59, 100000
  s_cbranch_scc1 L_wordy
L_wordyd:
  v_mov_b32 v12, 163092
  v_mov_b32 v13, 1
  s_mov_b64 exec, 1
  ds_add_u32 v12, v13
  s_mov_b64 exec, -1
  v_mov_b32 v12, 163076
  s_mov_b32 s59, 0
  s_nop 0
L_cw15:
  ds_read_b32 v13, v12
  s_waitcnt lgkmcnt(0)
  v_readfirstlane_b32 s50, v13
  s_add_u32 s59, s59, 1
  s_cmp_gt_u32 s59, 2000000
  s_nop 2
  s_cbranch_scc1 L_cw15d
  s_cmp_ge_u32 s50, 1
  s_cbranch_scc1 L_cw15d
  s_setprio 0
  s_sleep 1
  s_branch L_cw15
L_cw15d:
  s_waitcnt vmcnt(0)
  v_mov_b32 v12, 163136
  v_mov_b32 v13, 1
  s_mov_b64 exec, 1
  ds_add_u32 v12, v13
  s_mov_b64 exec, -1
  v_mov_b32 v12, 163136
  s_mov_b32 s59, 0
  s_nop 0
L_cw16:
  ds_read_b32 v13, v12
  s_waitcnt lgkmcnt(0)
  v_readfirstlane_b32 s50, v13
  s_add_u32 s59, s59, 1
  s_cmp_gt_u32 s59, 2000000
  s_nop 2
  s_cbranch_scc1 L_cw16d
  s_cmp_ge_u32 s50, 4
  s_cbranch_scc1 L_cw16d
  s_setprio 0
  s_sleep 1
  s_branch L_cw16
L_cw16d:
  ds_read_b64_tr_b16 v[216:217], v24 offset:0
  ds_read_b64_tr_b16 v[218:219], v24 offset:2304
  ds_read_b64_tr_b16 v[220:221], v24 offset:8
  ds_read_b64_tr_b16 v[222:223], v24 offset:2312
  ds_read_b64_tr_b16 v[224:225], v24 offset:16
  ds_read_b64_tr_b16 v[226:227], v24 offset:2320
  ds_read_b64_tr_b16 v[228:229], v24 offset:24
  ds_read_b64_tr_b16 v[230:231], v24 offset:2328
  ds_read_b64_tr_b16 v[232:233], v24 offset:32
  ds_read_b64_tr_b16 v[234:235], v24 offset:2336
  s_lshl_b32 s91, s92, 6
  v_add_u32 v14, s91, v25
  s_add_u32 s92, s92, 1
  s_cmp_eq_u32 s92, 18
  s_cselect_b32 s92, 0, s92
  ds_read_b128 v[236:239], v14
  s_waitcnt lgkmcnt(9)
  v_mfma_f32_16x16x32_bf16 v[176:179], v[216:219], v[32:35], 0
  ds_read_b64_tr_b16 v[240:241], v24 offset:4608
  v_mfma_f32_16x16x32_bf16 v[196:199], v[216:219], v[36:39], 0
  ds_read_b64_tr_b16 v[242:243], v24 offset:6912
  s_waitcnt lgkmcnt(9)
  v_mfma_f32_16x16x32_bf16 v[180:183], v[220:223], v[32:35], 0
  ds_read_b64_tr_b16 v[244:245], v24 offset:4616
  v_mfma_f32_16x16x32_bf16 v[200:203], v[220:223], v[36:39], 0
  ds_read_b64_tr_b16 v[246:247], v24 offset:6920
  s_waitcnt lgkmcnt(9)
  v_mfma_f32_16x16x32_bf16 v[184:187], v[224:227], v[32:35], 0
  ds_read_b64_tr_b16 v[216:217], v24 offset:4624
  v_mfma_f32_16x16x32_bf16 v[204:207], v[224:227], v[36:39], 0
  ds_read_b64_tr_b16 v[218:219], v24 offset:6928
  s_waitcnt lgkmcnt(9)
  v_mfma_f32_16x16x32_bf16 v[188:191], v[228:231], v[32:35], 0
  ds_read_b64_tr_b16 v[220:221], v24 offset:4632
  v_mfma_f32_16x16x32_bf16 v[208:211], v[228:231], v[36:39], 0
  ds_read_b64_tr_b16 v[222:223], v24 offset:6936
  s_waitcnt lgkmcnt(9)
  v_mfma_f32_16x16x32_bf16 v[192:195], v[232:235], v[32:35], 0
  ds_read_b64_tr_b16 v[224:225], v24 offset:4640
  v_mfma_f32_16x16x32_bf16 v[212:215], v[232:235], v[36:39], 0
  ds_read_b64_tr_b16 v[226:227], v24 offset:6944
  s_waitcnt lgkmcnt(10)
  v_mfma_f32_16x16x32_bf16 v[4:7], v[236:239], v[32:35], 0
  s_lshl_b32 s91, s92, 6
  v_add_u32 v14, s91, v25
  s_add_u32 s92, s92, 1
  s_cmp_eq_u32 s92, 18
  s_cselect_b32 s92, 0, s92
  ds_read_b128 v[228:231], v14
  v_mfma_f32_16x16x32_bf16 v[8:11], v[236:239], v[36:39], 0
  s_waitcnt lgkmcnt(9)
  v_mfma_f32_16x16x32_bf16 v[176:179], v[240:243], v[40:43], v[176:179]
  ds_read_b64_tr_b16 v[232:233], v24 offset:9216
  v_mfma_f32_16x16x32_bf16 v[196:199], v[240:243], v[44:47], v[196:199]
  ds_read_b64_tr_b16 v[234:235], v24 offset:11520
  s_waitcnt lgkmcnt(9)
  v_mfma_f32_16x16x32_bf16 v[180:183], v[244:247], v[40:43], v[180:183]
  ds_read_b64_tr_b16 v[236:237], v24 offset:9224
  v_mfma_f32_16x16x32_bf16 v[200:203], v[244:247], v[44:47], v[200:203]
  ds_read_b64_tr_b16 v[238:239], v24 offset:11528
  s_waitcnt lgkmcnt(9)
  v_mfma_f32_16x16x32_bf16 v[184:187], v[216:219], v[40:43], v[184:187]
  ds_read_b64_tr_b16 v[240:241], v24 offset:9232
  v_mfma_f32_16x16x32_bf16 v[204:207], v[216:219], v[44:47], v[204:207]
  ds_read_b64_tr_b16 v[242:243], v24 offset:11536
  s_waitcnt lgkmcnt(9)
  v_mfma_f32_16x16x32_bf16 v[188:191], v[220:223], v[40:43], v[188:191]
  ds_read_b64_tr_b16 v[244:245], v24 offset:9240
  v_mfma_f32_16x16x32_bf16 v[208:211], v[220:223], v[44:47], v[208:211]
  ds_read_b64_tr_b16 v[246:247], v24 offset:11544
  s_waitcnt lgkmcnt(9)
  v_mfma_f32_16x16x32_bf16 v[192:195], v[224:227], v[40:43], v[192:195]
  ds_read_b64_tr_b16 v[216:217], v24 offset:9248
  v_mfma_f32_16x16x32_bf16 v[212:215], v[224:227], v[44:47], v[212:215]
  ds_read_b64_tr_b16 v[218:219], v24 offset:11552
  s_waitcnt lgkmcnt(10)
  v_mfma_f32_16x16x32_bf16 v[4:7], v[228:231], v[40:43], v[4:7]
  s_lshl_b32 s91, s92, 6
  v_add_u32 v14, s91, v25
  s_add_u32 s92, s92, 1
  s_cmp_eq_u32 s92, 18
  s_cselect_b32 s92, 0, s92
  ds_read_b128 v[220:223], v14
  v_mfma_f32_16x16x32_bf16 v[8:11], v[228:231], v[44:47], v[8:11]
  s_waitcnt lgkmcnt(9)
  v_mfma_f32_16x16x32_bf16 v[176:179], v[232:235], v[48:51], v[176:179]
  ds_read_b64_tr_b16 v[224:225], v24 offset:13824
  v_mfma_f32_16x16x32_bf16 v[196:199], v[232:235], v[52:55], v[196:199]
  ds_read_b64_tr_b16 v[226:227], v24 offset:16128
  s_waitcnt lgkmcnt(9)
  v_mfma_f32_16x16x32_bf16 v[180:183], v[236:239], v[48:51], v[180:183]
  ds_read_b64_tr_b16 v[228:229], v24 offset:13832
  v_mfma_f32_16x16x32_bf16 v[200:203], v[236:239], v[52:55], v[200:203]
  ds_read_b64_tr_b16 v[230:231], v24 offset:16136
  s_waitcnt lgkmcnt(9)
  v_mfma_f32_16x16x32_bf16 v[184:187], v[240:243], v[48:51], v[184:187]
  ds_read_b64_tr_b16 v[232:233], v24 offset:13840
  v_mfma_f32_16x16x32_bf16 v[204:207], v[240:243], v[52:55], v[204:207]
  ds_read_b64_tr_b16 v[234:235], v24 offset:16144
  s_waitcnt lgkmcnt(9)
  v_mfma_f32_16x16x32_bf16 v[188:191], v[244:247], v[48:51], v[188:191]
  ds_read_b64_tr_b16 v[236:237], v24 offset:13848
  v_mfma_f32_16x16x32_bf16 v[208:211], v[244:247], v[52:55], v[208:211]
  ds_read_b64_tr_b16 v[238:239], v24 offset:16152
  s_waitcnt lgkmcnt(9)
  v_mfma_f32_16x16x32_bf16 v[192:195], v[216:219], v[48:51], v[192:195]
  ds_read_b64_tr_b16 v[240:241], v24 offset:13856
  v_mfma_f32_16x16x32_bf16 v[212:215], v[216:219], v[52:55], v[212:215]
  ds_read_b64_tr_b16 v[242:243], v24 offset:16160
  s_waitcnt lgkmcnt(10)
  v_mfma_f32_16x16x32_bf16 v[4:7], v[220:223], v[48:51], v[4:7]
  s_lshl_b32 s91, s92, 6
  v_add_u32 v14, s91, v25
  s_add_u32 s92, s92, 1
  s_cmp_eq_u32 s92, 18
  s_cselect_b32 s92, 0, s92
  ds_read_b128 v[244:247], v14
  v_mfma_f32_16x16x32_bf16 v[8:11], v[220:223], v[52:55], v[8:11]
  s_waitcnt lgkmcnt(9)
  v_mfma_f32_16x16x32_bf16 v[176:179], v[224:227], v[56:59], v[176:179]
  ds_read_b64_tr_b16 v[216:217], v24 offset:18432
  v_mfma_f32_16x16x32_bf16 v[196:199], v[224:227], v[60:63], v[196:199]
  ds_read_b64_tr_b16 v[218:219], v24 offset:20736
  s_waitcnt lgkmcnt(9)
  v_mfma_f32_16x16x32_bf16 v[180:183], v[228:231], v[56:59], v[180:183]
  ds_read_b64_tr_b16 v[220:221], v24 offset:18440
  v_mfma_f32_16x16x32_bf16 v[200:203], v[228:231], v[60:63], v[200:203]
  ds_read_b64_tr_b16 v[222:223], v24 offset:20744
  s_waitcnt lgkmcnt(9)
  v_mfma_f32_16x16x32_bf16 v[184:187], v[232:235], v[56:59], v[184:187]
  ds_read_b64_tr_b16 v[224:225], v24 offset:18448
  v_mfma_f32_16x16x32_bf16 v[204:207], v[232:235], v[60:63], v[204:207]
  ds_read_b64_tr_b16 v[226:227], v24 offset:20752
  s_waitcnt lgkmcnt(9)
  v_mfma_f32_16x16x32_bf16 v[188:191], v[236:239], v[56:59], v[188:191]
  ds_read_b64_tr_b16 v[228:229], v24 offset:18456
  v_mfma_f32_16x16x32_bf16 v[208:211], v[236:239], v[60:63], v[208:211]
  ds_read_b64_tr_b16 v[230:231], v24 offset:20760
  s_waitcnt lgkmcnt(9)
  v_mfma_f32_16x16x32_bf16 v[192:195], v[240:243], v[56:59], v[192:195]
  ds_read_b64_tr_b16 v[232:233], v24 offset:18464
  v_mfma_f32_16x16x32_bf16 v[212:215], v[240:243], v[60:63], v[212:215]
  ds_read_b64_tr_b16 v[234:235], v24 offset:20768
  s_waitcnt lgkmcnt(10)
  v_mfma_f32_16x16x32_bf16 v[4:7], v[244:247], v[56:59], v[4:7]
  s_lshl_b32 s91, s92, 6
  v_add_u32 v14, s91, v25
  s_add_u32 s92, s92, 1
  s_cmp_eq_u32 s92, 18
  s_cselect_b32 s92, 0, s92
  ds_read_b128 v[236:239], v14
  v_mfma_f32_16x16x32_bf16 v[8:11], v[244:247], v[60:63], v[8:11]
  s_waitcnt lgkmcnt(9)
  v_mfma_f32_16x16x32_bf16 v[176:179], v[216:219], v[64:67], v[176:179]
  ds_read_b64_tr_b16 v[240:241], v24 offset:23040
  v_mfma_f32_16x16x32_bf16 v[196:199], v[216:219], v[68:71], v[196:199]
  ds_read_b64_tr_b16 v[242:243], v24 offset:25344
  s_waitcnt lgkmcnt(9)
  v_mfma_f32_16x16x32_bf16 v[180:183], v[220:223], v[64:67], v[180:183]
  ds_read_b64_tr_b16 v[244:245], v24 offset:23048
  v_mfma_f32_16x16x32_bf16 v[200:203], v[220:223], v[68:71], v[200:203]
  ds_read_b64_tr_b16 v[246:247], v24 offset:25352
  s_waitcnt lgkmcnt(9)
  v_mfma_f32_16x16x32_bf16 v[184:187], v[224:227], v[64:67], v[184:187]
  ds_read_b64_tr_b16 v[216:217], v24 offset:23056
  v_mfma_f32_16x16x32_bf16 v[204:207], v[224:227], v[68:71], v[204:207]
  ds_read_b64_tr_b16 v[218:219], v24 offset:25360
  s_waitcnt lgkmcnt(9)
  v_mfma_f32_16x16x32_bf16 v[188:191], v[228:231], v[64:67], v[188:191]
  ds_read_b64_tr_b16 v[220:221], v24 offset:23064
  v_mfma_f32_16x16x32_bf16 v[208:211], v[228:231], v[68:71], v[208:211]
  ds_read_b64_tr_b16 v[222:223], v24 offset:25368
  s_waitcnt lgkmcnt(9)
  v_mfma_f32_16x16x32_bf16 v[192:195], v[232:235], v[64:67], v[192:195]
  ds_read_b64_tr_b16 v[224:225], v24 offset:23072
  v_mfma_f32_16x16x32_bf16 v[212:215], v[232:235], v[68:71], v[212:215]
  ds_read_b64_tr_b16 v[226:227], v24 offset:25376
  s_waitcnt lgkmcnt(10)
  v_mfma_f32_16x16x32_bf16 v[4:7], v[236:239], v[64:67], v[4:7]
  s_lshl_b32 s91, s92, 6
  v_add_u32 v14, s91, v25
  s_add_u32 s92, s92, 1
  s_cmp_eq_u32 s92, 18
  s_cselect_b32 s92, 0, s92
  ds_read_b128 v[228:231], v14
  v_mfma_f32_16x16x32_bf16 v[8:11], v[236:239], v[68:71], v[8:11]
  s_waitcnt lgkmcnt(9)
  v_mfma_f32_16x16x32_bf16 v[176:179], v[240:243], v[72:75], v[176:179]
  ds_read_b64_tr_b16 v[232:233], v24 offset:27648
  v_mfma_f32_16x16x32_bf16 v[196:199], v[240:243], v[76:79], v[196:199]
  ds_read_b64_tr_b16 v[234:235], v24 offset:29952
  s_waitcnt lgkmcnt(9)
  v_mfma_f32_16x16x32_bf16 v[180:183], v[244:247], v[72:75], v[180:183]
  ds_read_b64_tr_b16 v[236:237], v24 offset:27656
  v_mfma_f32_16x16x32_bf16 v[200:203], v[244:247], v[76:79], v[200:203]
  ds_read_b64_tr_b16 v[238:239], v24 offset:29960
  s_waitcnt lgkmcnt(9)
  v_mfma_f32_16x16x32_bf16 v[184:187], v[216:219], v[72:75], v[184:187]
  ds_read_b64_tr_b16 v[240:241], v24 offset:27664
  v_mfma_f32_16x16x32_bf16 v[204:207], v[216:219], v[76:79], v[204:207]
  ds_read_b64_tr_b16 v[242:243], v24 offset:29968
  s_waitcnt lgkmcnt(9)
  v_mfma_f32_16x16x32_bf16 v[188:191], v[220:223], v[72:75], v[188:191]
  ds_read_b64_tr_b16 v[244:245], v24 offset:27672
  v_mfma_f32_16x16x32_bf16 v[208:211], v[220:223], v[76:79], v[208:211]
  ds_read_b64_tr_b16 v[246:247], v24 offset:29976
  s_waitcnt lgkmcnt(9)
  v_mfma_f32_16x16x32_bf16 v[192:195], v[224:227], v[72:75], v[192:195]
  ds_read_b64_tr_b16 v[216:217], v24 offset:27680
  v_mfma_f32_16x16x32_bf16 v[212:215], v[224:227], v[76:79], v[212:215]
  ds_read_b64_tr_b16 v[218:219], v24 offset:29984
  s_waitcnt lgkmcnt(10)
  v_mfma_f32_16x16x32_bf16 v[4:7], v[228:231], v[72:75], v[4:7]
  s_lshl_b32 s91, s92, 6
  v_add_u32 v14, s91, v25
  s_add_u32 s92, s92, 1
  s_cmp_eq_u32 s92, 18
  s_cselect_b32 s92, 0, s92
  ds_read_b128 v[220:223], v14
  v_mfma_f32_16x16x32_bf16 v[8:11], v[228:231], v[76:79], v[8:11]
  s_waitcnt lgkmcnt(9)
  v_mfma_f32_16x16x32_bf16 v[176:179], v[232:235], v[80:83], v[176:179]
  ds_read_b64_tr_b16 v[224:225], v24 offset:32256
  v_mfma_f32_16x16x32_bf16 v[196:199], v[232:235], v[84:87], v[196:199]
  ds_read_b64_tr_b16 v[226:227], v24 offset:34560
  s_waitcnt lgkmcnt(9)
  v_mfma_f32_16x16x32_bf16 v[180:183], v[236:239], v[80:83], v[180:183]
  ds_read_b64_tr_b16 v[228:229], v24 offset:32264
  v_mfma_f32_16x16x32_bf16 v[200:203], v[236:239], v[84:87], v[200:203]
  ds_read_b64_tr_b16 v[230:231], v24 offset:34568
  s_waitcnt lgkmcnt(9)
  v_mfma_f32_16x16x32_bf16 v[184:187], v[240:243], v[80:83], v[184:187]
  ds_read_b64_tr_b16 v[232:233], v24 offset:32272
  v_mfma_f32_16x16x32_bf16 v[204:207], v[240:243], v[84:87], v[204:207]
  ds_read_b64_tr_b16 v[234:235], v24 offset:34576
  s_waitcnt lgkmcnt(9)
  v_mfma_f32_16x16x32_bf16 v[188:191], v[244:247], v[80:83], v[188:191]
  ds_read_b64_tr_b16 v[236:237], v24 offset:32280
  v_mfma_f32_16x16x32_bf16 v[208:211], v[244:247], v[84:87], v[208:211]
  ds_read_b64_tr_b16 v[238:239], v24 offset:34584
  s_waitcnt lgkmcnt(9)
  v_mfma_f32_16x16x32_bf16 v[192:195], v[216:219], v[80:83], v[192:195]
  ds_read_b64_tr_b16 v[240:241], v24 offset:32288
  v_mfma_f32_16x16x32_bf16 v[212:215], v[216:219], v[84:87], v[212:215]
  ds_read_b64_tr_b16 v[242:243], v24 offset:34592
  s_waitcnt lgkmcnt(10)
  v_mfma_f32_16x16x32_bf16 v[4:7], v[220:223], v[80:83], v[4:7]
  s_lshl_b32 s91, s92, 6
  v_add_u32 v14, s91, v25
  s_add_u32 s92, s92, 1
  s_cmp_eq_u32 s92, 18
  s_cselect_b32 s92, 0, s92
  ds_read_b128 v[244:247], v14
  v_mfma_f32_16x16x32_bf16 v[8:11], v[220:223], v[84:87], v[8:11]
  s_waitcnt lgkmcnt(9)
  v_mfma_f32_16x16x32_bf16 v[176:179], v[224:227], v[88:91], v[176:179]
  ds_read_b64_tr_b16 v[216:217], v24 offset:36864
  v_mfma_f32_16x16x32_bf16 v[196:199], v[224:227], v[92:95], v[196:199]
  ds_read_b64_tr_b16 v[218:219], v24 offset:39168
  s_waitcnt lgkmcnt(9)
  v_mfma_f32_16x16x32_bf16 v[180:183], v[228:231], v[88:91], v[180:183]
  ds_read_b64_tr_b16 v[220:221], v24 offset:36872
  v_mfma_f32_16x16x32_bf16 v[200:203], v[228:231], v[92:95], v[200:203]
  ds_read_b64_tr_b16 v[222:223], v24 offset:39176
  s_waitcnt lgkmcnt(9)
  v_mfma_f32_16x16x32_bf16 v[184:187], v[232:235], v[88:91], v[184:187]
  ds_read_b64_tr_b16 v[224:225], v24 offset:36880
  v_mfma_f32_16x16x32_bf16 v[204:207], v[232:235], v[92:95], v[204:207]
  ds_read_b64_tr_b16 v[226:227], v24 offset:39184
  s_waitcnt lgkmcnt(9)
  v_mfma_f32_16x16x32_bf16 v[188:191], v[236:239], v[88:91], v[188:191]
  ds_read_b64_tr_b16 v[228:229], v24 offset:36888
  v_mfma_f32_16x16x32_bf16 v[208:211], v[236:239], v[92:95], v[208:211]
  ds_read_b64_tr_b16 v[230:231], v24 offset:39192
  s_waitcnt lgkmcnt(9)
  v_mfma_f32_16x16x32_bf16 v[192:195], v[240:243], v[88:91], v[192:195]
  ds_read_b64_tr_b16 v[232:233], v24 offset:36896
  v_mfma_f32_16x16x32_bf16 v[212:215], v[240:243], v[92:95], v[212:215]
  ds_read_b64_tr_b16 v[234:235], v24 offset:39200
  s_waitcnt lgkmcnt(10)
  v_mfma_f32_16x16x32_bf16 v[4:7], v[244:247], v[88:91], v[4:7]
  s_lshl_b32 s91, s92, 6
  v_add_u32 v14, s91, v25
  s_add_u32 s92, s92, 1
  s_cmp_eq_u32 s92, 18
  s_cselect_b32 s92, 0, s92
  ds_read_b128 v[236:239], v14
  v_mfma_f32_16x16x32_bf16 v[8:11], v[244:247], v[92:95], v[8:11]
  s_waitcnt lgkmcnt(9)
  v_mfma_f32_16x16x32_bf16 v[176:179], v[216:219], v[96:99], v[176:179]
  ds_read_b64_tr_b16 v[240:241], v24 offset:41472
  v_mfma_f32_16x16x32_bf16 v[196:199], v[216:219], v[100:103], v[196:199]
  ds_read_b64_tr_b16 v[242:243], v24 offset:43776
  s_waitcnt lgkmcnt(9)
  v_mfma_f32_16x16x32_bf16 v[180:183], v[220:223], v[96:99], v[180:183]
  ds_read_b64_tr_b16 v[244:245], v24 offset:41480
  v_mfma_f32_16x16x32_bf16 v[200:203], v[220:223], v[100:103], v[200:203]
  ds_read_b64_tr_b16 v[246:247], v24 offset:43784
  s_waitcnt lgkmcnt(9)
  v_mfma_f32_16x16x32_bf16 v[184:187], v[224:227], v[96:99], v[184:187]
  ds_read_b64_tr_b16 v[216:217], v24 offset:41488
  v_mfma_f32_16x16x32_bf16 v[204:207], v[224:227], v[100:103], v[204:207]
  ds_read_b64_tr_b16 v[218:219], v24 offset:43792
  s_waitcnt lgkmcnt(9)
  v_mfma_f32_16x16x32_bf16 v[188:191], v[228:231], v[96:99], v[188:191]
  ds_read_b64_tr_b16 v[220:221], v24 offset:41496
  v_mfma_f32_16x16x32_bf16 v[208:211], v[228:231], v[100:103], v[208:211]
  ds_read_b64_tr_b16 v[222:223], v24 offset:43800
  s_waitcnt lgkmcnt(9)
  v_mfma_f32_16x16x32_bf16 v[192:195], v[232:235], v[96:99], v[192:195]
  ds_read_b64_tr_b16 v[224:225], v24 offset:41504
  v_mfma_f32_16x16x32_bf16 v[212:215], v[232:235], v[100:103], v[212:215]
  ds_read_b64_tr_b16 v[226:227], v24 offset:43808
  s_waitcnt lgkmcnt(10)
  v_mfma_f32_16x16x32_bf16 v[4:7], v[236:239], v[96:99], v[4:7]
  s_lshl_b32 s91, s92, 6
  v_add_u32 v14, s91, v25
  s_add_u32 s92, s92, 1
  s_cmp_eq_u32 s92, 18
  s_cselect_b32 s92, 0, s92
  ds_read_b128 v[228:231], v14
  v_mfma_f32_16x16x32_bf16 v[8:11], v[236:239], v[100:103], v[8:11]
  s_waitcnt lgkmcnt(9)
  v_mfma_f32_16x16x32_bf16 v[176:179], v[240:243], v[104:107], v[176:179]
  ds_read_b64_tr_b16 v[232:233], v24 offset:46080
  v_mfma_f32_16x16x32_bf16 v[196:199], v[240:243], v[108:111], v[196:199]
  ds_read_b64_tr_b16 v[234:235], v24 offset:48384
  s_waitcnt lgkmcnt(9)
  v_mfma_f32_16x16x32_bf16 v[180:183], v[244:247], v[104:107], v[180:183]
  ds_read_b64_tr_b16 v[236:237], v24 offset:46088
  v_mfma_f32_16x16x32_bf16 v[200:203], v[244:247], v[108:111], v[200:203]
  ds_read_b64_tr_b16 v[238:239], v24 offset:48392
  s_waitcnt lgkmcnt(9)
  v_mfma_f32_16x16x32_bf16 v[184:187], v[216:219], v[104:107], v[184:187]
  ds_read_b64_tr_b16 v[240:241], v24 offset:46096
  v_mfma_f32_16x16x32_bf16 v[204:207], v[216:219], v[108:111], v[204:207]
  ds_read_b64_tr_b16 v[242:243], v24 offset:48400
  s_waitcnt lgkmcnt(9)
  v_mfma_f32_16x16x32_bf16 v[188:191], v[220:223], v[104:107], v[188:191]
  ds_read_b64_tr_b16 v[244:245], v24 offset:46104
  v_mfma_f32_16x16x32_bf16 v[208:211], v[220:223], v[108:111], v[208:211]
  ds_read_b64_tr_b16 v[246:247], v24 offset:48408
  s_waitcnt lgkmcnt(9)
  v_mfma_f32_16x16x32_bf16 v[192:195], v[224:227], v[104:107], v[192:195]
  ds_read_b64_tr_b16 v[216:217], v24 offset:46112
  v_mfma_f32_16x16x32_bf16 v[212:215], v[224:227], v[108:111], v[212:215]
  ds_read_b64_tr_b16 v[218:219], v24 offset:48416
  s_waitcnt lgkmcnt(10)
  v_mfma_f32_16x16x32_bf16 v[4:7], v[228:231], v[104:107], v[4:7]
  s_lshl_b32 s91, s92, 6
  v_add_u32 v14, s91, v25
  s_add_u32 s92, s92, 1
  s_cmp_eq_u32 s92, 18
  s_cselect_b32 s92, 0, s92
  ds_read_b128 v[220:223], v14
  v_mfma_f32_16x16x32_bf16 v[8:11], v[228:231], v[108:111], v[8:11]
  s_waitcnt lgkmcnt(9)
  v_mfma_f32_16x16x32_bf16 v[176:179], v[232:235], v[112:115], v[176:179]
  ds_read_b64_tr_b16 v[224:225], v24 offset:50688
  v_mfma_f32_16x16x32_bf16 v[196:199], v[232:235], v[116:119], v[196:199]
  ds_read_b64_tr_b16 v[226:227], v24 offset:52992
  s_waitcnt lgkmcnt(9)
  v_mfma_f32_16x16x32_bf16 v[180:183], v[236:239], v[112:115], v[180:183]
  ds_read_b64_tr_b16 v[228:229], v24 offset:50696
  v_mfma_f32_16x16x32_bf16 v[200:203], v[236:239], v[116:119], v[200:203]
  ds_read_b64_tr_b16 v[230:231], v24 offset:53000
  s_waitcnt lgkmcnt(9)
  v_mfma_f32_16x16x32_bf16 v[184:187], v[240:243], v[112:115], v[184:187]
  ds_read_b64_tr_b16 v[232:233], v24 offset:50704
  v_mfma_f32_16x16x32_bf16 v[204:207], v[240:243], v[116:119], v[204:207]
  ds_read_b64_tr_b16 v[234:235], v24 offset:53008
  s_waitcnt lgkmcnt(9)
  v_mfma_f32_16x16x32_bf16 v[188:191], v[244:247], v[112:115], v[188:191]
  ds_read_b64_tr_b16 v[236:237], v24 offset:50712
  v_mfma_f32_16x16x32_bf16 v[208:211], v[244:247], v[116:119], v[208:211]
  ds_read_b64_tr_b16 v[238:239], v24 offset:53016
  s_waitcnt lgkmcnt(9)
  v_mfma_f32_16x16x32_bf16 v[192:195], v[216:219], v[112:115], v[192:195]
  ds_read_b64_tr_b16 v[240:241], v24 offset:50720
  v_mfma_f32_16x16x32_bf16 v[212:215], v[216:219], v[116:119], v[212:215]
  ds_read_b64_tr_b16 v[242:243], v24 offset:53024
  s_waitcnt lgkmcnt(10)
  v_mfma_f32_16x16x32_bf16 v[4:7], v[220:223], v[112:115], v[4:7]
  s_lshl_b32 s91, s92, 6
  v_add_u32 v14, s91, v25
  s_add_u32 s92, s92, 1
  s_cmp_eq_u32 s92, 18
  s_cselect_b32 s92, 0, s92
  ds_read_b128 v[244:247], v14
  v_mfma_f32_16x16x32_bf16 v[8:11], v[220:223], v[116:119], v[8:11]
  s_waitcnt lgkmcnt(9)
  v_mfma_f32_16x16x32_bf16 v[176:179], v[224:227], v[120:123], v[176:179]
  ds_read_b64_tr_b16 v[216:217], v24 offset:55296
  v_mfma_f32_16x16x32_bf16 v[196:199], v[224:227], v[124:127], v[196:199]
  ds_read_b64_tr_b16 v[218:219], v24 offset:57600
  s_waitcnt lgkmcnt(9)
  v_mfma_f32_16x16x32_bf16 v[180:183], v[228:231], v[120:123], v[180:183]
  ds_read_b64_tr_b16 v[220:221], v24 offset:55304
  v_mfma_f32_16x16x32_bf16 v[200:203], v[228:231], v[124:127], v[200:203]
  ds_read_b64_tr_b16 v[222:223], v24 offset:57608
  s_waitcnt lgkmcnt(9)
  v_mfma_f32_16x16x32_bf16 v[184:187], v[232:235], v[120:123], v[184:187]
  ds_read_b64_tr_b16 v[224:225], v24 offset:55312
  v_mfma_f32_16x16x32_bf16 v[204:207], v[232:235], v[124:127], v[204:207]
  ds_read_b64_tr_b16 v[226:227], v24 offset:57616
  s_waitcnt lgkmcnt(9)
  v_mfma_f32_16x16x32_bf16 v[188:191], v[236:239], v[120:123], v[188:191]
  ds_read_b64_tr_b16 v[228:229], v24 offset:55320
  v_mfma_f32_16x16x32_bf16 v[208:211], v[236:239], v[124:127], v[208:211]
  ds_read_b64_tr_b16 v[230:231], v24 offset:57624
  s_waitcnt lgkmcnt(9)
  v_mfma_f32_16x16x32_bf16 v[192:195], v[240:243], v[120:123], v[192:195]
  ds_read_b64_tr_b16 v[232:233], v24 offset:55328
  v_mfma_f32_16x16x32_bf16 v[212:215], v[240:243], v[124:127], v[212:215]
  ds_read_b64_tr_b16 v[234:235], v24 offset:57632
  s_waitcnt lgkmcnt(10)
  v_mfma_f32_16x16x32_bf16 v[4:7], v[244:247], v[120:123], v[4:7]
  s_lshl_b32 s91, s92, 6
  v_add_u32 v14, s91, v25
  s_add_u32 s92, s92, 1
  s_cmp_eq_u32 s92, 18
  s_cselect_b32 s92, 0, s92
  ds_read_b128 v[236:239], v14
  v_mfma_f32_16x16x32_bf16 v[8:11], v[244:247], v[124:127], v[8:11]
  s_waitcnt lgkmcnt(9)
  v_mfma_f32_16x16x32_bf16 v[176:179], v[216:219], v[128:131], v[176:179]
  ds_read_b64_tr_b16 v[240:241], v24 offset:59904
  v_mfma_f32_16x16x32_bf16 v[196:199], v[216:219], v[132:135], v[196:199]
  ds_read_b64_tr_b16 v[242:243], v24 offset:62208
  s_waitcnt lgkmcnt(9)
  v_mfma_f32_16x16x32_bf16 v[180:183], v[220:223], v[128:131], v[180:183]
  ds_read_b64_tr_b16 v[244:245], v24 offset:59912
  v_mfma_f32_16x16x32_bf16 v[200:203], v[220:223], v[132:135], v[200:203]
  ds_read_b64_tr_b16 v[246:247], v24 offset:62216
  s_waitcnt lgkmcnt(9)
  v_mfma_f32_16x16x32_bf16 v[184:187], v[224:227], v[128:131], v[184:187]
  ds_read_b64_tr_b16 v[216:217], v24 offset:59920
  v_mfma_f32_16x16x32_bf16 v[204:207], v[224:227], v[132:135], v[204:207]
  ds_read_b64_tr_b16 v[218:219], v24 offset:62224
  s_waitcnt lgkmcnt(9)
  v_mfma_f32_16x16x32_bf16 v[188:191], v[228:231], v[128:131], v[188:191]
  ds_read_b64_tr_b16 v[220:221], v24 offset:59928
  v_mfma_f32_16x16x32_bf16 v[208:211], v[228:231], v[132:135], v[208:211]
  ds_read_b64_tr_b16 v[222:223], v24 offset:62232
  s_waitcnt lgkmcnt(9)
  v_mfma_f32_16x16x32_bf16 v[192:195], v[232:235], v[128:131], v[192:195]
  ds_read_b64_tr_b16 v[224:225], v24 offset:59936
  v_mfma_f32_16x16x32_bf16 v[212:215], v[232:235], v[132:135], v[212:215]
  ds_read_b64_tr_b16 v[226:227], v24 offset:62240
  s_waitcnt lgkmcnt(10)
  v_mfma_f32_16x16x32_bf16 v[4:7], v[236:239], v[128:131], v[4:7]
  s_lshl_b32 s91, s92, 6
  v_add_u32 v14, s91, v25
  s_add_u32 s92, s92, 1
  s_cmp_eq_u32 s92, 18
  s_cselect_b32 s92, 0, s92
  ds_read_b128 v[228:231], v14
  v_mfma_f32_16x16x32_bf16 v[8:11], v[236:239], v[132:135], v[8:11]
  s_waitcnt lgkmcnt(9)
  v_mfma_f32_16x16x32_bf16 v[176:179], v[240:243], v[136:139], v[176:179]
  ds_read_b64_tr_b16 v[232:233], v23 offset:49152
  v_mfma_f32_16x16x32_bf16 v[196:199], v[240:243], v[140:143], v[196:199]
  ds_read_b64_tr_b16 v[234:235], v23 offset:51456
  s_waitcnt lgkmcnt(9)
  v_mfma_f32_16x16x32_bf16 v[180:183], v[244:247], v[136:139], v[180:183]
  ds_read_b64_tr_b16 v[236:237], v23 offset:49160
  v_mfma_f32_16x16x32_bf16 v[200:203], v[244:247], v[140:143], v[200:203]
  ds_read_b64_tr_b16 v[238:239], v23 offset:51464
  s_waitcnt lgkmcnt(9)
  v_mfma_f32_16x16x32_bf16 v[184:187], v[216:219], v[136:139], v[184:187]
  ds_read_b64_tr_b16 v[240:241], v23 offset:49168
  v_mfma_f32_16x16x32_bf16 v[204:207], v[216:219], v[140:143], v[204:207]
  ds_read_b64_tr_b16 v[242:243], v23 offset:51472
  s_waitcnt lgkmcnt(9)
  v_mfma_f32_16x16x32_bf16 v[188:191], v[220:223], v[136:139], v[188:191]
  ds_read_b64_tr_b16 v[244:245], v23 offset:49176
  v_mfma_f32_16x16x32_bf16 v[208:211], v[220:223], v[140:143], v[208:211]
  ds_read_b64_tr_b16 v[246:247], v23 offset:51480
  s_waitcnt lgkmcnt(9)
  v_mfma_f32_16x16x32_bf16 v[192:195], v[224:227], v[136:139], v[192:195]
  ds_read_b64_tr_b16 v[216:217], v23 offset:49184
  v_mfma_f32_16x16x32_bf16 v[212:215], v[224:227], v[140:143], v[212:215]
  ds_read_b64_tr_b16 v[218:219], v23 offset:51488
  s_waitcnt lgkmcnt(10)
  v_mfma_f32_16x16x32_bf16 v[4:7], v[228:231], v[136:139], v[4:7]
  s_lshl_b32 s91, s92, 6
  v_add_u32 v14, s91, v25
  s_add_u32 s92, s92, 1
  s_cmp_eq_u32 s92, 18
  s_cselect_b32 s92, 0, s92
  ds_read_b128 v[220:223], v14
  v_mfma_f32_16x16x32_bf16 v[8:11], v[228:231], v[140:143], v[8:11]
  s_waitcnt lgkmcnt(9)
  v_mfma_f32_16x16x32_bf16 v[176:179], v[232:235], v[144:147], v[176:179]
  ds_read_b64_tr_b16 v[224:225], v23 offset:53760
  v_mfma_f32_16x16x32_bf16 v[196:199], v[232:235], v[148:151], v[196:199]
  ds_read_b64_tr_b16 v[226:227], v23 offset:56064
  s_waitcnt lgkmcnt(9)
  v_mfma_f32_16x16x32_bf16 v[180:183], v[236:239], v[144:147], v[180:183]
  ds_read_b64_tr_b16 v[228:229], v23 offset:53768
  v_mfma_f32_16x16x32_bf16 v[200:203], v[236:239], v[148:151], v[200:203]
  ds_read_b64_tr_b16 v[230:231], v23 offset:56072
  s_waitcnt lgkmcnt(9)
  v_mfma_f32_16x16x32_bf16 v[184:187], v[240:243], v[144:147], v[184:187]
  ds_read_b64_tr_b16 v[232:233], v23 offset:53776
  v_mfma_f32_16x16x32_bf16 v[204:207], v[240:243], v[148:151], v[204:207]
  ds_read_b64_tr_b16 v[234:235], v23 offset:56080
  s_waitcnt lgkmcnt(9)
  v_mfma_f32_16x16x32_bf16 v[188:191], v[244:247], v[144:147], v[188:191]
  ds_read_b64_tr_b16 v[236:237], v23 offset:53784
  v_mfma_f32_16x16x32_bf16 v[208:211], v[244:247], v[148:151], v[208:211]
  ds_read_b64_tr_b16 v[238:239], v23 offset:56088
  s_waitcnt lgkmcnt(9)
  v_mfma_f32_16x16x32_bf16 v[192:195], v[216:219], v[144:147], v[192:195]
  ds_read_b64_tr_b16 v[240:241], v23 offset:53792
  v_mfma_f32_16x16x32_bf16 v[212:215], v[216:219], v[148:151], v[212:215]
  ds_read_b64_tr_b16 v[242:243], v23 offset:56096
  s_waitcnt lgkmcnt(10)
  v_mfma_f32_16x16x32_bf16 v[4:7], v[220:223], v[144:147], v[4:7]
  s_lshl_b32 s91, s92, 6
  v_add_u32 v14, s91, v25
  s_add_u32 s92, s92, 1
  s_cmp_eq_u32 s92, 18
  s_cselect_b32 s92, 0, s92
  ds_read_b128 v[244:247], v14
  v_mfma_f32_16x16x32_bf16 v[8:11], v[220:223], v[148:151], v[8:11]
  s_waitcnt lgkmcnt(9)
  v_mfma_f32_16x16x32_bf16 v[176:179], v[224:227], v[152:155], v[176:179]
  ds_read_b64_tr_b16 v[216:217], v23 offset:58368
  v_mfma_f32_16x16x32_bf16 v[196:199], v[224:227], v[156:159], v[196:199]
  ds_read_b64_tr_b16 v[218:219], v23 offset:60672
  s_waitcnt lgkmcnt(9)
  v_mfma_f32_16x16x32_bf16 v[180:183], v[228:231], v[152:155], v[180:183]
  ds_read_b64_tr_b16 v[220:221], v23 offset:58376
  v_mfma_f32_16x16x32_bf16 v[200:203], v[228:231], v[156:159], v[200:203]
  ds_read_b64_tr_b16 v[222:223], v23 offset:60680
  s_waitcnt lgkmcnt(9)
  v_mfma_f32_16x16x32_bf16 v[184:187], v[232:235], v[152:155], v[184:187]
  ds_read_b64_tr_b16 v[224:225], v23 offset:58384
  v_mfma_f32_16x16x32_bf16 v[204:207], v[232:235], v[156:159], v[204:207]
  ds_read_b64_tr_b16 v[226:227], v23 offset:60688
  s_waitcnt lgkmcnt(9)
  v_mfma_f32_16x16x32_bf16 v[188:191], v[236:239], v[152:155], v[188:191]
  ds_read_b64_tr_b16 v[228:229], v23 offset:58392
  v_mfma_f32_16x16x32_bf16 v[208:211], v[236:239], v[156:159], v[208:211]
  ds_read_b64_tr_b16 v[230:231], v23 offset:60696
  s_waitcnt lgkmcnt(9)
  v_mfma_f32_16x16x32_bf16 v[192:195], v[240:243], v[152:155], v[192:195]
  ds_read_b64_tr_b16 v[232:233], v23 offset:58400
  v_mfma_f32_16x16x32_bf16 v[212:215], v[240:243], v[156:159], v[212:215]
  ds_read_b64_tr_b16 v[234:235], v23 offset:60704
  s_waitcnt lgkmcnt(10)
  v_mfma_f32_16x16x32_bf16 v[4:7], v[244:247], v[152:155], v[4:7]
  s_lshl_b32 s91, s92, 6
  v_add_u32 v14, s91, v25
  s_add_u32 s92, s92, 1
  s_cmp_eq_u32 s92, 18
  s_cselect_b32 s92, 0, s92
  ds_read_b128 v[236:239], v14
  v_mfma_f32_16x16x32_bf16 v[8:11], v[244:247], v[156:159], v[8:11]
  s_waitcnt lgkmcnt(9)
  v_mfma_f32_16x16x32_bf16 v[176:179], v[216:219], v[160:163], v[176:179]
  ds_read_b64_tr_b16 v[240:241], v23 offset:41472
  v_mfma_f32_16x16x32_bf16 v[196:199], v[216:219], v[164:167], v[196:199]
  ds_read_b64_tr_b16 v[242:243], v23 offset:43776
  s_waitcnt lgkmcnt(9)
  v_mfma_f32_16x16x32_bf16 v[180:183], v[220:223], v[160:163], v[180:183]
  ds_read_b64_tr_b16 v[244:245], v23 offset:41480
  v_mfma_f32_16x16x32_bf16 v[200:203], v[220:223], v[164:167], v[200:203]
  ds_read_b64_tr_b16 v[246:247], v23 offset:43784
  s_waitcnt lgkmcnt(9)
  v_mfma_f32_16x16x32_bf16 v[184:187], v[224:227], v[160:163], v[184:187]
  ds_read_b64_tr_b16 v[216:217], v23 offset:41488
  v_mfma_f32_16x16x32_bf16 v[204:207], v[224:227], v[164:167], v[204:207]
  ds_read_b64_tr_b16 v[218:219], v23 offset:43792
  s_waitcnt lgkmcnt(9)
  v_mfma_f32_16x16x32_bf16 v[188:191], v[228:231], v[160:163], v[188:191]
  ds_read_b64_tr_b16 v[220:221], v23 offset:41496
  v_mfma_f32_16x16x32_bf16 v[208:211], v[228:231], v[164:167], v[208:211]
  ds_read_b64_tr_b16 v[222:223], v23 offset:43800
  s_waitcnt lgkmcnt(9)
  v_mfma_f32_16x16x32_bf16 v[192:195], v[232:235], v[160:163], v[192:195]
  ds_read_b64_tr_b16 v[224:225], v23 offset:41504
  v_mfma_f32_16x16x32_bf16 v[212:215], v[232:235], v[164:167], v[212:215]
  ds_read_b64_tr_b16 v[226:227], v23 offset:43808
  s_waitcnt lgkmcnt(10)
  v_mfma_f32_16x16x32_bf16 v[4:7], v[236:239], v[160:163], v[4:7]
  s_lshl_b32 s91, s92, 6
  v_add_u32 v14, s91, v25
  s_add_u32 s92, s92, 1
  s_cmp_eq_u32 s92, 18
  s_cselect_b32 s92, 0, s92
  ds_read_b128 v[228:231], v14
  v_mfma_f32_16x16x32_bf16 v[8:11], v[236:239], v[164:167], v[8:11]
  s_waitcnt lgkmcnt(9)
  v_mfma_f32_16x16x32_bf16 v[176:179], v[240:243], v[168:171], v[176:179]
  v_mfma_f32_16x16x32_bf16 v[196:199], v[240:243], v[172:175], v[196:199]
  s_waitcnt lgkmcnt(7)
  v_mfma_f32_16x16x32_bf16 v[180:183], v[244:247], v[168:171], v[180:183]
  v_mfma_f32_16x16x32_bf16 v[200:203], v[244:247], v[172:175], v[200:203]
  s_waitcnt lgkmcnt(5)
  v_mfma_f32_16x16x32_bf16 v[184:187], v[216:219], v[168:171], v[184:187]
  v_mfma_f32_16x16x32_bf16 v[204:207], v[216:219], v[172:175], v[204:207]
  s_waitcnt lgkmcnt(3)
  v_mfma_f32_16x16x32_bf16 v[188:191], v[220:223], v[168:171], v[188:191]
  v_mfma_f32_16x16x32_bf16 v[208:211], v[220:223], v[172:175], v[208:211]
  s_waitcnt lgkmcnt(1)
  v_mfma_f32_16x16x32_bf16 v[192:195], v[224:227], v[168:171], v[192:195]
  v_mfma_f32_16x16x32_bf16 v[212:215], v[224:227], v[172:175], v[212:215]
  s_waitcnt lgkmcnt(0)
  v_mfma_f32_16x16x32_bf16 v[4:7], v[228:231], v[168:171], v[4:7]
  v_mfma_f32_16x16x32_bf16 v[8:11], v[228:231], v[172:175], v[8:11]
  v_mov_b32 v12, 163200
  v_mov_b32 v13, 1
  s_mov_b64 exec, 1
  ds_add_u32 v12, v13
  s_mov_b64 exec, -1
  v_cmp_eq_u32 vcc, 1, v3
  s_nop 1
  v_cndmask_b32 v4, v4, v8, vcc
  v_lshlrev_b32 v6, 2, v1
  v_cmp_gt_u32 vcc, 32, v1
  v_mov_b32 v7, 2147418112
  s_nop 0
  v_cndmask_b32 v6, v7, v6, vcc
  s_lshl_b32 s50, s40, 9
  s_lshl_b32 s51, s45, 7
  s_add_u32 s50, s50, s51
  s_add_u32 s50, s50, 10485760
  s_cmp_eq_u32 s41, 0
  s_cselect_b32 s50, s50, 2147418112
  buffer_store_dword v4, v6, s[12:15], s50 offen sc1
  v_cvt_pk_bf16_f32 v32, v176, v177
  v_cvt_pk_bf16_f32 v33, v178, v179
  v_cvt_pk_bf16_f32 v34, v180, v181
  v_cvt_pk_bf16_f32 v35, v182, v183
  v_cvt_pk_bf16_f32 v36, v184, v185
  v_cvt_pk_bf16_f32 v37, v186, v187
  v_cvt_pk_bf16_f32 v38, v188, v189
  v_cvt_pk_bf16_f32 v39, v190, v191
  v_cvt_pk_bf16_f32 v40, v192, v193
  v_cvt_pk_bf16_f32 v41, v194, v195
  v_mov_b32 v42, 0
  v_mov_b32 v43, 0
  v_cvt_pk_bf16_f32 v44, v196, v197
  v_cvt_pk_bf16_f32 v45, v198, v199
  v_cvt_pk_bf16_f32 v46, v200, v201
  v_cvt_pk_bf16_f32 v47, v202, v203
  v_cvt_pk_bf16_f32 v48, v204, v205
  v_cvt_pk_bf16_f32 v49, v206, v207
  v_cvt_pk_bf16_f32 v50, v208, v209
  v_cvt_pk_bf16_f32 v51, v210, v211
  v_cvt_pk_bf16_f32 v52, v212, v213
  v_cvt_pk_bf16_f32 v53, v214, v215
  v_mov_b32 v54, 0
  v_mov_b32 v55, 0
  ds_read_b128 v[144:147], v248 offset:0
  ds_read_b128 v[148:151], v248 offset:16
  ds_read_b128 v[152:155], v248 offset:32
  ds_read_b128 v[156:159], v248 offset:192
  ds_read_b128 v[160:163], v248 offset:208
  ds_read_b128 v[164:167], v248 offset:224
  ds_read_b128 v[168:171], v248 offset:384
  ds_read_b128 v[172:175], v248 offset:400
  ds_read_b128 v[176:179], v248 offset:416
  ds_read_b128 v[180:183], v248 offset:576
  ds_read_b128 v[184:187], v248 offset:592
  ds_read_b128 v[188:191], v248 offset:608
  ds_read_b128 v[192:195], v248 offset:768
  ds_read_b128 v[196:199], v248 offset:784
  ds_read_b128 v[200:203], v248 offset:800
  v_mov_b32 v4, 163200
  s_mov_b32 s59, 0
  s_nop 0
L_cw17:
  ds_read_b32 v5, v4
  s_waitcnt lgkmcnt(0)
  v_readfirstlane_b32 s50, v5
  s_add_u32 s59, s59, 1
  s_cmp_gt_u32 s59, 2000000
  s_nop 2
  s_cbranch_scc1 L_cw17d
  s_cmp_ge_u32 s50, 4
  s_cbranch_scc1 L_cw17d
  s_setprio 0
  s_sleep 1
  s_branch L_cw17
L_cw17d:
  s_waitcnt lgkmcnt(0)
  v_mfma_f32_16x16x32_bf16 v[64:67], v[144:147], v[32:35], 0
  v_mfma_f32_16x16x32_bf16 v[64:67], v[148:151], v[36:39], v[64:67]
  v_mfma_f32_16x16x32_bf16 v[64:67], v[152:155], v[40:43], v[64:67]
  v_mfma_f32_16x16x32_bf16 v[68:71], v[156:159], v[32:35], 0
  v_mfma_f32_16x16x32_bf16 v[68:71], v[160:163], v[36:39], v[68:71]
  v_mfma_f32_16x16x32_bf16 v[68:71], v[164:167], v[40:43], v[68:71]
  v_mfma_f32_16x16x32_bf16 v[72:75], v[168:171], v[32:35], 0
  v_mfma_f32_16x16x32_bf16 v[72:75], v[172:175], v[36:39], v[72:75]
  v_mfma_f32_16x16x32_bf16 v[72:75], v[176:179], v[40:43], v[72:75]
  v_mfma_f32_16x16x32_bf16 v[76:79], v[180:183], v[32:35], 0
  v_mfma_f32_16x16x32_bf16 v[76:79], v[184:187], v[36:39], v[76:79]
  v_mfma_f32_16x16x32_bf16 v[76:79], v[188:191], v[40:43], v[76:79]
  v_mfma_f32_16x16x32_bf16 v[80:83], v[192:195], v[32:35], 0
  v_mfma_f32_16x16x32_bf16 v[80:83], v[196:199], v[36:39], v[80:83]
  v_mfma_f32_16x16x32_bf16 v[80:83], v[200:203], v[40:43], v[80:83]
  v_mfma_f32_16x16x32_bf16 v[104:107], v[144:147], v[44:47], 0
  v_max3_f32 v4, v64, v65, v66
  v_min3_f32 v6, v64, v65, v66
  v_max3_f32 v8, v67, v68, v69
  v_mfma_f32_16x16x32_bf16 v[104:107], v[148:151], v[48:51], v[104:107]
  v_min3_f32 v9, v67, v68, v69
  v_max3_f32 v4, v4, v70, v71
  v_min3_f32 v6, v6, v70, v71
  v_mfma_f32_16x16x32_bf16 v[104:107], v[152:155], v[52:55], v[104:107]
  v_max3_f32 v8, v8, v72, v73
  v_min3_f32 v9, v9, v72, v73
  v_max3_f32 v4, v4, v74, v75
  v_mfma_f32_16x16x32_bf16 v[108:111], v[156:159], v[44:47], 0
  v_min3_f32 v6, v6, v74, v75
  v_max3_f32 v8, v8, v76, v77
  v_min3_f32 v9, v9, v76, v77
  v_mfma_f32_16x16x32_bf16 v[108:111], v[160:163], v[48:51], v[108:111]
  v_max3_f32 v4, v4, v78, v79
  v_min3_f32 v6, v6, v78, v79
  v_max3_f32 v8, v8, v80, v81
  v_mfma_f32_16x16x32_bf16 v[108:111], v[164:167], v[52:55], v[108:111]
  v_min3_f32 v9, v9, v80, v81
  v_max_f32 v4, v4, v8
  v_min_f32 v6, v6, v9
  v_mfma_f32_16x16x32_bf16 v[112:115], v[168:171], v[44:47], 0
  v_mul_f32 v4, s62, v4
  v_mul_f32 v6, s60, v6
  v_pk_fma_f32 v[84:85], v[64:65], s[60:61], v[4:5] op_sel_hi:[1,1,0]
  v_mfma_f32_16x16x32_bf16 v[112:115], v[172:175], v[48:51], v[112:115]
  v_pk_fma_f32 v[64:65], v[64:65], s[62:63], v[6:7] op_sel_hi:[1,1,0]
  v_pk_fma_f32 v[86:87], v[66:67], s[60:61], v[4:5] op_sel_hi:[1,1,0]
  v_pk_fma_f32 v[66:67], v[66:67], s[62:63], v[6:7] op_sel_hi:[1,1,0]
  v_mfma_f32_16x16x32_bf16 v[112:115], v[176:179], v[52:55], v[112:115]
  v_pk_fma_f32 v[88:89], v[68:69], s[60:61], v[4:5] op_sel_hi:[1,1,0]
  v_pk_fma_f32 v[68:69], v[68:69], s[62:63], v[6:7] op_sel_hi:[1,1,0]
  v_pk_fma_f32 v[90:91], v[70:71], s[60:61], v[4:5] op_sel_hi:[1,1,0]
  v_mfma_f32_16x16x32_bf16 v[116:119], v[180:183], v[44:47], 0
  v_pk_fma_f32 v[70:71], v[70:71], s[62:63], v[6:7] op_sel_hi:[1,1,0]
  v_pk_fma_f32 v[92:93], v[72:73], s[60:61], v[4:5] op_sel_hi:[1,1,0]
  v_pk_fma_f32 v[72:73], v[72:73], s[62:63], v[6:7] op_sel_hi:[1,1,0]
  v_mfma_f32_16x16x32_bf16 v[116:119], v[184:187], v[48:51], v[116:119]
  v_pk_fma_f32 v[94:95], v[74:75], s[60:61], v[4:5] op_sel_hi:[1,1,0]
  v_pk_fma_f32 v[74:75], v[74:75], s[62:63], v[6:7] op_sel_hi:[1,1,0]
  v_pk_fma_f32 v[96:97], v[76:77], s[60:61], v[4:5] op_sel_hi:[1,1,0]
  v_mfma_f32_16x16x32_bf16 v[116:119], v[188:191], v[52:55], v[116:119]
  v_pk_fma_f32 v[76:77], v[76:77], s[62:63], v[6:7] op_sel_hi:[1,1,0]
  v_pk_fma_f32 v[98:99], v[78:79], s[60:61], v[4:5] op_sel_hi:[1,1,0]
  v_pk_fma_f32 v[78:79], v[78:79], s[62:63], v[6:7] op_sel_hi:[1,1,0]
  v_mfma_f32_16x16x32_bf16 v[120:123], v[192:195], v[44:47], 0
  v_pk_fma_f32 v[100:101], v[80:81], s[60:61], v[4:5] op_sel_hi:[1,1,0]
  v_pk_fma_f32 v[80:81], v[80:81], s[62:63], v[6:7] op_sel_hi:[1,1,0]
  v_exp_f32 v84, v84
  v_mfma_f32_16x16x32_bf16 v[120:123], v[196:199], v[48:51], v[120:123]
  v_exp_f32 v64, v64
  v_exp_f32 v85, v85
  v_exp_f32 v65, v65
  v_mfma_f32_16x16x32_bf16 v[120:123], v[200:203], v[52:55], v[120:123]
  v_exp_f32 v86, v86
  v_exp_f32 v66, v66
  v_exp_f32 v87, v87
  v_exp_f32 v67, v67
  v_exp_f32 v88, v88
  v_exp_f32 v68, v68
  v_exp_f32 v89, v89
  v_exp_f32 v69, v69
  v_exp_f32 v90, v90
  v_exp_f32 v70, v70
  v_exp_f32 v91, v91
  v_exp_f32 v71, v71
  v_exp_f32 v92, v92
  v_exp_f32 v72, v72
  v_exp_f32 v93, v93
  v_exp_f32 v73, v73
  v_exp_f32 v94, v94
  v_exp_f32 v74, v74
  v_exp_f32 v95, v95
  v_exp_f32 v75, v75
  v_exp_f32 v96, v96
  v_exp_f32 v76, v76
  v_exp_f32 v97, v97
  v_exp_f32 v77, v77
  v_exp_f32 v98, v98
  v_exp_f32 v78, v78
  v_exp_f32 v99, v99
  v_exp_f32 v79, v79
  v_exp_f32 v100, v100
  v_exp_f32 v80, v80
  v_exp_f32 v101, v101
  v_exp_f32 v81, v81
  v_pk_add_f32 v[8:9], v[84:85], v[86:87]
  v_pk_add_f32 v[10:11], v[64:65], v[66:67]
  v_pk_add_f32 v[8:9], v[8:9], v[88:89]
  v_pk_add_f32 v[10:11], v[10:11], v[68:69]
  v_pk_add_f32 v[8:9], v[8:9], v[90:91]
  v_pk_add_f32 v[10:11], v[10:11], v[70:71]
  v_pk_add_f32 v[8:9], v[8:9], v[92:93]
  v_pk_add_f32 v[10:11], v[10:11], v[72:73]
  v_pk_add_f32 v[8:9], v[8:9], v[94:95]
  v_pk_add_f32 v[10:11], v[10:11], v[74:75]
  v_pk_add_f32 v[8:9], v[8:9], v[96:97]
  v_pk_add_f32 v[10:11], v[10:11], v[76:77]
  v_pk_add_f32 v[8:9], v[8:9], v[98:99]
  v_pk_add_f32 v[10:11], v[10:11], v[78:79]
  v_pk_add_f32 v[8:9], v[8:9], v[100:101]
  v_pk_add_f32 v[10:11], v[10:11], v[80:81]
  v_add_f32 v8, v8, v9
  v_add_f32 v10, v10, v11
  v_rcp_f32 v8, v8
  v_rcp_f32 v10, v10
  v_pk_mul_f32 v[84:85], v[84:85], v[8:9] op_sel_hi:[1,0]
  v_pk_mul_f32 v[64:65], v[64:65], v[10:11] op_sel_hi:[1,0]
  v_pk_mul_f32 v[86:87], v[86:87], v[8:9] op_sel_hi:[1,0]
  v_pk_mul_f32 v[66:67], v[66:67], v[10:11] op_sel_hi:[1,0]
  v_pk_mul_f32 v[88:89], v[88:89], v[8:9] op_sel_hi:[1,0]
  v_pk_mul_f32 v[68:69], v[68:69], v[10:11] op_sel_hi:[1,0]
  v_pk_mul_f32 v[90:91], v[90:91], v[8:9] op_sel_hi:[1,0]
  v_pk_mul_f32 v[70:71], v[70:71], v[10:11] op_sel_hi:[1,0]
  v_pk_mul_f32 v[92:93], v[92:93], v[8:9] op_sel_hi:[1,0]
  v_pk_mul_f32 v[72:73], v[72:73], v[10:11] op_sel_hi:[1,0]
  v_pk_mul_f32 v[94:95], v[94:95], v[8:9] op_sel_hi:[1,0]
  v_pk_mul_f32 v[74:75], v[74:75], v[10:11] op_sel_hi:[1,0]
  v_pk_mul_f32 v[96:97], v[96:97], v[8:9] op_sel_hi:[1,0]
  v_pk_mul_f32 v[76:77], v[76:77], v[10:11] op_sel_hi:[1,0]
  v_pk_mul_f32 v[98:99], v[98:99], v[8:9] op_sel_hi:[1,0]
  v_pk_mul_f32 v[78:79], v[78:79], v[10:11] op_sel_hi:[1,0]
  v_pk_mul_f32 v[100:101], v[100:101], v[8:9] op_sel_hi:[1,0]
  v_pk_mul_f32 v[80:81], v[80:81], v[10:11] op_sel_hi:[1,0]
  v_cvt_pk_bf16_f32 v124, v84, v85
  v_cvt_pk_bf16_f32 v125, v86, v87
  v_cvt_pk_bf16_f32 v126, v88, v89
  v_cvt_pk_bf16_f32 v127, v90, v91
  v_cvt_pk_bf16_f32 v128, v92, v93
  v_cvt_pk_bf16_f32 v129, v94, v95
  v_cvt_pk_bf16_f32 v130, v96, v97
  v_cvt_pk_bf16_f32 v131, v98, v99
  v_cvt_pk_bf16_f32 v132, v100, v101
  v_cvt_pk_bf16_f32 v133, v64, v65
  v_cvt_pk_bf16_f32 v134, v66, v67
  v_cvt_pk_bf16_f32 v135, v68, v69
  v_cvt_pk_bf16_f32 v136, v70, v71
  v_cvt_pk_bf16_f32 v137, v72, v73
  v_cvt_pk_bf16_f32 v138, v74, v75
  v_cvt_pk_bf16_f32 v139, v76, v77
  v_cvt_pk_bf16_f32 v140, v78, v79
  v_cvt_pk_bf16_f32 v141, v80, v81
  v_mov_b32 v142, 0
  v_mov_b32 v143, 0
  s_mul_i32 s50, s45, 5120
  s_add_u32 s50, s50, 81920
  v_add_u32 v12, s50, v250
  ds_write_b128 v12, v[124:127] offset:0
  ds_write_b128 v12, v[128:131] offset:1024
  ds_write_b128 v12, v[132:135] offset:2048
  ds_write_b128 v12, v[136:139] offset:3072
  ds_write_b128 v12, v[140:143] offset:4096
  v_max3_f32 v4, v104, v105, v106
  v_min3_f32 v6, v104, v105, v106
  v_max3_f32 v8, v107, v108, v109
  v_min3_f32 v9, v107, v108, v109
  v_max3_f32 v4, v4, v110, v111
  v_min3_f32 v6, v6, v110, v111
  v_max3_f32 v8, v8, v112, v113
  v_min3_f32 v9, v9, v112, v113
  v_max3_f32 v4, v4, v114, v115
  v_min3_f32 v6, v6, v114, v115
  v_max3_f32 v8, v8, v116, v117
  v_min3_f32 v9, v9, v116, v117
  v_max3_f32 v4, v4, v118, v119
  v_min3_f32 v6, v6, v118, v119
  v_max3_f32 v8, v8, v120, v121
  v_min3_f32 v9, v9, v120, v121
  v_max_f32 v4, v4, v8
  v_min_f32 v6, v6, v9
  v_mul_f32 v4, s62, v4
  v_mul_f32 v6, s60, v6
  v_pk_fma_f32 v[84:85], v[104:105], s[60:61], v[4:5] op_sel_hi:[1,1,0]
  v_pk_fma_f32 v[104:105], v[104:105], s[62:63], v[6:7] op_sel_hi:[1,1,0]
  v_pk_fma_f32 v[86:87], v[106:107], s[60:61], v[4:5] op_sel_hi:[1,1,0]
  v_pk_fma_f32 v[106:107], v[106:107], s[62:63], v[6:7] op_sel_hi:[1,1,0]
  v_pk_fma_f32 v[88:89], v[108:109], s[60:61], v[4:5] op_sel_hi:[1,1,0]
  v_pk_fma_f32 v[108:109], v[108:109], s[62:63], v[6:7] op_sel_hi:[1,1,0]
  v_pk_fma_f32 v[90:91], v[110:111], s[60:61], v[4:5] op_sel_hi:[1,1,0]
  v_pk_fma_f32 v[110:111], v[110:111], s[62:63], v[6:7] op_sel_hi:[1,1,0]
  v_pk_fma_f32 v[92:93], v[112:113], s[60:61], v[4:5] op_sel_hi:[1,1,0]
  v_pk_fma_f32 v[112:113], v[112:113], s[62:63], v[6:7] op_sel_hi:[1,1,0]
  v_pk_fma_f32 v[94:95], v[114:115], s[60:61], v[4:5] op_sel_hi:[1,1,0]
  v_pk_fma_f32 v[114:115], v[114:115], s[62:63], v[6:7] op_sel_hi:[1,1,0]
  v_pk_fma_f32 v[96:97], v[116:117], s[60:61], v[4:5] op_sel_hi:[1,1,0]
  v_pk_fma_f32 v[116:117], v[116:117], s[62:63], v[6:7] op_sel_hi:[1,1,0]
  v_pk_fma_f32 v[98:99], v[118:119], s[60:61], v[4:5] op_sel_hi:[1,1,0]
  v_pk_fma_f32 v[118:119], v[118:119], s[62:63], v[6:7] op_sel_hi:[1,1,0]
  v_pk_fma_f32 v[100:101], v[120:121], s[60:61], v[4:5] op_sel_hi:[1,1,0]
  v_pk_fma_f32 v[120:121], v[120:121], s[62:63], v[6:7] op_sel_hi:[1,1,0]
  v_exp_f32 v84, v84
  v_exp_f32 v104, v104
  v_exp_f32 v85, v85
  v_exp_f32 v105, v105
  v_exp_f32 v86, v86
  v_exp_f32 v106, v106
  v_exp_f32 v87, v87
  v_exp_f32 v107, v107
  v_exp_f32 v88, v88
  v_exp_f32 v108, v108
  v_exp_f32 v89, v89
  v_exp_f32 v109, v109
  v_exp_f32 v90, v90
  v_exp_f32 v110, v110
  v_exp_f32 v91, v91
  v_exp_f32 v111, v111
  v_exp_f32 v92, v92
  v_exp_f32 v112, v112
  v_exp_f32 v93, v93
  v_exp_f32 v113, v113
  v_exp_f32 v94, v94
  v_exp_f32 v114, v114
  v_exp_f32 v95, v95
  v_exp_f32 v115, v115
  v_exp_f32 v96, v96
  v_exp_f32 v116, v116
  v_exp_f32 v97, v97
  v_exp_f32 v117, v117
  v_exp_f32 v98, v98
  v_exp_f32 v118, v118
  v_exp_f32 v99, v99
  v_exp_f32 v119, v119
  v_exp_f32 v100, v100
  v_exp_f32 v120, v120
  v_exp_f32 v101, v101
  v_exp_f32 v121, v121
  v_pk_add_f32 v[8:9], v[84:85], v[86:87]
  v_pk_add_f32 v[10:11], v[104:105], v[106:107]
  v_pk_add_f32 v[8:9], v[8:9], v[88:89]
  v_pk_add_f32 v[10:11], v[10:11], v[108:109]
  v_pk_add_f32 v[8:9], v[8:9], v[90:91]
  v_pk_add_f32 v[10:11], v[10:11], v[110:111]
  v_pk_add_f32 v[8:9], v[8:9], v[92:93]
  v_pk_add_f32 v[10:11], v[10:11], v[112:113]
  v_pk_add_f32 v[8:9], v[8:9], v[94:95]
  v_pk_add_f32 v[10:11], v[10:11], v[114:115]
  v_pk_add_f32 v[8:9], v[8:9], v[96:97]
  v_pk_add_f32 v[10:11], v[10:11], v[116:117]
  v_pk_add_f32 v[8:9], v[8:9], v[98:99]
  v_pk_add_f32 v[10:11], v[10:11], v[118:119]
  v_pk_add_f32 v[8:9], v[8:9], v[100:101]
  v_pk_add_f32 v[10:11], v[10:11], v[120:121]
  v_add_f32 v8, v8, v9
  v_add_f32 v10, v10, v11
  v_rcp_f32 v8, v8
  v_rcp_f32 v10, v10
  v_pk_mul_f32 v[84:85], v[84:85], v[8:9] op_sel_hi:[1,0]
  v_pk_mul_f32 v[104:105], v[104:105], v[10:11] op_sel_hi:[1,0]
  v_pk_mul_f32 v[86:87], v[86:87], v[8:9] op_sel_hi:[1,0]
  v_pk_mul_f32 v[106:107], v[106:107], v[10:11] op_sel_hi:[1,0]
  v_pk_mul_f32 v[88:89], v[88:89], v[8:9] op_sel_hi:[1,0]
  v_pk_mul_f32 v[108:109], v[108:109], v[10:11] op_sel_hi:[1,0]
  v_pk_mul_f32 v[90:91], v[90:91], v[8:9] op_sel_hi:[1,0]
  v_pk_mul_f32 v[110:111], v[110:111], v[10:11] op_sel_hi:[1,0]
  v_pk_mul_f32 v[92:93], v[92:93], v[8:9] op_sel_hi:[1,0]
  v_pk_mul_f32 v[112:113], v[112:113], v[10:11] op_sel_hi:[1,0]
  v_pk_mul_f32 v[94:95], v[94:95], v[8:9] op_sel_hi:[1,0]
  v_pk_mul_f32 v[114:115], v[114:115], v[10:11] op_sel_hi:[1,0]
  v_pk_mul_f32 v[96:97], v[96:97], v[8:9] op_sel_hi:[1,0]
  v_pk_mul_f32 v[116:117], v[116:117], v[10:11] op_sel_hi:[1,0]
  v_pk_mul_f32 v[98:99], v[98:99], v[8:9] op_sel_hi:[1,0]
  v_pk_mul_f32 v[118:119], v[118:119], v[10:11] op_sel_hi:[1,0]
  v_pk_mul_f32 v[100:101], v[100:101], v[8:9] op_sel_hi:[1,0]
  v_pk_mul_f32 v[120:121], v[120:121], v[10:11] op_sel_hi:[1,0]
  v_cvt_pk_bf16_f32 v204, v84, v85
  v_cvt_pk_bf16_f32 v205, v86, v87
  v_cvt_pk_bf16_f32 v206, v88, v89
  v_cvt_pk_bf16_f32 v207, v90, v91
  v_cvt_pk_bf16_f32 v208, v92, v93
  v_cvt_pk_bf16_f32 v209, v94, v95
  v_cvt_pk_bf16_f32 v210, v96, v97
  v_cvt_pk_bf16_f32 v211, v98, v99
  v_cvt_pk_bf16_f32 v212, v100, v101
  v_cvt_pk_bf16_f32 v213, v104, v105
  v_cvt_pk_bf16_f32 v214, v106, v107
  v_cvt_pk_bf16_f32 v215, v108, v109
  v_cvt_pk_bf16_f32 v216, v110, v111
  v_cvt_pk_bf16_f32 v217, v112, v113
  v_cvt_pk_bf16_f32 v218, v114, v115
  v_cvt_pk_bf16_f32 v219, v116, v117
  v_cvt_pk_bf16_f32 v220, v118, v119
  v_cvt_pk_bf16_f32 v221, v120, v121
  v_mov_b32 v222, 0
  v_mov_b32 v223, 0
  s_add_u32 s51, s66, 52992
  s_add_u32 m0, s54, 41472
  s_nop 0
  buffer_load_dwordx4 v250, s[12:15], s51 offen lds
  s_add_u32 s51, s66, 57088
  s_add_u32 m0, s54, 45568
  s_nop 0
  buffer_load_dwordx4 v250, s[12:15], s51 offen lds
  s_add_u32 s51, s66, 61184
  s_add_u32 m0, s54, 49664
  s_nop 0
  buffer_load_dwordx4 v250, s[12:15], s51 offen lds
  s_add_u32 s51, s66, 65280
  s_add_u32 m0, s54, 53760
  s_nop 0
  buffer_load_dwordx4 v250, s[12:15], s51 offen lds
  s_add_u32 s51, s66, 69376
  s_add_u32 m0, s54, 57856
  s_nop 0
  buffer_load_dwordx4 v250, s[12:15], s51 offen lds
  s_add_u32 s51, s66, 73472
  s_add_u32 m0, s54, 61952
  s_nop 0
  buffer_load_dwordx4 v250, s[12:15], s51 offen lds
  s_add_u32 s51, s66, 77568
  s_add_u32 m0, s54, 66048
  s_nop 0
  buffer_load_dwordx4 v250, s[12:15], s51 offen lds
  s_add_u32 s51, s66, 81664
  s_add_u32 m0, s54, 70144
  s_nop 0
  buffer_load_dwordx4 v250, s[12:15], s51 offen lds
  s_add_u32 s51, s66, 85760
  s_add_u32 m0, s54, 74240
  s_nop 0
  buffer_load_dwordx4 v250, s[12:15], s51 offen lds
  v_cmp_gt_u32 vcc, 2304, v252
  s_nop 0
  s_mov_b64 exec, vcc
  s_add_u32 s51, s66, 89856
  s_add_u32 m0, s54, 78336
  s_nop 0
  buffer_load_dwordx4 v250, s[12:15], s51 offen lds
  s_mov_b64 exec, -1
  s_add_u32 s51, s66, 92160
  s_add_u32 m0, s54, 103680
  s_nop 0
  buffer_load_dwordx4 v250, s[12:15], s51 offen lds
  s_add_u32 s51, s66, 96256
  s_add_u32 m0, s54, 107776
  s_nop 0
  buffer_load_dwordx4 v250, s[12:15], s51 offen lds
  s_add_u32 s51, s66, 100352
  s_add_u32 m0, s54, 111872
  s_nop 0
  buffer_load_dwordx4 v250, s[12:15], s51 offen lds
  s_add_u32 s51, s66, 104448
  s_add_u32 m0, s54, 115968
  s_nop 0
  buffer_load_dwordx4 v250, s[12:15], s51 offen lds
  s_add_u32 s51, s66, 108544
  s_add_u32 m0, s54, 120064
  s_nop 0
  buffer_load_dwordx4 v250, s[12:15], s51 offen lds
  s_add_u32 s51, s66, 112640
  s_add_u32 m0, s54, 124160
  s_nop 0
  buffer_load_dwordx4 v250, s[12:15], s51 offen lds
  s_add_u32 s51, s66, 116736
  s_add_u32 m0, s54, 128256
  s_nop 0
  buffer_load_dwordx4 v250, s[12:15], s51 offen lds
  v_cmp_gt_u32 vcc, 1280, v252
  s_nop 0
  s_mov_b64 exec, vcc
  s_add_u32 s51, s66, 120832
  s_add_u32 m0, s54, 132352
  s_nop 0
  buffer_load_dwordx4 v250, s[12:15], s51 offen lds
  s_mov_b64 exec, -1
  s_waitcnt vmcnt(18) lgkmcnt(0)
  s_barrier
  ds_read_b128 v[32:35], v249 offset:0
  ds_read_b128 v[36:39], v249 offset:16
  ds_read_b128 v[40:43], v249 offset:32
  ds_read_b128 v[44:47], v249 offset:48
  ds_read_b128 v[48:51], v249 offset:64
  ds_read_b128 v[52:55], v249 offset:320
  ds_read_b128 v[56:59], v249 offset:336
  ds_read_b128 v[60:63], v249 offset:352
  ds_read_b128 v[64:67], v249 offset:368
  ds_read_b128 v[68:71], v249 offset:384
  ds_read_b128 v[72:75], v249 offset:640
  ds_read_b128 v[76:79], v249 offset:656
  ds_read_b128 v[80:83], v249 offset:672
  s_mul_i32 s50, s44, 2304
  s_add_u32 s50, s50, 81920
  s_movk_i32 s51, 144
  v_mul_u32_u24 v7, s51, v2
  v_add_u32 v7, s50, v7
  v_mul_u32_u24 v8, 36, v3
  v_add_u32 v8, v7, v8
  v_lshl_add_u32 v6, v3, 4, v7
  s_lshr_b32 s50, s93, 2
  s_lshl_b32 s50, s50, 12
  s_and_b32 s51, s93, 3
  s_lshl_b32 s51, s51, 7
  s_add_u32 s50, s50, s51
  s_lshl_b32 s51, s41, 3
  s_add_u32 s50, s50, s51
  s_add_u32 s48, s50, 12582912
  s_waitcnt lgkmcnt(12)
  s_barrier
  v_mfma_f32_16x16x32_bf16 v[136:139], v[32:35], v[204:207], 0
  s_waitcnt lgkmcnt(11)
  v_mfma_f32_16x16x32_bf16 v[136:139], v[36:39], v[208:211], v[136:139]
  s_waitcnt lgkmcnt(10)
  v_mfma_f32_16x16x32_bf16 v[136:139], v[40:43], v[212:215], v[136:139]
  s_waitcnt lgkmcnt(9)
  v_mfma_f32_16x16x32_bf16 v[136:139], v[44:47], v[216:219], v[136:139]
  s_waitcnt lgkmcnt(8)
  v_mfma_f32_16x16x32_bf16 v[136:139], v[48:51], v[220:223], v[136:139]
  s_waitcnt lgkmcnt(7)
  v_mfma_f32_16x16x32_bf16 v[140:143], v[52:55], v[204:207], 0
  s_waitcnt lgkmcnt(6)
  v_mfma_f32_16x16x32_bf16 v[140:143], v[56:59], v[208:211], v[140:143]
  s_waitcnt lgkmcnt(5)
  v_mfma_f32_16x16x32_bf16 v[140:143], v[60:63], v[212:215], v[140:143]
  s_waitcnt lgkmcnt(4)
  v_mfma_f32_16x16x32_bf16 v[140:143], v[64:67], v[216:219], v[140:143]
  s_waitcnt lgkmcnt(3)
  v_mfma_f32_16x16x32_bf16 v[140:143], v[68:71], v[220:223], v[140:143]
  s_waitcnt lgkmcnt(2)
  v_mfma_f32_16x16x32_bf16 v[144:147], v[72:75], v[204:207], 0
  s_waitcnt lgkmcnt(1)
  v_mfma_f32_16x16x32_bf16 v[144:147], v[76:79], v[208:211], v[144:147]
  s_waitcnt lgkmcnt(0)
  v_mfma_f32_16x16x32_bf16 v[144:147], v[80:83], v[212:215], v[144:147]
  ds_read_b128 v[84:87], v249 offset:688
  ds_read_b128 v[88:91], v249 offset:704
  ds_read_b128 v[92:95], v249 offset:960
  ds_read_b128 v[96:99], v249 offset:976
  ds_read_b128 v[100:103], v249 offset:992
  ds_read_b128 v[104:107], v249 offset:1008
  ds_read_b128 v[108:111], v249 offset:1024
  ds_read_b128 v[112:115], v249 offset:1280
  ds_read_b128 v[116:119], v249 offset:1296
  ds_read_b128 v[120:123], v249 offset:1312
  ds_read_b128 v[124:127], v249 offset:1328
  ds_read_b128 v[128:131], v249 offset:1344
  s_waitcnt lgkmcnt(11)
  v_mfma_f32_16x16x32_bf16 v[144:147], v[84:87], v[216:219], v[144:147]
  s_waitcnt lgkmcnt(10)
  v_mfma_f32_16x16x32_bf16 v[144:147], v[88:91], v[220:223], v[144:147]
  s_waitcnt lgkmcnt(9)
  v_mfma_f32_16x16x32_bf16 v[148:151], v[92:95], v[204:207], 0
  s_waitcnt lgkmcnt(8)
  v_mfma_f32_16x16x32_bf16 v[148:151], v[96:99], v[208:211], v[148:151]
  s_waitcnt lgkmcnt(7)
  v_mfma_f32_16x16x32_bf16 v[148:151], v[100:103], v[212:215], v[148:151]
  s_waitcnt lgkmcnt(6)
  v_mfma_f32_16x16x32_bf16 v[148:151], v[104:107], v[216:219], v[148:151]
  s_waitcnt lgkmcnt(5)
  v_mfma_f32_16x16x32_bf16 v[148:151], v[108:111], v[220:223], v[148:151]
  s_waitcnt lgkmcnt(4)
  v_mfma_f32_16x16x32_bf16 v[152:155], v[112:115], v[204:207], 0
  s_waitcnt lgkmcnt(3)
  v_mfma_f32_16x16x32_bf16 v[152:155], v[116:119], v[208:211], v[152:155]
  s_waitcnt lgkmcnt(2)
  v_mfma_f32_16x16x32_bf16 v[152:155], v[120:123], v[212:215], v[152:155]
  s_waitcnt lgkmcnt(1)
  v_mfma_f32_16x16x32_bf16 v[152:155], v[124:127], v[216:219], v[152:155]
  s_waitcnt lgkmcnt(0)
  v_mfma_f32_16x16x32_bf16 v[152:155], v[128:131], v[220:223], v[152:155]
  s_nop 7
  v_add_f32 v4, 0x358637bd, v154
  v_rcp_f32 v4, v4
  s_nop 0
  v_pk_mul_f32 v[136:137], v[136:137], v[4:5] op_sel_hi:[1,0]
  v_pk_mul_f32 v[138:139], v[138:139], v[4:5] op_sel_hi:[1,0]
  v_pk_mul_f32 v[140:141], v[140:141], v[4:5] op_sel_hi:[1,0]
  v_pk_mul_f32 v[142:143], v[142:143], v[4:5] op_sel_hi:[1,0]
  v_pk_mul_f32 v[144:145], v[144:145], v[4:5] op_sel_hi:[1,0]
  v_pk_mul_f32 v[146:147], v[146:147], v[4:5] op_sel_hi:[1,0]
  v_pk_mul_f32 v[148:149], v[148:149], v[4:5] op_sel_hi:[1,0]
  v_pk_mul_f32 v[150:151], v[150:151], v[4:5] op_sel_hi:[1,0]
  v_pk_mul_f32 v[152:153], v[152:153], v[4:5] op_sel_hi:[1,0]
  v_cvt_pk_bf16_f32 v156, v136, v137
  v_cvt_pk_bf16_f32 v157, v138, v139
  v_cvt_pk_bf16_f32 v158, v140, v141
  v_cvt_pk_bf16_f32 v159, v142, v143
  v_cvt_pk_bf16_f32 v160, v144, v145
  v_cvt_pk_bf16_f32 v161, v146, v147
  v_cvt_pk_bf16_f32 v162, v148, v149
  v_cvt_pk_bf16_f32 v163, v150, v151
  v_cvt_pk_bf16_f32 v164, v152, v153
  ds_write2_b32 v8, v156, v157 offset0:0 offset1:1
  ds_write2_b32 v8, v158, v159 offset0:2 offset1:3
  ds_write2_b32 v8, v160, v161 offset0:4 offset1:5
  ds_write2_b32 v8, v162, v163 offset0:6 offset1:7
  ds_write_b32 v8, v164 offset:32
  s_waitcnt lgkmcnt(0)
  ds_read_b128 v[136:139], v6 offset:0
  ds_read_b128 v[140:143], v6 offset:64
  ds_read_b128 v[144:147], v6 offset:128
  s_waitcnt lgkmcnt(2)
  buffer_store_dwordx4 v[136:139], v28, s[12:15], 0 offen sc1
  s_waitcnt lgkmcnt(1)
  buffer_store_dwordx4 v[140:143], v29, s[12:15], 0 offen sc1
  s_waitcnt lgkmcnt(0)
  buffer_store_dwordx4 v[144:147], v30, s[12:15], 0 offen sc1
  s_barrier
  v_mov_b32 v10, s80
  v_mov_b32 v11, s81
  v_lshlrev_b32 v9, 9, v1
  s_waitcnt vmcnt(0)
  s_mov_b64 exec, 255
  buffer_store_dwordx2 v[10:11], v9, s[12:15], s48 offen sc1
  s_mov_b64 exec, -1
  s_add_u32 s51, s66, 122112
  s_add_u32 m0, s54, 0
  s_nop 0
  buffer_load_dwordx4 v250, s[12:15], s51 offen lds
  v_cmp_gt_u32 vcc, 2816, v252
  s_nop 0
  s_mov_b64 exec, vcc
  s_add_u32 s51, s66, 126208
  s_add_u32 m0, s54, 4096
  s_nop 0
  buffer_load_dwordx4 v250, s[12:15], s51 offen lds
  s_mov_b64 exec, -1
  s_add_u32 s51, s66, 129024
  s_add_u32 m0, s54, 80640
  s_nop 0
  buffer_load_dwordx4 v250, s[12:15], s51 offen lds
  s_add_u32 s51, s66, 133120
  s_add_u32 m0, s54, 84736
  s_nop 0
  buffer_load_dwordx4 v250, s[12:15], s51 offen lds
  s_add_u32 s51, s66, 137216
  s_add_u32 m0, s54, 88832
  s_nop 0
  buffer_load_dwordx4 v250, s[12:15], s51 offen lds
  s_add_u32 s51, s66, 141312
  s_add_u32 m0, s54, 92928
  s_nop 0
  buffer_load_dwordx4 v250, s[12:15], s51 offen lds
  s_add_u32 s51, s66, 145408
  s_add_u32 m0, s54, 97024
  s_nop 0
  buffer_load_dwordx4 v250, s[12:15], s51 offen lds
  v_cmp_gt_u32 vcc, 2560, v252
  s_nop 0
  s_mov_b64 exec, vcc
  s_add_u32 s51, s66, 149504
  s_add_u32 m0, s54, 101120
  s_nop 0
  buffer_load_dwordx4 v250, s[12:15], s51 offen lds
  s_mov_b64 exec, -1
  s_add_u32 s51, s66, 152064
  s_add_u32 m0, s54, 156672
  s_nop 0
  buffer_load_dwordx4 v250, s[12:15], s51 offen lds
  v_cmp_gt_u32 vcc, 512, v252
  s_nop 0
  s_mov_b64 exec, vcc
  s_add_u32 s51, s66, 156160
  s_add_u32 m0, s54, 160768
  s_nop 0
  buffer_load_dwordx4 v250, s[12:15], s51 offen lds
  s_mov_b64 exec, -1
  v_cmp_gt_u32 vcc, 2304, v252
  s_nop 0
  s_mov_b64 exec, vcc
  s_add_u32 s51, s66, 156672
  s_add_u32 m0, s54, 154368
  s_nop 0
  buffer_load_dwordx4 v250, s[12:15], s51 offen lds
  s_mov_b64 exec, -1
  v_cmp_gt_u32 vcc, 2304, v252
  s_nop 0
  s_mov_b64 exec, vcc
  s_add_u32 s51, s66, 158976
  s_add_u32 m0, s54, 152064
  s_nop 0
  buffer_load_dwordx4 v250, s[12:15], s51 offen lds
  s_mov_b64 exec, -1
  s_waitcnt vmcnt(0)
  s_barrier
L_fin:
L_end:
  s_endpgm

.section .rodata,"a"
.p2align 6
.amdhsa_kernel gated_mix__linear_kernel_hedgehog__linear_kernel_hedgehog__prompt_kernel
  .amdhsa_next_free_vgpr 256
  .amdhsa_next_free_sgpr 102
  .amdhsa_accum_offset 256
  .amdhsa_group_segment_fixed_size 0
  .amdhsa_kernarg_size 96
  .amdhsa_user_sgpr_count 2
  .amdhsa_user_sgpr_kernarg_segment_ptr 1
  .amdhsa_system_sgpr_workgroup_id_x 1
.end_amdhsa_kernel
```
